```python
import torch

def _softmax(x, axis=-1):
    return torch.softmax(x, dim=axis)
def _gelu(x):
    return torch.nn.functional.gelu(x, approximate="tanh")
def _silu(x):
    return torch.nn.functional.silu(x)
def _sigmoid(x):
    return torch.sigmoid(x)
def _layernorm(x, axis=-1, eps=1e-5):
    m = x.mean(dim=axis, keepdim=True)
    v = x.var(dim=axis, keepdim=True, unbiased=False)
    return (x - m) / torch.sqrt(v + eps)
def _scatter_add(tgt, idx, src, axis=0):
    return tgt.clone().index_add_(axis, idx, src)
def _segment_sum(src, seg, n):
    out = torch.zeros((n,) + src.shape[1:], dtype=src.dtype)
    return out.index_add_(0, seg, src)
def _pad(x, pw):
    flat = tuple(v for pair in reversed(pw) for v in pair)
    return torch.nn.functional.pad(x, flat)

kernel_name = 'gated_mix__compressed_kv_cla__grouped_kv_mqa__prompt'

def setup_inputs():

    _w = (lambda a: (lambda t: t.to(torch.bfloat16) if t.is_floating_point() else t)(torch.as_tensor(a)))
    def _A_setup():
        B, H, Sq, Sk, D, M = 1, 32, 2048, 2048, 128, 512
        Dc = 4 * D
        return {
            "x": _w((lambda *s: torch.randn(*s, dtype=torch.bfloat16) * 0.05)(B, Sq, M)),
            "c_kv": _w((lambda *s: torch.randn(*s, dtype=torch.bfloat16) * 0.8)(B, Sk, Dc)),
            "w_q": _w((lambda *s: torch.randn(*s, dtype=torch.bfloat16) * 6.4)(M, H, D) * (M ** -0.5)),
            "w_uk": _w((lambda *s: torch.randn(*s, dtype=torch.bfloat16) * 6.4)(Dc, H, D) * (Dc ** -0.5)),
            "w_uv": _w((lambda *s: torch.randn(*s, dtype=torch.bfloat16) * 0.8)(Dc, H, D) * (Dc ** -0.5)),
            "w_o": _w((lambda *s: torch.randn(*s, dtype=torch.bfloat16) * 0.8)(H, D, M) * ((H * D) ** -0.5)),
        }
    _A_in = _A_setup()

    def _B_setup():
        B, S, D, H = 1, 2048, 512, 32
        Dh = D // H
        return {
            "x": _w((lambda *s: torch.randn(*s, dtype=torch.bfloat16) * 0.05)(B, S, D)),
            "wq": _w((lambda *s: torch.randn(*s, dtype=torch.bfloat16) * 3.2)(D, H * Dh)),
            "wk": _w((lambda *s: torch.randn(*s, dtype=torch.bfloat16) * 3.2)(D, Dh)),
            "wv": _w((lambda *s: torch.randn(*s, dtype=torch.bfloat16) * 0.1)(D, Dh)),
            "wo": _w((lambda *s: torch.randn(*s, dtype=torch.bfloat16) * 0.1)(H * Dh, D)),
        }
    _B_in = _B_setup()

    return {
        "A_x": _A_in["x"],
        "A_c_kv": _A_in["c_kv"],
        "A_w_q": _A_in["w_q"],
        "A_w_uk": _A_in["w_uk"],
        "A_w_uv": _A_in["w_uv"],
        "A_w_o": _A_in["w_o"],
        "B_x": _B_in["x"],
        "B_wq": _B_in["wq"],
        "B_wk": _B_in["wk"],
        "B_wv": _B_in["wv"],
        "B_wo": _B_in["wo"],
        "gate_w": _w((lambda *s: torch.randn(*s, dtype=torch.bfloat16) * 0.05)(512) * 16.0),
    }

def reference(A_x, A_c_kv, A_w_q, A_w_uk, A_w_uv, A_w_o, B_x, B_wq, B_wk, B_wv, B_wo, gate_w):
    def _A_ref(x, c_kv, w_q, w_uk, w_uv, w_o):
        B, Sq, M = x.shape[0], x.shape[1], x.shape[2]
        Sk = c_kv.shape[1]
        H, D = w_q.shape[1], w_q.shape[2]
        q = torch.einsum("bqm,mhd->bhqd", x, w_q)
        k = torch.einsum("bkc,chd->bhkd", c_kv, w_uk)
        v = torch.einsum("bkc,chd->bhkd", c_kv, w_uv)
        scores = torch.einsum("bhqd,bhkd->bhqk", q, k) * (D ** -0.5)
        off = Sk - Sq
        qi = torch.arange(Sq)[:, None]
        kj = torch.arange(Sk)[None, :]
        cmask = kj <= (qi + off)
        scores = torch.where(cmask[None, None], scores, -1e9)
        p = _softmax(scores, axis=-1)
        ctx = torch.einsum("bhqk,bhkd->bhqd", p, v)
        return torch.einsum("bhqd,hdm->bqm", ctx, w_o)

    def _B_ref(x, wq, wk, wv, wo):
        B, S, D = x.shape
        H = 32
        Dh = D // H
        q = (lambda x, *d: x.permute(*d))((x @ wq).reshape(B, S, H, Dh), 0, 2, 1, 3)
        k = x @ wk
        v = x @ wv
        scores = torch.einsum("bhqd,bkd->bhqk", q, k) * (Dh ** -0.5)
        p = _softmax(scores, axis=-1)
        o = torch.einsum("bhqk,bkd->bhqd", p, v)
        return (lambda x, *d: x.permute(*d))(o, 0, 2, 1, 3).reshape(B, S, H * Dh) @ wo

    x = A_x
    g = _sigmoid((x * gate_w).sum(-1, keepdims=True))
    a = _A_ref(x, A_c_kv, A_w_q, A_w_uk, A_w_uv, A_w_o)
    b = _B_ref(x, B_wq, B_wk, B_wv, B_wo)
    return g * a + (1 - g) * b
```

```asm
; @launch kernel=l0_kernel grid=(80,1,1) block=(256,1,1) lds=65536
; @launch kernel=l1_kernel grid=(512,1,1) block=(256,1,1) lds=65536
; @launch kernel=a_kernel grid=(256,1,1) block=(320,1,1) lds=65536
; @launch kernel=l3_kernel grid=(256,1,1) block=(256,1,1) lds=65536
.amdgcn_target "amdgcn-amd-amdhsa--gfx950"
.text
.globl l0_kernel
.p2align 8
.type l0_kernel,@function
l0_kernel:
  s_cmp_ge_u32 s2, 80
  s_cbranch_scc1 l0_kernel_end
  s_load_dwordx2 s[40:41], s[0:1], 0
  s_load_dwordx2 s[42:43], s[0:1], 56
  s_load_dwordx4 s[44:47], s[0:1], 64
  s_load_dwordx2 s[48:49], s[0:1], 88
  s_load_dwordx2 s[50:51], s[0:1], 112
  s_waitcnt lgkmcnt(0)
  s_cmp_ge_u32 s2, 64
  s_cbranch_scc1 l0_kernel_kv
  s_mov_b32 s16, s2
  v_and_b32 v1, 63, v0
  v_lshrrev_b32 v2, 6, v0
  s_nop 0
  v_readfirstlane_b32 s17, v2
  s_nop 3
  s_and_b32 s18, s17, 1
  s_lshr_b32 s19, s17, 1
  s_lshl_b32 s26, s17, 12
  s_add_u32 s27, s26, 16384
  v_lshrrev_b32 v2, 4, v1
  v_and_b32 v3, 15, v1
  v_lshlrev_b32 v4, 2, v2
  v_xor_b32 v3, v3, v4
  v_lshlrev_b32 v3, 4, v3
  s_mov_b32 s28, 1024
  v_mul_lo_u32 v4, v2, s28
  v_add_u32 v10, v3, v4
  v_lshrrev_b32 v5, 3, v1
  v_and_b32 v3, 7, v1
  v_xor_b32 v3, v3, v2
  v_lshlrev_b32 v3, 4, v3
  s_mov_b32 s28, 1024
  v_mul_lo_u32 v4, v5, s28
  v_add_u32 v11, v3, v4
  v_xor_b32 v12, 64, v11
  v_lshrrev_b32 v2, 5, v1
  v_bfe_u32 v3, v1, 4, 1
  v_bfe_u32 v4, v1, 2, 2
  v_and_b32 v5, 3, v1
  v_lshlrev_b32 v6, 3, v2
  v_add_u32 v6, v6, v4
  v_lshlrev_b32 v6, 8, v6
  v_lshrrev_b32 v7, 1, v5
  v_lshlrev_b32 v8, 1, v3
  v_add_u32 v7, v7, v8
  s_lshl_b32 s28, s18, 3
  v_add_u32 v7, s28, v7
  v_lshlrev_b32 v8, 2, v4
  v_and_b32 v5, 1, v5
  v_lshlrev_b32 v5, 3, v5
  v_add_u32 v6, v6, v5
  v_add_u32 v9, 0, v7
  v_xor_b32 v9, v9, v8
  v_lshlrev_b32 v9, 4, v9
  v_add_u32 v13, v6, v9
  v_add_u32 v9, 4, v7
  v_xor_b32 v9, v9, v8
  v_lshlrev_b32 v9, 4, v9
  v_add_u32 v14, v6, v9
  v_and_b32 v3, 31, v1
  s_lshl_b32 s28, s19, 6
  v_add_u32 v4, s28, v3
  v_lshlrev_b32 v4, 7, v4
  v_bfe_u32 v5, v1, 1, 3
  v_add_u32 v6, 0, v2
  v_xor_b32 v6, v6, v5
  v_lshlrev_b32 v6, 4, v6
  v_add_u32 v15, v4, v6
  v_add_u32 v6, 2, v2
  v_xor_b32 v6, v6, v5
  v_lshlrev_b32 v6, 4, v6
  v_add_u32 v16, v4, v6
  v_add_u32 v6, 4, v2
  v_xor_b32 v6, v6, v5
  v_lshlrev_b32 v6, 4, v6
  v_add_u32 v17, v4, v6
  v_add_u32 v6, 6, v2
  v_xor_b32 v6, v6, v5
  v_lshlrev_b32 v6, 4, v6
  v_add_u32 v18, v4, v6
  s_mov_b32 s28, 1024
  v_mul_lo_u32 v4, v3, s28
  v_lshlrev_b32 v5, 4, v2
  v_add_u32 v19, v4, v5
  s_mov_b32 s4, s40
  s_mov_b32 s5, s41
  s_mov_b32 s6, 0x200000
  s_mov_b32 s7, 0x20000
  s_mov_b32 s8, s42
  s_mov_b32 s9, s43
  s_mov_b32 s10, 0x80000
  s_mov_b32 s11, 0x20000
  s_mov_b32 s12, s50
  s_mov_b32 s13, s51
  s_mov_b32 s14, 0x4600000
  s_mov_b32 s15, 0x20000
  s_lshr_b32 s30, s16, 2
  s_and_b32 s31, s16, 3
  s_lshl_b32 s28, s30, 7
  s_lshl_b32 s21, s17, 5
  s_add_u32 s21, s21, s28
  s_lshl_b32 s21, s21, 10
  s_lshl_b32 s22, s17, 14
  s_lshl_b32 s28, s31, 8
  s_add_u32 s22, s22, s28
  s_lshl_b32 s23, s30, 7
  s_lshl_b32 s28, s19, 6
  s_add_u32 s23, s23, s28
  s_lshl_b32 s23, s23, 10
  s_lshl_b32 s28, s31, 8
  s_add_u32 s23, s23, s28
  s_lshl_b32 s28, s18, 7
  s_add_u32 s23, s23, s28
  s_add_u32 s23, s23, 0x4000000
  s_add_u32 s24, s23, 32768
  s_add_u32 m0, s26, 0
  s_add_u32 s28, s22, 0
  buffer_load_dwordx4 v10, s[8:11], s28 offen lds
  s_add_u32 m0, s26, 1024
  s_add_u32 s28, s22, 4096
  buffer_load_dwordx4 v10, s[8:11], s28 offen lds
  s_add_u32 m0, s26, 2048
  s_add_u32 s28, s22, 8192
  buffer_load_dwordx4 v10, s[8:11], s28 offen lds
  s_add_u32 m0, s26, 3072
  s_add_u32 s28, s22, 12288
  buffer_load_dwordx4 v10, s[8:11], s28 offen lds
  s_add_u32 m0, s27, 0
  s_add_u32 s28, s21, 0
  buffer_load_dwordx4 v11, s[4:7], s28 offen lds
  s_add_u32 m0, s27, 1024
  s_add_u32 s28, s21, 8192
  buffer_load_dwordx4 v12, s[4:7], s28 offen lds
  s_add_u32 m0, s27, 2048
  s_add_u32 s28, s21, 16384
  buffer_load_dwordx4 v11, s[4:7], s28 offen lds
  s_add_u32 m0, s27, 3072
  s_add_u32 s28, s21, 24576
  buffer_load_dwordx4 v12, s[4:7], s28 offen lds
  s_add_u32 s22, s22, 65536
  s_add_u32 s21, s21, 128
  s_waitcnt vmcnt(0)
  s_barrier
  s_add_u32 m0, s26, 32768
  s_add_u32 s28, s22, 0
  buffer_load_dwordx4 v10, s[8:11], s28 offen lds
  s_add_u32 m0, s26, 33792
  s_add_u32 s28, s22, 4096
  buffer_load_dwordx4 v10, s[8:11], s28 offen lds
  s_add_u32 m0, s26, 34816
  s_add_u32 s28, s22, 8192
  buffer_load_dwordx4 v10, s[8:11], s28 offen lds
  s_add_u32 m0, s26, 35840
  s_add_u32 s28, s22, 12288
  buffer_load_dwordx4 v10, s[8:11], s28 offen lds
  s_add_u32 m0, s27, 32768
  s_add_u32 s28, s21, 0
  buffer_load_dwordx4 v11, s[4:7], s28 offen lds
  s_add_u32 m0, s27, 33792
  s_add_u32 s28, s21, 8192
  buffer_load_dwordx4 v12, s[4:7], s28 offen lds
  s_add_u32 m0, s27, 34816
  s_add_u32 s28, s21, 16384
  buffer_load_dwordx4 v11, s[4:7], s28 offen lds
  s_add_u32 m0, s27, 35840
  s_add_u32 s28, s21, 24576
  buffer_load_dwordx4 v12, s[4:7], s28 offen lds
  s_add_u32 s22, s22, 65536
  s_add_u32 s21, s21, 128
  ds_read_b64_tr_b16 v[28:29], v13 offset:0
  ds_read_b64_tr_b16 v[30:31], v13 offset:1024
  ds_read_b64_tr_b16 v[32:33], v14 offset:0
  ds_read_b64_tr_b16 v[34:35], v14 offset:1024
  ds_read_b128 v[36:39], v15 offset:16384
  ds_read_b128 v[40:43], v15 offset:20480
  ds_read_b64_tr_b16 v[44:45], v13 offset:4096
  ds_read_b64_tr_b16 v[46:47], v13 offset:5120
  ds_read_b64_tr_b16 v[48:49], v14 offset:4096
  ds_read_b64_tr_b16 v[50:51], v14 offset:5120
  ds_read_b128 v[52:55], v16 offset:16384
  ds_read_b128 v[56:59], v16 offset:20480
  s_waitcnt lgkmcnt(6)
  v_mfma_f32_32x32x16_bf16 v[64:79], v[28:31], v[36:39], 0
  v_mfma_f32_32x32x16_bf16 v[80:95], v[28:31], v[40:43], 0
  v_mfma_f32_32x32x16_bf16 v[96:111], v[32:35], v[36:39], 0
  v_mfma_f32_32x32x16_bf16 v[112:127], v[32:35], v[40:43], 0
  ds_read_b64_tr_b16 v[28:29], v13 offset:8192
  ds_read_b64_tr_b16 v[30:31], v13 offset:9216
  ds_read_b64_tr_b16 v[32:33], v14 offset:8192
  ds_read_b64_tr_b16 v[34:35], v14 offset:9216
  ds_read_b128 v[36:39], v17 offset:16384
  ds_read_b128 v[40:43], v17 offset:20480
  s_waitcnt lgkmcnt(6)
  v_mfma_f32_32x32x16_bf16 v[64:79], v[44:47], v[52:55], v[64:79]
  v_mfma_f32_32x32x16_bf16 v[80:95], v[44:47], v[56:59], v[80:95]
  v_mfma_f32_32x32x16_bf16 v[96:111], v[48:51], v[52:55], v[96:111]
  v_mfma_f32_32x32x16_bf16 v[112:127], v[48:51], v[56:59], v[112:127]
  ds_read_b64_tr_b16 v[44:45], v13 offset:12288
  ds_read_b64_tr_b16 v[46:47], v13 offset:13312
  ds_read_b64_tr_b16 v[48:49], v14 offset:12288
  ds_read_b64_tr_b16 v[50:51], v14 offset:13312
  ds_read_b128 v[52:55], v18 offset:16384
  ds_read_b128 v[56:59], v18 offset:20480
  s_waitcnt lgkmcnt(6)
  v_mfma_f32_32x32x16_bf16 v[64:79], v[28:31], v[36:39], v[64:79]
  v_mfma_f32_32x32x16_bf16 v[80:95], v[28:31], v[40:43], v[80:95]
  v_mfma_f32_32x32x16_bf16 v[96:111], v[32:35], v[36:39], v[96:111]
  v_mfma_f32_32x32x16_bf16 v[112:127], v[32:35], v[40:43], v[112:127]
  s_waitcnt lgkmcnt(0)
  v_mfma_f32_32x32x16_bf16 v[64:79], v[44:47], v[52:55], v[64:79]
  v_mfma_f32_32x32x16_bf16 v[80:95], v[44:47], v[56:59], v[80:95]
  v_mfma_f32_32x32x16_bf16 v[96:111], v[48:51], v[52:55], v[96:111]
  v_mfma_f32_32x32x16_bf16 v[112:127], v[48:51], v[56:59], v[112:127]
  s_waitcnt vmcnt(0)
  s_barrier
  s_add_u32 m0, s26, 0
  s_add_u32 s28, s22, 0
  buffer_load_dwordx4 v10, s[8:11], s28 offen lds
  s_add_u32 m0, s26, 1024
  s_add_u32 s28, s22, 4096
  buffer_load_dwordx4 v10, s[8:11], s28 offen lds
  s_add_u32 m0, s26, 2048
  s_add_u32 s28, s22, 8192
  buffer_load_dwordx4 v10, s[8:11], s28 offen lds
  s_add_u32 m0, s26, 3072
  s_add_u32 s28, s22, 12288
  buffer_load_dwordx4 v10, s[8:11], s28 offen lds
  s_add_u32 m0, s27, 0
  s_add_u32 s28, s21, 0
  buffer_load_dwordx4 v11, s[4:7], s28 offen lds
  s_add_u32 m0, s27, 1024
  s_add_u32 s28, s21, 8192
  buffer_load_dwordx4 v12, s[4:7], s28 offen lds
  s_add_u32 m0, s27, 2048
  s_add_u32 s28, s21, 16384
  buffer_load_dwordx4 v11, s[4:7], s28 offen lds
  s_add_u32 m0, s27, 3072
  s_add_u32 s28, s21, 24576
  buffer_load_dwordx4 v12, s[4:7], s28 offen lds
  s_add_u32 s22, s22, 65536
  s_add_u32 s21, s21, 128
  ds_read_b64_tr_b16 v[28:29], v13 offset:32768
  ds_read_b64_tr_b16 v[30:31], v13 offset:33792
  ds_read_b64_tr_b16 v[32:33], v14 offset:32768
  ds_read_b64_tr_b16 v[34:35], v14 offset:33792
  ds_read_b128 v[36:39], v15 offset:49152
  ds_read_b128 v[40:43], v15 offset:53248
  ds_read_b64_tr_b16 v[44:45], v13 offset:36864
  ds_read_b64_tr_b16 v[46:47], v13 offset:37888
  ds_read_b64_tr_b16 v[48:49], v14 offset:36864
  ds_read_b64_tr_b16 v[50:51], v14 offset:37888
  ds_read_b128 v[52:55], v16 offset:49152
  ds_read_b128 v[56:59], v16 offset:53248
  s_waitcnt lgkmcnt(6)
  v_mfma_f32_32x32x16_bf16 v[64:79], v[28:31], v[36:39], v[64:79]
  v_mfma_f32_32x32x16_bf16 v[80:95], v[28:31], v[40:43], v[80:95]
  v_mfma_f32_32x32x16_bf16 v[96:111], v[32:35], v[36:39], v[96:111]
  v_mfma_f32_32x32x16_bf16 v[112:127], v[32:35], v[40:43], v[112:127]
  ds_read_b64_tr_b16 v[28:29], v13 offset:40960
  ds_read_b64_tr_b16 v[30:31], v13 offset:41984
  ds_read_b64_tr_b16 v[32:33], v14 offset:40960
  ds_read_b64_tr_b16 v[34:35], v14 offset:41984
  ds_read_b128 v[36:39], v17 offset:49152
  ds_read_b128 v[40:43], v17 offset:53248
  s_waitcnt lgkmcnt(6)
  v_mfma_f32_32x32x16_bf16 v[64:79], v[44:47], v[52:55], v[64:79]
  v_mfma_f32_32x32x16_bf16 v[80:95], v[44:47], v[56:59], v[80:95]
  v_mfma_f32_32x32x16_bf16 v[96:111], v[48:51], v[52:55], v[96:111]
  v_mfma_f32_32x32x16_bf16 v[112:127], v[48:51], v[56:59], v[112:127]
  ds_read_b64_tr_b16 v[44:45], v13 offset:45056
  ds_read_b64_tr_b16 v[46:47], v13 offset:46080
  ds_read_b64_tr_b16 v[48:49], v14 offset:45056
  ds_read_b64_tr_b16 v[50:51], v14 offset:46080
  ds_read_b128 v[52:55], v18 offset:49152
  ds_read_b128 v[56:59], v18 offset:53248
  s_waitcnt lgkmcnt(6)
  v_mfma_f32_32x32x16_bf16 v[64:79], v[28:31], v[36:39], v[64:79]
  v_mfma_f32_32x32x16_bf16 v[80:95], v[28:31], v[40:43], v[80:95]
  v_mfma_f32_32x32x16_bf16 v[96:111], v[32:35], v[36:39], v[96:111]
  v_mfma_f32_32x32x16_bf16 v[112:127], v[32:35], v[40:43], v[112:127]
  s_waitcnt lgkmcnt(0)
  v_mfma_f32_32x32x16_bf16 v[64:79], v[44:47], v[52:55], v[64:79]
  v_mfma_f32_32x32x16_bf16 v[80:95], v[44:47], v[56:59], v[80:95]
  v_mfma_f32_32x32x16_bf16 v[96:111], v[48:51], v[52:55], v[96:111]
  v_mfma_f32_32x32x16_bf16 v[112:127], v[48:51], v[56:59], v[112:127]
  s_waitcnt vmcnt(0)
  s_barrier
  s_add_u32 m0, s26, 32768
  s_add_u32 s28, s22, 0
  buffer_load_dwordx4 v10, s[8:11], s28 offen lds
  s_add_u32 m0, s26, 33792
  s_add_u32 s28, s22, 4096
  buffer_load_dwordx4 v10, s[8:11], s28 offen lds
  s_add_u32 m0, s26, 34816
  s_add_u32 s28, s22, 8192
  buffer_load_dwordx4 v10, s[8:11], s28 offen lds
  s_add_u32 m0, s26, 35840
  s_add_u32 s28, s22, 12288
  buffer_load_dwordx4 v10, s[8:11], s28 offen lds
  s_add_u32 m0, s27, 32768
  s_add_u32 s28, s21, 0
  buffer_load_dwordx4 v11, s[4:7], s28 offen lds
  s_add_u32 m0, s27, 33792
  s_add_u32 s28, s21, 8192
  buffer_load_dwordx4 v12, s[4:7], s28 offen lds
  s_add_u32 m0, s27, 34816
  s_add_u32 s28, s21, 16384
  buffer_load_dwordx4 v11, s[4:7], s28 offen lds
  s_add_u32 m0, s27, 35840
  s_add_u32 s28, s21, 24576
  buffer_load_dwordx4 v12, s[4:7], s28 offen lds
  s_add_u32 s22, s22, 65536
  s_add_u32 s21, s21, 128
  ds_read_b64_tr_b16 v[28:29], v13 offset:0
  ds_read_b64_tr_b16 v[30:31], v13 offset:1024
  ds_read_b64_tr_b16 v[32:33], v14 offset:0
  ds_read_b64_tr_b16 v[34:35], v14 offset:1024
  ds_read_b128 v[36:39], v15 offset:16384
  ds_read_b128 v[40:43], v15 offset:20480
  ds_read_b64_tr_b16 v[44:45], v13 offset:4096
  ds_read_b64_tr_b16 v[46:47], v13 offset:5120
  ds_read_b64_tr_b16 v[48:49], v14 offset:4096
  ds_read_b64_tr_b16 v[50:51], v14 offset:5120
  ds_read_b128 v[52:55], v16 offset:16384
  ds_read_b128 v[56:59], v16 offset:20480
  s_waitcnt lgkmcnt(6)
  v_mfma_f32_32x32x16_bf16 v[64:79], v[28:31], v[36:39], v[64:79]
  v_mfma_f32_32x32x16_bf16 v[80:95], v[28:31], v[40:43], v[80:95]
  v_mfma_f32_32x32x16_bf16 v[96:111], v[32:35], v[36:39], v[96:111]
  v_mfma_f32_32x32x16_bf16 v[112:127], v[32:35], v[40:43], v[112:127]
  ds_read_b64_tr_b16 v[28:29], v13 offset:8192
  ds_read_b64_tr_b16 v[30:31], v13 offset:9216
  ds_read_b64_tr_b16 v[32:33], v14 offset:8192
  ds_read_b64_tr_b16 v[34:35], v14 offset:9216
  ds_read_b128 v[36:39], v17 offset:16384
  ds_read_b128 v[40:43], v17 offset:20480
  s_waitcnt lgkmcnt(6)
  v_mfma_f32_32x32x16_bf16 v[64:79], v[44:47], v[52:55], v[64:79]
  v_mfma_f32_32x32x16_bf16 v[80:95], v[44:47], v[56:59], v[80:95]
  v_mfma_f32_32x32x16_bf16 v[96:111], v[48:51], v[52:55], v[96:111]
  v_mfma_f32_32x32x16_bf16 v[112:127], v[48:51], v[56:59], v[112:127]
  ds_read_b64_tr_b16 v[44:45], v13 offset:12288
  ds_read_b64_tr_b16 v[46:47], v13 offset:13312
  ds_read_b64_tr_b16 v[48:49], v14 offset:12288
  ds_read_b64_tr_b16 v[50:51], v14 offset:13312
  ds_read_b128 v[52:55], v18 offset:16384
  ds_read_b128 v[56:59], v18 offset:20480
  s_waitcnt lgkmcnt(6)
  v_mfma_f32_32x32x16_bf16 v[64:79], v[28:31], v[36:39], v[64:79]
  v_mfma_f32_32x32x16_bf16 v[80:95], v[28:31], v[40:43], v[80:95]
  v_mfma_f32_32x32x16_bf16 v[96:111], v[32:35], v[36:39], v[96:111]
  v_mfma_f32_32x32x16_bf16 v[112:127], v[32:35], v[40:43], v[112:127]
  s_waitcnt lgkmcnt(0)
  v_mfma_f32_32x32x16_bf16 v[64:79], v[44:47], v[52:55], v[64:79]
  v_mfma_f32_32x32x16_bf16 v[80:95], v[44:47], v[56:59], v[80:95]
  v_mfma_f32_32x32x16_bf16 v[96:111], v[48:51], v[52:55], v[96:111]
  v_mfma_f32_32x32x16_bf16 v[112:127], v[48:51], v[56:59], v[112:127]
  s_waitcnt vmcnt(0)
  s_barrier
  s_add_u32 m0, s26, 0
  s_add_u32 s28, s22, 0
  buffer_load_dwordx4 v10, s[8:11], s28 offen lds
  s_add_u32 m0, s26, 1024
  s_add_u32 s28, s22, 4096
  buffer_load_dwordx4 v10, s[8:11], s28 offen lds
  s_add_u32 m0, s26, 2048
  s_add_u32 s28, s22, 8192
  buffer_load_dwordx4 v10, s[8:11], s28 offen lds
  s_add_u32 m0, s26, 3072
  s_add_u32 s28, s22, 12288
  buffer_load_dwordx4 v10, s[8:11], s28 offen lds
  s_add_u32 m0, s27, 0
  s_add_u32 s28, s21, 0
  buffer_load_dwordx4 v11, s[4:7], s28 offen lds
  s_add_u32 m0, s27, 1024
  s_add_u32 s28, s21, 8192
  buffer_load_dwordx4 v12, s[4:7], s28 offen lds
  s_add_u32 m0, s27, 2048
  s_add_u32 s28, s21, 16384
  buffer_load_dwordx4 v11, s[4:7], s28 offen lds
  s_add_u32 m0, s27, 3072
  s_add_u32 s28, s21, 24576
  buffer_load_dwordx4 v12, s[4:7], s28 offen lds
  s_add_u32 s22, s22, 65536
  s_add_u32 s21, s21, 128
  ds_read_b64_tr_b16 v[28:29], v13 offset:32768
  ds_read_b64_tr_b16 v[30:31], v13 offset:33792
  ds_read_b64_tr_b16 v[32:33], v14 offset:32768
  ds_read_b64_tr_b16 v[34:35], v14 offset:33792
  ds_read_b128 v[36:39], v15 offset:49152
  ds_read_b128 v[40:43], v15 offset:53248
  ds_read_b64_tr_b16 v[44:45], v13 offset:36864
  ds_read_b64_tr_b16 v[46:47], v13 offset:37888
  ds_read_b64_tr_b16 v[48:49], v14 offset:36864
  ds_read_b64_tr_b16 v[50:51], v14 offset:37888
  ds_read_b128 v[52:55], v16 offset:49152
  ds_read_b128 v[56:59], v16 offset:53248
  s_waitcnt lgkmcnt(6)
  v_mfma_f32_32x32x16_bf16 v[64:79], v[28:31], v[36:39], v[64:79]
  v_mfma_f32_32x32x16_bf16 v[80:95], v[28:31], v[40:43], v[80:95]
  v_mfma_f32_32x32x16_bf16 v[96:111], v[32:35], v[36:39], v[96:111]
  v_mfma_f32_32x32x16_bf16 v[112:127], v[32:35], v[40:43], v[112:127]
  ds_read_b64_tr_b16 v[28:29], v13 offset:40960
  ds_read_b64_tr_b16 v[30:31], v13 offset:41984
  ds_read_b64_tr_b16 v[32:33], v14 offset:40960
  ds_read_b64_tr_b16 v[34:35], v14 offset:41984
  ds_read_b128 v[36:39], v17 offset:49152
  ds_read_b128 v[40:43], v17 offset:53248
  s_waitcnt lgkmcnt(6)
  v_mfma_f32_32x32x16_bf16 v[64:79], v[44:47], v[52:55], v[64:79]
  v_mfma_f32_32x32x16_bf16 v[80:95], v[44:47], v[56:59], v[80:95]
  v_mfma_f32_32x32x16_bf16 v[96:111], v[48:51], v[52:55], v[96:111]
  v_mfma_f32_32x32x16_bf16 v[112:127], v[48:51], v[56:59], v[112:127]
  ds_read_b64_tr_b16 v[44:45], v13 offset:45056
  ds_read_b64_tr_b16 v[46:47], v13 offset:46080
  ds_read_b64_tr_b16 v[48:49], v14 offset:45056
  ds_read_b64_tr_b16 v[50:51], v14 offset:46080
  ds_read_b128 v[52:55], v18 offset:49152
  ds_read_b128 v[56:59], v18 offset:53248
  s_waitcnt lgkmcnt(6)
  v_mfma_f32_32x32x16_bf16 v[64:79], v[28:31], v[36:39], v[64:79]
  v_mfma_f32_32x32x16_bf16 v[80:95], v[28:31], v[40:43], v[80:95]
  v_mfma_f32_32x32x16_bf16 v[96:111], v[32:35], v[36:39], v[96:111]
  v_mfma_f32_32x32x16_bf16 v[112:127], v[32:35], v[40:43], v[112:127]
  s_waitcnt lgkmcnt(0)
  v_mfma_f32_32x32x16_bf16 v[64:79], v[44:47], v[52:55], v[64:79]
  v_mfma_f32_32x32x16_bf16 v[80:95], v[44:47], v[56:59], v[80:95]
  v_mfma_f32_32x32x16_bf16 v[96:111], v[48:51], v[52:55], v[96:111]
  v_mfma_f32_32x32x16_bf16 v[112:127], v[48:51], v[56:59], v[112:127]
  s_waitcnt vmcnt(0)
  s_barrier
  s_add_u32 m0, s26, 32768
  s_add_u32 s28, s22, 0
  buffer_load_dwordx4 v10, s[8:11], s28 offen lds
  s_add_u32 m0, s26, 33792
  s_add_u32 s28, s22, 4096
  buffer_load_dwordx4 v10, s[8:11], s28 offen lds
  s_add_u32 m0, s26, 34816
  s_add_u32 s28, s22, 8192
  buffer_load_dwordx4 v10, s[8:11], s28 offen lds
  s_add_u32 m0, s26, 35840
  s_add_u32 s28, s22, 12288
  buffer_load_dwordx4 v10, s[8:11], s28 offen lds
  s_add_u32 m0, s27, 32768
  s_add_u32 s28, s21, 0
  buffer_load_dwordx4 v11, s[4:7], s28 offen lds
  s_add_u32 m0, s27, 33792
  s_add_u32 s28, s21, 8192
  buffer_load_dwordx4 v12, s[4:7], s28 offen lds
  s_add_u32 m0, s27, 34816
  s_add_u32 s28, s21, 16384
  buffer_load_dwordx4 v11, s[4:7], s28 offen lds
  s_add_u32 m0, s27, 35840
  s_add_u32 s28, s21, 24576
  buffer_load_dwordx4 v12, s[4:7], s28 offen lds
  s_add_u32 s22, s22, 65536
  s_add_u32 s21, s21, 128
  ds_read_b64_tr_b16 v[28:29], v13 offset:0
  ds_read_b64_tr_b16 v[30:31], v13 offset:1024
  ds_read_b64_tr_b16 v[32:33], v14 offset:0
  ds_read_b64_tr_b16 v[34:35], v14 offset:1024
  ds_read_b128 v[36:39], v15 offset:16384
  ds_read_b128 v[40:43], v15 offset:20480
  ds_read_b64_tr_b16 v[44:45], v13 offset:4096
  ds_read_b64_tr_b16 v[46:47], v13 offset:5120
  ds_read_b64_tr_b16 v[48:49], v14 offset:4096
  ds_read_b64_tr_b16 v[50:51], v14 offset:5120
  ds_read_b128 v[52:55], v16 offset:16384
  ds_read_b128 v[56:59], v16 offset:20480
  s_waitcnt lgkmcnt(6)
  v_mfma_f32_32x32x16_bf16 v[64:79], v[28:31], v[36:39], v[64:79]
  v_mfma_f32_32x32x16_bf16 v[80:95], v[28:31], v[40:43], v[80:95]
  v_mfma_f32_32x32x16_bf16 v[96:111], v[32:35], v[36:39], v[96:111]
  v_mfma_f32_32x32x16_bf16 v[112:127], v[32:35], v[40:43], v[112:127]
  ds_read_b64_tr_b16 v[28:29], v13 offset:8192
  ds_read_b64_tr_b16 v[30:31], v13 offset:9216
  ds_read_b64_tr_b16 v[32:33], v14 offset:8192
  ds_read_b64_tr_b16 v[34:35], v14 offset:9216
  ds_read_b128 v[36:39], v17 offset:16384
  ds_read_b128 v[40:43], v17 offset:20480
  s_waitcnt lgkmcnt(6)
  v_mfma_f32_32x32x16_bf16 v[64:79], v[44:47], v[52:55], v[64:79]
  v_mfma_f32_32x32x16_bf16 v[80:95], v[44:47], v[56:59], v[80:95]
  v_mfma_f32_32x32x16_bf16 v[96:111], v[48:51], v[52:55], v[96:111]
  v_mfma_f32_32x32x16_bf16 v[112:127], v[48:51], v[56:59], v[112:127]
  ds_read_b64_tr_b16 v[44:45], v13 offset:12288
  ds_read_b64_tr_b16 v[46:47], v13 offset:13312
  ds_read_b64_tr_b16 v[48:49], v14 offset:12288
  ds_read_b64_tr_b16 v[50:51], v14 offset:13312
  ds_read_b128 v[52:55], v18 offset:16384
  ds_read_b128 v[56:59], v18 offset:20480
  s_waitcnt lgkmcnt(6)
  v_mfma_f32_32x32x16_bf16 v[64:79], v[28:31], v[36:39], v[64:79]
  v_mfma_f32_32x32x16_bf16 v[80:95], v[28:31], v[40:43], v[80:95]
  v_mfma_f32_32x32x16_bf16 v[96:111], v[32:35], v[36:39], v[96:111]
  v_mfma_f32_32x32x16_bf16 v[112:127], v[32:35], v[40:43], v[112:127]
  s_waitcnt lgkmcnt(0)
  v_mfma_f32_32x32x16_bf16 v[64:79], v[44:47], v[52:55], v[64:79]
  v_mfma_f32_32x32x16_bf16 v[80:95], v[44:47], v[56:59], v[80:95]
  v_mfma_f32_32x32x16_bf16 v[96:111], v[48:51], v[52:55], v[96:111]
  v_mfma_f32_32x32x16_bf16 v[112:127], v[48:51], v[56:59], v[112:127]
  s_waitcnt vmcnt(0)
  s_barrier
  s_add_u32 m0, s26, 0
  s_add_u32 s28, s22, 0
  buffer_load_dwordx4 v10, s[8:11], s28 offen lds
  s_add_u32 m0, s26, 1024
  s_add_u32 s28, s22, 4096
  buffer_load_dwordx4 v10, s[8:11], s28 offen lds
  s_add_u32 m0, s26, 2048
  s_add_u32 s28, s22, 8192
  buffer_load_dwordx4 v10, s[8:11], s28 offen lds
  s_add_u32 m0, s26, 3072
  s_add_u32 s28, s22, 12288
  buffer_load_dwordx4 v10, s[8:11], s28 offen lds
  s_add_u32 m0, s27, 0
  s_add_u32 s28, s21, 0
  buffer_load_dwordx4 v11, s[4:7], s28 offen lds
  s_add_u32 m0, s27, 1024
  s_add_u32 s28, s21, 8192
  buffer_load_dwordx4 v12, s[4:7], s28 offen lds
  s_add_u32 m0, s27, 2048
  s_add_u32 s28, s21, 16384
  buffer_load_dwordx4 v11, s[4:7], s28 offen lds
  s_add_u32 m0, s27, 3072
  s_add_u32 s28, s21, 24576
  buffer_load_dwordx4 v12, s[4:7], s28 offen lds
  s_add_u32 s22, s22, 65536
  s_add_u32 s21, s21, 128
  ds_read_b64_tr_b16 v[28:29], v13 offset:32768
  ds_read_b64_tr_b16 v[30:31], v13 offset:33792
  ds_read_b64_tr_b16 v[32:33], v14 offset:32768
  ds_read_b64_tr_b16 v[34:35], v14 offset:33792
  ds_read_b128 v[36:39], v15 offset:49152
  ds_read_b128 v[40:43], v15 offset:53248
  ds_read_b64_tr_b16 v[44:45], v13 offset:36864
  ds_read_b64_tr_b16 v[46:47], v13 offset:37888
  ds_read_b64_tr_b16 v[48:49], v14 offset:36864
  ds_read_b64_tr_b16 v[50:51], v14 offset:37888
  ds_read_b128 v[52:55], v16 offset:49152
  ds_read_b128 v[56:59], v16 offset:53248
  s_waitcnt lgkmcnt(6)
  v_mfma_f32_32x32x16_bf16 v[64:79], v[28:31], v[36:39], v[64:79]
  v_mfma_f32_32x32x16_bf16 v[80:95], v[28:31], v[40:43], v[80:95]
  v_mfma_f32_32x32x16_bf16 v[96:111], v[32:35], v[36:39], v[96:111]
  v_mfma_f32_32x32x16_bf16 v[112:127], v[32:35], v[40:43], v[112:127]
  ds_read_b64_tr_b16 v[28:29], v13 offset:40960
  ds_read_b64_tr_b16 v[30:31], v13 offset:41984
  ds_read_b64_tr_b16 v[32:33], v14 offset:40960
  ds_read_b64_tr_b16 v[34:35], v14 offset:41984
  ds_read_b128 v[36:39], v17 offset:49152
  ds_read_b128 v[40:43], v17 offset:53248
  s_waitcnt lgkmcnt(6)
  v_mfma_f32_32x32x16_bf16 v[64:79], v[44:47], v[52:55], v[64:79]
  v_mfma_f32_32x32x16_bf16 v[80:95], v[44:47], v[56:59], v[80:95]
  v_mfma_f32_32x32x16_bf16 v[96:111], v[48:51], v[52:55], v[96:111]
  v_mfma_f32_32x32x16_bf16 v[112:127], v[48:51], v[56:59], v[112:127]
  ds_read_b64_tr_b16 v[44:45], v13 offset:45056
  ds_read_b64_tr_b16 v[46:47], v13 offset:46080
  ds_read_b64_tr_b16 v[48:49], v14 offset:45056
  ds_read_b64_tr_b16 v[50:51], v14 offset:46080
  ds_read_b128 v[52:55], v18 offset:49152
  ds_read_b128 v[56:59], v18 offset:53248
  s_waitcnt lgkmcnt(6)
  v_mfma_f32_32x32x16_bf16 v[64:79], v[28:31], v[36:39], v[64:79]
  v_mfma_f32_32x32x16_bf16 v[80:95], v[28:31], v[40:43], v[80:95]
  v_mfma_f32_32x32x16_bf16 v[96:111], v[32:35], v[36:39], v[96:111]
  v_mfma_f32_32x32x16_bf16 v[112:127], v[32:35], v[40:43], v[112:127]
  s_waitcnt lgkmcnt(0)
  v_mfma_f32_32x32x16_bf16 v[64:79], v[44:47], v[52:55], v[64:79]
  v_mfma_f32_32x32x16_bf16 v[80:95], v[44:47], v[56:59], v[80:95]
  v_mfma_f32_32x32x16_bf16 v[96:111], v[48:51], v[52:55], v[96:111]
  v_mfma_f32_32x32x16_bf16 v[112:127], v[48:51], v[56:59], v[112:127]
  s_waitcnt vmcnt(0)
  s_barrier
  s_add_u32 m0, s26, 32768
  s_add_u32 s28, s22, 0
  buffer_load_dwordx4 v10, s[8:11], s28 offen lds
  s_add_u32 m0, s26, 33792
  s_add_u32 s28, s22, 4096
  buffer_load_dwordx4 v10, s[8:11], s28 offen lds
  s_add_u32 m0, s26, 34816
  s_add_u32 s28, s22, 8192
  buffer_load_dwordx4 v10, s[8:11], s28 offen lds
  s_add_u32 m0, s26, 35840
  s_add_u32 s28, s22, 12288
  buffer_load_dwordx4 v10, s[8:11], s28 offen lds
  s_add_u32 m0, s27, 32768
  s_add_u32 s28, s21, 0
  buffer_load_dwordx4 v11, s[4:7], s28 offen lds
  s_add_u32 m0, s27, 33792
  s_add_u32 s28, s21, 8192
  buffer_load_dwordx4 v12, s[4:7], s28 offen lds
  s_add_u32 m0, s27, 34816
  s_add_u32 s28, s21, 16384
  buffer_load_dwordx4 v11, s[4:7], s28 offen lds
  s_add_u32 m0, s27, 35840
  s_add_u32 s28, s21, 24576
  buffer_load_dwordx4 v12, s[4:7], s28 offen lds
  s_add_u32 s22, s22, 65536
  s_add_u32 s21, s21, 128
  ds_read_b64_tr_b16 v[28:29], v13 offset:0
  ds_read_b64_tr_b16 v[30:31], v13 offset:1024
  ds_read_b64_tr_b16 v[32:33], v14 offset:0
  ds_read_b64_tr_b16 v[34:35], v14 offset:1024
  ds_read_b128 v[36:39], v15 offset:16384
  ds_read_b128 v[40:43], v15 offset:20480
  ds_read_b64_tr_b16 v[44:45], v13 offset:4096
  ds_read_b64_tr_b16 v[46:47], v13 offset:5120
  ds_read_b64_tr_b16 v[48:49], v14 offset:4096
  ds_read_b64_tr_b16 v[50:51], v14 offset:5120
  ds_read_b128 v[52:55], v16 offset:16384
  ds_read_b128 v[56:59], v16 offset:20480
  s_waitcnt lgkmcnt(6)
  v_mfma_f32_32x32x16_bf16 v[64:79], v[28:31], v[36:39], v[64:79]
  v_mfma_f32_32x32x16_bf16 v[80:95], v[28:31], v[40:43], v[80:95]
  v_mfma_f32_32x32x16_bf16 v[96:111], v[32:35], v[36:39], v[96:111]
  v_mfma_f32_32x32x16_bf16 v[112:127], v[32:35], v[40:43], v[112:127]
  ds_read_b64_tr_b16 v[28:29], v13 offset:8192
  ds_read_b64_tr_b16 v[30:31], v13 offset:9216
  ds_read_b64_tr_b16 v[32:33], v14 offset:8192
  ds_read_b64_tr_b16 v[34:35], v14 offset:9216
  ds_read_b128 v[36:39], v17 offset:16384
  ds_read_b128 v[40:43], v17 offset:20480
  s_waitcnt lgkmcnt(6)
  v_mfma_f32_32x32x16_bf16 v[64:79], v[44:47], v[52:55], v[64:79]
  v_mfma_f32_32x32x16_bf16 v[80:95], v[44:47], v[56:59], v[80:95]
  v_mfma_f32_32x32x16_bf16 v[96:111], v[48:51], v[52:55], v[96:111]
  v_mfma_f32_32x32x16_bf16 v[112:127], v[48:51], v[56:59], v[112:127]
  ds_read_b64_tr_b16 v[44:45], v13 offset:12288
  ds_read_b64_tr_b16 v[46:47], v13 offset:13312
  ds_read_b64_tr_b16 v[48:49], v14 offset:12288
  ds_read_b64_tr_b16 v[50:51], v14 offset:13312
  ds_read_b128 v[52:55], v18 offset:16384
  ds_read_b128 v[56:59], v18 offset:20480
  s_waitcnt lgkmcnt(6)
  v_mfma_f32_32x32x16_bf16 v[64:79], v[28:31], v[36:39], v[64:79]
  v_mfma_f32_32x32x16_bf16 v[80:95], v[28:31], v[40:43], v[80:95]
  v_mfma_f32_32x32x16_bf16 v[96:111], v[32:35], v[36:39], v[96:111]
  v_mfma_f32_32x32x16_bf16 v[112:127], v[32:35], v[40:43], v[112:127]
  s_waitcnt lgkmcnt(0)
  v_mfma_f32_32x32x16_bf16 v[64:79], v[44:47], v[52:55], v[64:79]
  v_mfma_f32_32x32x16_bf16 v[80:95], v[44:47], v[56:59], v[80:95]
  v_mfma_f32_32x32x16_bf16 v[96:111], v[48:51], v[52:55], v[96:111]
  v_mfma_f32_32x32x16_bf16 v[112:127], v[48:51], v[56:59], v[112:127]
  s_waitcnt vmcnt(0)
  s_barrier
  ds_read_b64_tr_b16 v[28:29], v13 offset:32768
  ds_read_b64_tr_b16 v[30:31], v13 offset:33792
  ds_read_b64_tr_b16 v[32:33], v14 offset:32768
  ds_read_b64_tr_b16 v[34:35], v14 offset:33792
  ds_read_b128 v[36:39], v15 offset:49152
  ds_read_b128 v[40:43], v15 offset:53248
  ds_read_b64_tr_b16 v[44:45], v13 offset:36864
  ds_read_b64_tr_b16 v[46:47], v13 offset:37888
  ds_read_b64_tr_b16 v[48:49], v14 offset:36864
  ds_read_b64_tr_b16 v[50:51], v14 offset:37888
  ds_read_b128 v[52:55], v16 offset:49152
  ds_read_b128 v[56:59], v16 offset:53248
  s_waitcnt lgkmcnt(6)
  v_mfma_f32_32x32x16_bf16 v[64:79], v[28:31], v[36:39], v[64:79]
  v_mfma_f32_32x32x16_bf16 v[80:95], v[28:31], v[40:43], v[80:95]
  v_mfma_f32_32x32x16_bf16 v[96:111], v[32:35], v[36:39], v[96:111]
  v_mfma_f32_32x32x16_bf16 v[112:127], v[32:35], v[40:43], v[112:127]
  ds_read_b64_tr_b16 v[28:29], v13 offset:40960
  ds_read_b64_tr_b16 v[30:31], v13 offset:41984
  ds_read_b64_tr_b16 v[32:33], v14 offset:40960
  ds_read_b64_tr_b16 v[34:35], v14 offset:41984
  ds_read_b128 v[36:39], v17 offset:49152
  ds_read_b128 v[40:43], v17 offset:53248
  s_waitcnt lgkmcnt(6)
  v_mfma_f32_32x32x16_bf16 v[64:79], v[44:47], v[52:55], v[64:79]
  v_mfma_f32_32x32x16_bf16 v[80:95], v[44:47], v[56:59], v[80:95]
  v_mfma_f32_32x32x16_bf16 v[96:111], v[48:51], v[52:55], v[96:111]
  v_mfma_f32_32x32x16_bf16 v[112:127], v[48:51], v[56:59], v[112:127]
  ds_read_b64_tr_b16 v[44:45], v13 offset:45056
  ds_read_b64_tr_b16 v[46:47], v13 offset:46080
  ds_read_b64_tr_b16 v[48:49], v14 offset:45056
  ds_read_b64_tr_b16 v[50:51], v14 offset:46080
  ds_read_b128 v[52:55], v18 offset:49152
  ds_read_b128 v[56:59], v18 offset:53248
  s_waitcnt lgkmcnt(6)
  v_mfma_f32_32x32x16_bf16 v[64:79], v[28:31], v[36:39], v[64:79]
  v_mfma_f32_32x32x16_bf16 v[80:95], v[28:31], v[40:43], v[80:95]
  v_mfma_f32_32x32x16_bf16 v[96:111], v[32:35], v[36:39], v[96:111]
  v_mfma_f32_32x32x16_bf16 v[112:127], v[32:35], v[40:43], v[112:127]
  s_waitcnt lgkmcnt(0)
  v_mfma_f32_32x32x16_bf16 v[64:79], v[44:47], v[52:55], v[64:79]
  v_mfma_f32_32x32x16_bf16 v[80:95], v[44:47], v[56:59], v[80:95]
  v_mfma_f32_32x32x16_bf16 v[96:111], v[48:51], v[52:55], v[96:111]
  v_mfma_f32_32x32x16_bf16 v[112:127], v[48:51], v[56:59], v[112:127]
  s_nop 15
  s_nop 3
  v_cvt_pk_bf16_f32 v20, v64, v65
  v_cvt_pk_bf16_f32 v21, v66, v67
  v_cvt_pk_bf16_f32 v22, v68, v69
  v_cvt_pk_bf16_f32 v23, v70, v71
  s_nop 1
  v_permlane32_swap_b32 v20, v22
  v_permlane32_swap_b32 v21, v23
  buffer_store_dwordx4 v[20:23], v19, s[12:15], s23 offen offset:0
  v_cvt_pk_bf16_f32 v24, v72, v73
  v_cvt_pk_bf16_f32 v25, v74, v75
  v_cvt_pk_bf16_f32 v26, v76, v77
  v_cvt_pk_bf16_f32 v27, v78, v79
  s_nop 1
  v_permlane32_swap_b32 v24, v26
  v_permlane32_swap_b32 v25, v27
  buffer_store_dwordx4 v[24:27], v19, s[12:15], s23 offen offset:32
  v_cvt_pk_bf16_f32 v20, v96, v97
  v_cvt_pk_bf16_f32 v21, v98, v99
  v_cvt_pk_bf16_f32 v22, v100, v101
  v_cvt_pk_bf16_f32 v23, v102, v103
  s_nop 1
  v_permlane32_swap_b32 v20, v22
  v_permlane32_swap_b32 v21, v23
  buffer_store_dwordx4 v[20:23], v19, s[12:15], s23 offen offset:64
  v_cvt_pk_bf16_f32 v24, v104, v105
  v_cvt_pk_bf16_f32 v25, v106, v107
  v_cvt_pk_bf16_f32 v26, v108, v109
  v_cvt_pk_bf16_f32 v27, v110, v111
  s_nop 1
  v_permlane32_swap_b32 v24, v26
  v_permlane32_swap_b32 v25, v27
  buffer_store_dwordx4 v[24:27], v19, s[12:15], s23 offen offset:96
  v_cvt_pk_bf16_f32 v20, v80, v81
  v_cvt_pk_bf16_f32 v21, v82, v83
  v_cvt_pk_bf16_f32 v22, v84, v85
  v_cvt_pk_bf16_f32 v23, v86, v87
  s_nop 1
  v_permlane32_swap_b32 v20, v22
  v_permlane32_swap_b32 v21, v23
  buffer_store_dwordx4 v[20:23], v19, s[12:15], s24 offen offset:0
  v_cvt_pk_bf16_f32 v24, v88, v89
  v_cvt_pk_bf16_f32 v25, v90, v91
  v_cvt_pk_bf16_f32 v26, v92, v93
  v_cvt_pk_bf16_f32 v27, v94, v95
  s_nop 1
  v_permlane32_swap_b32 v24, v26
  v_permlane32_swap_b32 v25, v27
  buffer_store_dwordx4 v[24:27], v19, s[12:15], s24 offen offset:32
  v_cvt_pk_bf16_f32 v20, v112, v113
  v_cvt_pk_bf16_f32 v21, v114, v115
  v_cvt_pk_bf16_f32 v22, v116, v117
  v_cvt_pk_bf16_f32 v23, v118, v119
  s_nop 1
  v_permlane32_swap_b32 v20, v22
  v_permlane32_swap_b32 v21, v23
  buffer_store_dwordx4 v[20:23], v19, s[12:15], s24 offen offset:64
  v_cvt_pk_bf16_f32 v24, v120, v121
  v_cvt_pk_bf16_f32 v25, v122, v123
  v_cvt_pk_bf16_f32 v26, v124, v125
  v_cvt_pk_bf16_f32 v27, v126, v127
  s_nop 1
  v_permlane32_swap_b32 v24, v26
  v_permlane32_swap_b32 v25, v27
  buffer_store_dwordx4 v[24:27], v19, s[12:15], s24 offen offset:96
  s_waitcnt vmcnt(0)
  s_branch l0_kernel_end
l0_kernel_kv:
  s_mov_b32 s4, s40
  s_mov_b32 s5, s41
  s_mov_b32 s6, 0x200000
  s_mov_b32 s7, 0x20000
  s_mov_b32 s8, s44
  s_mov_b32 s9, s45
  s_mov_b32 s10, 0x4000
  s_mov_b32 s11, 0x20000
  s_mov_b32 s12, s46
  s_mov_b32 s13, s47
  s_mov_b32 s14, 0x4000
  s_mov_b32 s15, 0x20000
  s_mov_b32 s32, s48
  s_mov_b32 s33, s49
  s_mov_b32 s34, 0x400
  s_mov_b32 s35, 0x20000
  s_mov_b32 s36, s50
  s_mov_b32 s37, s51
  s_mov_b32 s38, 0x4600000
  s_mov_b32 s39, 0x20000
  v_and_b32 v1, 63, v0
  v_lshrrev_b32 v2, 6, v0
  s_nop 0
  v_readfirstlane_b32 s17, v2
  s_nop 3
  v_lshlrev_b32 v2, 5, v0
  v_lshlrev_b32 v3, 6, v0
  buffer_load_dwordx4 v[20:23], v2, s[8:11], 0 offen offset:0
  buffer_load_dwordx4 v[24:27], v2, s[8:11], 0 offen offset:16
  buffer_load_dwordx4 v[28:31], v2, s[12:15], 0 offen
  buffer_load_dwordx4 v[32:35], v2, s[12:15], 0 offen offset:16
  s_waitcnt vmcnt(0)
  ds_write_b128 v3, v[20:23] offset:0
  ds_write_b128 v3, v[24:27] offset:16
  ds_write_b128 v3, v[28:31] offset:32
  ds_write_b128 v3, v[32:35] offset:48
  s_nop 0
  v_add_u32 v4, 8192, v2
  buffer_load_dwordx4 v[20:23], v4, s[8:11], 0 offen
  buffer_load_dwordx4 v[24:27], v4, s[8:11], 0 offen offset:16
  buffer_load_dwordx4 v[28:31], v4, s[12:15], 0 offen
  buffer_load_dwordx4 v[32:35], v4, s[12:15], 0 offen offset:16
  s_waitcnt vmcnt(0)
  ds_write_b128 v3, v[20:23] offset:16384
  ds_write_b128 v3, v[24:27] offset:16400
  ds_write_b128 v3, v[28:31] offset:16416
  ds_write_b128 v3, v[32:35] offset:16432
  s_waitcnt lgkmcnt(0)
  s_barrier
  s_sub_u32 s18, s2, 64
  s_lshl_b32 s18, s18, 7
  s_lshl_b32 s19, s17, 5
  s_add_u32 s18, s18, s19
  v_and_b32 v2, 31, v1
  v_lshlrev_b32 v3, 10, v2
  v_lshrrev_b32 v4, 5, v1
  v_lshlrev_b32 v5, 4, v4
  v_add_u32 v10, v3, v5
  s_lshl_b32 s20, s18, 10
  v_bfe_u32 v6, v1, 4, 1
  v_bfe_u32 v7, v1, 2, 2
  v_and_b32 v8, 3, v1
  v_lshlrev_b32 v9, 3, v4
  v_add_u32 v9, v9, v7
  v_lshlrev_b32 v9, 6, v9
  v_lshlrev_b32 v6, 5, v6
  v_lshlrev_b32 v8, 3, v8
  v_add_u32 v9, v9, v6
  v_add_u32 v11, v9, v8
  v_lshlrev_b32 v12, 4, v4
  buffer_load_dwordx4 v[20:23], v10, s[4:7], s20 offen offset:0
  v_mov_b32 v52, 0
  v_mov_b32 v53, 0
  v_mov_b32 v54, 0
  v_mov_b32 v55, 0
  ds_read_b64_tr_b16 v[36:37], v11 offset:0
  ds_read_b64_tr_b16 v[38:39], v11 offset:256
  buffer_load_dwordx4 v[24:27], v10, s[4:7], s20 offen offset:32
  v_mov_b32 v56, 0
  v_mov_b32 v57, 0
  v_mov_b32 v58, 0
  v_mov_b32 v59, 0
  ds_read_b64_tr_b16 v[40:41], v11 offset:1024
  ds_read_b64_tr_b16 v[42:43], v11 offset:1280
  buffer_load_dwordx4 v[28:31], v10, s[4:7], s20 offen offset:64
  v_mov_b32 v60, 0
  v_mov_b32 v61, 0
  v_mov_b32 v62, 0
  v_mov_b32 v63, 0
  ds_read_b64_tr_b16 v[44:45], v11 offset:2048
  ds_read_b64_tr_b16 v[46:47], v11 offset:2304
  buffer_load_dwordx4 v[32:35], v10, s[4:7], s20 offen offset:96
  v_mov_b32 v64, 0
  v_mov_b32 v65, 0
  v_mov_b32 v66, 0
  v_mov_b32 v67, 0
  ds_read_b64_tr_b16 v[48:49], v11 offset:3072
  ds_read_b64_tr_b16 v[50:51], v11 offset:3328
  v_cmp_eq_u32 vcc, 0, v2
  s_and_saveexec_b64 s[22:23], vcc
  buffer_load_dwordx4 v[52:55], v12, s[32:35], 0 offen offset:0
  buffer_load_dwordx4 v[56:59], v12, s[32:35], 0 offen offset:32
  buffer_load_dwordx4 v[60:63], v12, s[32:35], 0 offen offset:64
  buffer_load_dwordx4 v[64:67], v12, s[32:35], 0 offen offset:96
  s_mov_b64 exec, s[22:23]
  s_waitcnt vmcnt(0) lgkmcnt(0)
  v_mfma_f32_32x32x16_bf16 v[96:111], v[36:39], v[20:23], 0
  v_mfma_f32_32x32x16_bf16 v[112:127], v[52:55], v[20:23], 0
  v_mfma_f32_32x32x16_bf16 v[96:111], v[40:43], v[24:27], v[96:111]
  v_mfma_f32_32x32x16_bf16 v[112:127], v[56:59], v[24:27], v[112:127]
  v_mfma_f32_32x32x16_bf16 v[96:111], v[44:47], v[28:31], v[96:111]
  v_mfma_f32_32x32x16_bf16 v[112:127], v[60:63], v[28:31], v[112:127]
  v_mfma_f32_32x32x16_bf16 v[96:111], v[48:51], v[32:35], v[96:111]
  v_mfma_f32_32x32x16_bf16 v[112:127], v[64:67], v[32:35], v[112:127]
  buffer_load_dwordx4 v[20:23], v10, s[4:7], s20 offen offset:128
  v_mov_b32 v52, 0
  v_mov_b32 v53, 0
  v_mov_b32 v54, 0
  v_mov_b32 v55, 0
  ds_read_b64_tr_b16 v[36:37], v11 offset:4096
  ds_read_b64_tr_b16 v[38:39], v11 offset:4352
  buffer_load_dwordx4 v[24:27], v10, s[4:7], s20 offen offset:160
  v_mov_b32 v56, 0
  v_mov_b32 v57, 0
  v_mov_b32 v58, 0
  v_mov_b32 v59, 0
  ds_read_b64_tr_b16 v[40:41], v11 offset:5120
  ds_read_b64_tr_b16 v[42:43], v11 offset:5376
  buffer_load_dwordx4 v[28:31], v10, s[4:7], s20 offen offset:192
  v_mov_b32 v60, 0
  v_mov_b32 v61, 0
  v_mov_b32 v62, 0
  v_mov_b32 v63, 0
  ds_read_b64_tr_b16 v[44:45], v11 offset:6144
  ds_read_b64_tr_b16 v[46:47], v11 offset:6400
  buffer_load_dwordx4 v[32:35], v10, s[4:7], s20 offen offset:224
  v_mov_b32 v64, 0
  v_mov_b32 v65, 0
  v_mov_b32 v66, 0
  v_mov_b32 v67, 0
  ds_read_b64_tr_b16 v[48:49], v11 offset:7168
  ds_read_b64_tr_b16 v[50:51], v11 offset:7424
  v_cmp_eq_u32 vcc, 0, v2
  s_and_saveexec_b64 s[22:23], vcc
  buffer_load_dwordx4 v[52:55], v12, s[32:35], 0 offen offset:128
  buffer_load_dwordx4 v[56:59], v12, s[32:35], 0 offen offset:160
  buffer_load_dwordx4 v[60:63], v12, s[32:35], 0 offen offset:192
  buffer_load_dwordx4 v[64:67], v12, s[32:35], 0 offen offset:224
  s_mov_b64 exec, s[22:23]
  s_waitcnt vmcnt(0) lgkmcnt(0)
  v_mfma_f32_32x32x16_bf16 v[96:111], v[36:39], v[20:23], v[96:111]
  v_mfma_f32_32x32x16_bf16 v[112:127], v[52:55], v[20:23], v[112:127]
  v_mfma_f32_32x32x16_bf16 v[96:111], v[40:43], v[24:27], v[96:111]
  v_mfma_f32_32x32x16_bf16 v[112:127], v[56:59], v[24:27], v[112:127]
  v_mfma_f32_32x32x16_bf16 v[96:111], v[44:47], v[28:31], v[96:111]
  v_mfma_f32_32x32x16_bf16 v[112:127], v[60:63], v[28:31], v[112:127]
  v_mfma_f32_32x32x16_bf16 v[96:111], v[48:51], v[32:35], v[96:111]
  v_mfma_f32_32x32x16_bf16 v[112:127], v[64:67], v[32:35], v[112:127]
  buffer_load_dwordx4 v[20:23], v10, s[4:7], s20 offen offset:256
  v_mov_b32 v52, 0
  v_mov_b32 v53, 0
  v_mov_b32 v54, 0
  v_mov_b32 v55, 0
  ds_read_b64_tr_b16 v[36:37], v11 offset:8192
  ds_read_b64_tr_b16 v[38:39], v11 offset:8448
  buffer_load_dwordx4 v[24:27], v10, s[4:7], s20 offen offset:288
  v_mov_b32 v56, 0
  v_mov_b32 v57, 0
  v_mov_b32 v58, 0
  v_mov_b32 v59, 0
  ds_read_b64_tr_b16 v[40:41], v11 offset:9216
  ds_read_b64_tr_b16 v[42:43], v11 offset:9472
  buffer_load_dwordx4 v[28:31], v10, s[4:7], s20 offen offset:320
  v_mov_b32 v60, 0
  v_mov_b32 v61, 0
  v_mov_b32 v62, 0
  v_mov_b32 v63, 0
  ds_read_b64_tr_b16 v[44:45], v11 offset:10240
  ds_read_b64_tr_b16 v[46:47], v11 offset:10496
  buffer_load_dwordx4 v[32:35], v10, s[4:7], s20 offen offset:352
  v_mov_b32 v64, 0
  v_mov_b32 v65, 0
  v_mov_b32 v66, 0
  v_mov_b32 v67, 0
  ds_read_b64_tr_b16 v[48:49], v11 offset:11264
  ds_read_b64_tr_b16 v[50:51], v11 offset:11520
  v_cmp_eq_u32 vcc, 0, v2
  s_and_saveexec_b64 s[22:23], vcc
  buffer_load_dwordx4 v[52:55], v12, s[32:35], 0 offen offset:256
  buffer_load_dwordx4 v[56:59], v12, s[32:35], 0 offen offset:288
  buffer_load_dwordx4 v[60:63], v12, s[32:35], 0 offen offset:320
  buffer_load_dwordx4 v[64:67], v12, s[32:35], 0 offen offset:352
  s_mov_b64 exec, s[22:23]
  s_waitcnt vmcnt(0) lgkmcnt(0)
  v_mfma_f32_32x32x16_bf16 v[96:111], v[36:39], v[20:23], v[96:111]
  v_mfma_f32_32x32x16_bf16 v[112:127], v[52:55], v[20:23], v[112:127]
  v_mfma_f32_32x32x16_bf16 v[96:111], v[40:43], v[24:27], v[96:111]
  v_mfma_f32_32x32x16_bf16 v[112:127], v[56:59], v[24:27], v[112:127]
  v_mfma_f32_32x32x16_bf16 v[96:111], v[44:47], v[28:31], v[96:111]
  v_mfma_f32_32x32x16_bf16 v[112:127], v[60:63], v[28:31], v[112:127]
  v_mfma_f32_32x32x16_bf16 v[96:111], v[48:51], v[32:35], v[96:111]
  v_mfma_f32_32x32x16_bf16 v[112:127], v[64:67], v[32:35], v[112:127]
  buffer_load_dwordx4 v[20:23], v10, s[4:7], s20 offen offset:384
  v_mov_b32 v52, 0
  v_mov_b32 v53, 0
  v_mov_b32 v54, 0
  v_mov_b32 v55, 0
  ds_read_b64_tr_b16 v[36:37], v11 offset:12288
  ds_read_b64_tr_b16 v[38:39], v11 offset:12544
  buffer_load_dwordx4 v[24:27], v10, s[4:7], s20 offen offset:416
  v_mov_b32 v56, 0
  v_mov_b32 v57, 0
  v_mov_b32 v58, 0
  v_mov_b32 v59, 0
  ds_read_b64_tr_b16 v[40:41], v11 offset:13312
  ds_read_b64_tr_b16 v[42:43], v11 offset:13568
  buffer_load_dwordx4 v[28:31], v10, s[4:7], s20 offen offset:448
  v_mov_b32 v60, 0
  v_mov_b32 v61, 0
  v_mov_b32 v62, 0
  v_mov_b32 v63, 0
  ds_read_b64_tr_b16 v[44:45], v11 offset:14336
  ds_read_b64_tr_b16 v[46:47], v11 offset:14592
  buffer_load_dwordx4 v[32:35], v10, s[4:7], s20 offen offset:480
  v_mov_b32 v64, 0
  v_mov_b32 v65, 0
  v_mov_b32 v66, 0
  v_mov_b32 v67, 0
  ds_read_b64_tr_b16 v[48:49], v11 offset:15360
  ds_read_b64_tr_b16 v[50:51], v11 offset:15616
  v_cmp_eq_u32 vcc, 0, v2
  s_and_saveexec_b64 s[22:23], vcc
  buffer_load_dwordx4 v[52:55], v12, s[32:35], 0 offen offset:384
  buffer_load_dwordx4 v[56:59], v12, s[32:35], 0 offen offset:416
  buffer_load_dwordx4 v[60:63], v12, s[32:35], 0 offen offset:448
  buffer_load_dwordx4 v[64:67], v12, s[32:35], 0 offen offset:480
  s_mov_b64 exec, s[22:23]
  s_waitcnt vmcnt(0) lgkmcnt(0)
  v_mfma_f32_32x32x16_bf16 v[96:111], v[36:39], v[20:23], v[96:111]
  v_mfma_f32_32x32x16_bf16 v[112:127], v[52:55], v[20:23], v[112:127]
  v_mfma_f32_32x32x16_bf16 v[96:111], v[40:43], v[24:27], v[96:111]
  v_mfma_f32_32x32x16_bf16 v[112:127], v[56:59], v[24:27], v[112:127]
  v_mfma_f32_32x32x16_bf16 v[96:111], v[44:47], v[28:31], v[96:111]
  v_mfma_f32_32x32x16_bf16 v[112:127], v[60:63], v[28:31], v[112:127]
  v_mfma_f32_32x32x16_bf16 v[96:111], v[48:51], v[32:35], v[96:111]
  v_mfma_f32_32x32x16_bf16 v[112:127], v[64:67], v[32:35], v[112:127]
  buffer_load_dwordx4 v[20:23], v10, s[4:7], s20 offen offset:512
  v_mov_b32 v52, 0
  v_mov_b32 v53, 0
  v_mov_b32 v54, 0
  v_mov_b32 v55, 0
  ds_read_b64_tr_b16 v[36:37], v11 offset:16384
  ds_read_b64_tr_b16 v[38:39], v11 offset:16640
  buffer_load_dwordx4 v[24:27], v10, s[4:7], s20 offen offset:544
  v_mov_b32 v56, 0
  v_mov_b32 v57, 0
  v_mov_b32 v58, 0
  v_mov_b32 v59, 0
  ds_read_b64_tr_b16 v[40:41], v11 offset:17408
  ds_read_b64_tr_b16 v[42:43], v11 offset:17664
  buffer_load_dwordx4 v[28:31], v10, s[4:7], s20 offen offset:576
  v_mov_b32 v60, 0
  v_mov_b32 v61, 0
  v_mov_b32 v62, 0
  v_mov_b32 v63, 0
  ds_read_b64_tr_b16 v[44:45], v11 offset:18432
  ds_read_b64_tr_b16 v[46:47], v11 offset:18688
  buffer_load_dwordx4 v[32:35], v10, s[4:7], s20 offen offset:608
  v_mov_b32 v64, 0
  v_mov_b32 v65, 0
  v_mov_b32 v66, 0
  v_mov_b32 v67, 0
  ds_read_b64_tr_b16 v[48:49], v11 offset:19456
  ds_read_b64_tr_b16 v[50:51], v11 offset:19712
  v_cmp_eq_u32 vcc, 0, v2
  s_and_saveexec_b64 s[22:23], vcc
  buffer_load_dwordx4 v[52:55], v12, s[32:35], 0 offen offset:512
  buffer_load_dwordx4 v[56:59], v12, s[32:35], 0 offen offset:544
  buffer_load_dwordx4 v[60:63], v12, s[32:35], 0 offen offset:576
  buffer_load_dwordx4 v[64:67], v12, s[32:35], 0 offen offset:608
  s_mov_b64 exec, s[22:23]
  s_waitcnt vmcnt(0) lgkmcnt(0)
  v_mfma_f32_32x32x16_bf16 v[96:111], v[36:39], v[20:23], v[96:111]
  v_mfma_f32_32x32x16_bf16 v[112:127], v[52:55], v[20:23], v[112:127]
  v_mfma_f32_32x32x16_bf16 v[96:111], v[40:43], v[24:27], v[96:111]
  v_mfma_f32_32x32x16_bf16 v[112:127], v[56:59], v[24:27], v[112:127]
  v_mfma_f32_32x32x16_bf16 v[96:111], v[44:47], v[28:31], v[96:111]
  v_mfma_f32_32x32x16_bf16 v[112:127], v[60:63], v[28:31], v[112:127]
  v_mfma_f32_32x32x16_bf16 v[96:111], v[48:51], v[32:35], v[96:111]
  v_mfma_f32_32x32x16_bf16 v[112:127], v[64:67], v[32:35], v[112:127]
  buffer_load_dwordx4 v[20:23], v10, s[4:7], s20 offen offset:640
  v_mov_b32 v52, 0
  v_mov_b32 v53, 0
  v_mov_b32 v54, 0
  v_mov_b32 v55, 0
  ds_read_b64_tr_b16 v[36:37], v11 offset:20480
  ds_read_b64_tr_b16 v[38:39], v11 offset:20736
  buffer_load_dwordx4 v[24:27], v10, s[4:7], s20 offen offset:672
  v_mov_b32 v56, 0
  v_mov_b32 v57, 0
  v_mov_b32 v58, 0
  v_mov_b32 v59, 0
  ds_read_b64_tr_b16 v[40:41], v11 offset:21504
  ds_read_b64_tr_b16 v[42:43], v11 offset:21760
  buffer_load_dwordx4 v[28:31], v10, s[4:7], s20 offen offset:704
  v_mov_b32 v60, 0
  v_mov_b32 v61, 0
  v_mov_b32 v62, 0
  v_mov_b32 v63, 0
  ds_read_b64_tr_b16 v[44:45], v11 offset:22528
  ds_read_b64_tr_b16 v[46:47], v11 offset:22784
  buffer_load_dwordx4 v[32:35], v10, s[4:7], s20 offen offset:736
  v_mov_b32 v64, 0
  v_mov_b32 v65, 0
  v_mov_b32 v66, 0
  v_mov_b32 v67, 0
  ds_read_b64_tr_b16 v[48:49], v11 offset:23552
  ds_read_b64_tr_b16 v[50:51], v11 offset:23808
  v_cmp_eq_u32 vcc, 0, v2
  s_and_saveexec_b64 s[22:23], vcc
  buffer_load_dwordx4 v[52:55], v12, s[32:35], 0 offen offset:640
  buffer_load_dwordx4 v[56:59], v12, s[32:35], 0 offen offset:672
  buffer_load_dwordx4 v[60:63], v12, s[32:35], 0 offen offset:704
  buffer_load_dwordx4 v[64:67], v12, s[32:35], 0 offen offset:736
  s_mov_b64 exec, s[22:23]
  s_waitcnt vmcnt(0) lgkmcnt(0)
  v_mfma_f32_32x32x16_bf16 v[96:111], v[36:39], v[20:23], v[96:111]
  v_mfma_f32_32x32x16_bf16 v[112:127], v[52:55], v[20:23], v[112:127]
  v_mfma_f32_32x32x16_bf16 v[96:111], v[40:43], v[24:27], v[96:111]
  v_mfma_f32_32x32x16_bf16 v[112:127], v[56:59], v[24:27], v[112:127]
  v_mfma_f32_32x32x16_bf16 v[96:111], v[44:47], v[28:31], v[96:111]
  v_mfma_f32_32x32x16_bf16 v[112:127], v[60:63], v[28:31], v[112:127]
  v_mfma_f32_32x32x16_bf16 v[96:111], v[48:51], v[32:35], v[96:111]
  v_mfma_f32_32x32x16_bf16 v[112:127], v[64:67], v[32:35], v[112:127]
  buffer_load_dwordx4 v[20:23], v10, s[4:7], s20 offen offset:768
  v_mov_b32 v52, 0
  v_mov_b32 v53, 0
  v_mov_b32 v54, 0
  v_mov_b32 v55, 0
  ds_read_b64_tr_b16 v[36:37], v11 offset:24576
  ds_read_b64_tr_b16 v[38:39], v11 offset:24832
  buffer_load_dwordx4 v[24:27], v10, s[4:7], s20 offen offset:800
  v_mov_b32 v56, 0
  v_mov_b32 v57, 0
  v_mov_b32 v58, 0
  v_mov_b32 v59, 0
  ds_read_b64_tr_b16 v[40:41], v11 offset:25600
  ds_read_b64_tr_b16 v[42:43], v11 offset:25856
  buffer_load_dwordx4 v[28:31], v10, s[4:7], s20 offen offset:832
  v_mov_b32 v60, 0
  v_mov_b32 v61, 0
  v_mov_b32 v62, 0
  v_mov_b32 v63, 0
  ds_read_b64_tr_b16 v[44:45], v11 offset:26624
  ds_read_b64_tr_b16 v[46:47], v11 offset:26880
  buffer_load_dwordx4 v[32:35], v10, s[4:7], s20 offen offset:864
  v_mov_b32 v64, 0
  v_mov_b32 v65, 0
  v_mov_b32 v66, 0
  v_mov_b32 v67, 0
  ds_read_b64_tr_b16 v[48:49], v11 offset:27648
  ds_read_b64_tr_b16 v[50:51], v11 offset:27904
  v_cmp_eq_u32 vcc, 0, v2
  s_and_saveexec_b64 s[22:23], vcc
  buffer_load_dwordx4 v[52:55], v12, s[32:35], 0 offen offset:768
  buffer_load_dwordx4 v[56:59], v12, s[32:35], 0 offen offset:800
  buffer_load_dwordx4 v[60:63], v12, s[32:35], 0 offen offset:832
  buffer_load_dwordx4 v[64:67], v12, s[32:35], 0 offen offset:864
  s_mov_b64 exec, s[22:23]
  s_waitcnt vmcnt(0) lgkmcnt(0)
  v_mfma_f32_32x32x16_bf16 v[96:111], v[36:39], v[20:23], v[96:111]
  v_mfma_f32_32x32x16_bf16 v[112:127], v[52:55], v[20:23], v[112:127]
  v_mfma_f32_32x32x16_bf16 v[96:111], v[40:43], v[24:27], v[96:111]
  v_mfma_f32_32x32x16_bf16 v[112:127], v[56:59], v[24:27], v[112:127]
  v_mfma_f32_32x32x16_bf16 v[96:111], v[44:47], v[28:31], v[96:111]
  v_mfma_f32_32x32x16_bf16 v[112:127], v[60:63], v[28:31], v[112:127]
  v_mfma_f32_32x32x16_bf16 v[96:111], v[48:51], v[32:35], v[96:111]
  v_mfma_f32_32x32x16_bf16 v[112:127], v[64:67], v[32:35], v[112:127]
  buffer_load_dwordx4 v[20:23], v10, s[4:7], s20 offen offset:896
  v_mov_b32 v52, 0
  v_mov_b32 v53, 0
  v_mov_b32 v54, 0
  v_mov_b32 v55, 0
  ds_read_b64_tr_b16 v[36:37], v11 offset:28672
  ds_read_b64_tr_b16 v[38:39], v11 offset:28928
  buffer_load_dwordx4 v[24:27], v10, s[4:7], s20 offen offset:928
  v_mov_b32 v56, 0
  v_mov_b32 v57, 0
  v_mov_b32 v58, 0
  v_mov_b32 v59, 0
  ds_read_b64_tr_b16 v[40:41], v11 offset:29696
  ds_read_b64_tr_b16 v[42:43], v11 offset:29952
  buffer_load_dwordx4 v[28:31], v10, s[4:7], s20 offen offset:960
  v_mov_b32 v60, 0
  v_mov_b32 v61, 0
  v_mov_b32 v62, 0
  v_mov_b32 v63, 0
  ds_read_b64_tr_b16 v[44:45], v11 offset:30720
  ds_read_b64_tr_b16 v[46:47], v11 offset:30976
  buffer_load_dwordx4 v[32:35], v10, s[4:7], s20 offen offset:992
  v_mov_b32 v64, 0
  v_mov_b32 v65, 0
  v_mov_b32 v66, 0
  v_mov_b32 v67, 0
  ds_read_b64_tr_b16 v[48:49], v11 offset:31744
  ds_read_b64_tr_b16 v[50:51], v11 offset:32000
  v_cmp_eq_u32 vcc, 0, v2
  s_and_saveexec_b64 s[22:23], vcc
  buffer_load_dwordx4 v[52:55], v12, s[32:35], 0 offen offset:896
  buffer_load_dwordx4 v[56:59], v12, s[32:35], 0 offen offset:928
  buffer_load_dwordx4 v[60:63], v12, s[32:35], 0 offen offset:960
  buffer_load_dwordx4 v[64:67], v12, s[32:35], 0 offen offset:992
  s_mov_b64 exec, s[22:23]
  s_waitcnt vmcnt(0) lgkmcnt(0)
  v_mfma_f32_32x32x16_bf16 v[96:111], v[36:39], v[20:23], v[96:111]
  v_mfma_f32_32x32x16_bf16 v[112:127], v[52:55], v[20:23], v[112:127]
  v_mfma_f32_32x32x16_bf16 v[96:111], v[40:43], v[24:27], v[96:111]
  v_mfma_f32_32x32x16_bf16 v[112:127], v[56:59], v[24:27], v[112:127]
  v_mfma_f32_32x32x16_bf16 v[96:111], v[44:47], v[28:31], v[96:111]
  v_mfma_f32_32x32x16_bf16 v[112:127], v[60:63], v[28:31], v[112:127]
  v_mfma_f32_32x32x16_bf16 v[96:111], v[48:51], v[32:35], v[96:111]
  v_mfma_f32_32x32x16_bf16 v[112:127], v[64:67], v[32:35], v[112:127]
  s_nop 15
  s_nop 3
  v_lshlrev_b32 v3, 5, v2
  v_lshlrev_b32 v5, 3, v4
  v_add_u32 v3, v3, v5
  s_lshl_b32 s21, s18, 5
  s_add_u32 s21, s21, 0x4200000
  v_cvt_pk_bf16_f32 v20, v96, v97
  v_cvt_pk_bf16_f32 v21, v98, v99
  buffer_store_dwordx2 v[20:21], v3, s[36:39], s21 offen offset:0
  s_nop 1
  v_cvt_pk_bf16_f32 v20, v100, v101
  v_cvt_pk_bf16_f32 v21, v102, v103
  buffer_store_dwordx2 v[20:21], v3, s[36:39], s21 offen offset:16
  s_nop 1
  v_bfe_u32 v20, v2, 4, 1
  v_lshlrev_b32 v20, 10, v20
  v_bfe_u32 v21, v2, 2, 1
  v_lshlrev_b32 v21, 9, v21
  v_add_u32 v20, v20, v21
  v_bfe_u32 v21, v2, 3, 1
  v_lshlrev_b32 v21, 2, v21
  v_and_b32 v22, 3, v2
  v_add_u32 v21, v21, v22
  v_lshlrev_b32 v21, 1, v21
  v_add_u32 v20, v20, v21
  v_lshlrev_b32 v21, 6, v4
  v_add_u32 v20, v20, v21
  s_lshr_b32 s21, s18, 5
  s_lshl_b32 s21, s21, 11
  s_add_u32 s21, s21, 0x4210000
  v_cvt_pk_bf16_f32 v22, v104, v104
  buffer_store_short v22, v20, s[36:39], s21 offen offset:0
  s_nop 0
  v_cvt_pk_bf16_f32 v22, v105, v105
  buffer_store_short v22, v20, s[36:39], s21 offen offset:16
  s_nop 0
  v_cvt_pk_bf16_f32 v22, v106, v106
  buffer_store_short v22, v20, s[36:39], s21 offen offset:32
  s_nop 0
  v_cvt_pk_bf16_f32 v22, v107, v107
  buffer_store_short v22, v20, s[36:39], s21 offen offset:48
  s_nop 0
  v_cvt_pk_bf16_f32 v22, v108, v108
  buffer_store_short v22, v20, s[36:39], s21 offen offset:128
  s_nop 0
  v_cvt_pk_bf16_f32 v22, v109, v109
  buffer_store_short v22, v20, s[36:39], s21 offen offset:144
  s_nop 0
  v_cvt_pk_bf16_f32 v22, v110, v110
  buffer_store_short v22, v20, s[36:39], s21 offen offset:160
  s_nop 0
  v_cvt_pk_bf16_f32 v22, v111, v111
  buffer_store_short v22, v20, s[36:39], s21 offen offset:176
  s_nop 0
  v_lshlrev_b32 v21, 6, v4
  v_sub_u32 v23, v20, v21
  v_lshlrev_b32 v21, 7, v4
  v_add_u32 v23, v23, v21
  v_mov_b32 v24, 0
  v_mov_b32 v25, 0x3f80
  v_cmp_eq_u32 vcc, 0, v4
  s_nop 1
  v_cndmask_b32 v25, v24, v25, vcc
  buffer_store_short v25, v23, s[36:39], s21 offen offset:256
  buffer_store_short v24, v23, s[36:39], s21 offen offset:272
  buffer_store_short v24, v23, s[36:39], s21 offen offset:288
  buffer_store_short v24, v23, s[36:39], s21 offen offset:304
  buffer_store_short v24, v23, s[36:39], s21 offen offset:320
  buffer_store_short v24, v23, s[36:39], s21 offen offset:336
  buffer_store_short v24, v23, s[36:39], s21 offen offset:352
  buffer_store_short v24, v23, s[36:39], s21 offen offset:368
  v_cvt_pk_bf16_f32 v26, 0, v112
  v_mul_f32 v26, 0xbfb8aa3b, v26
  v_exp_f32 v26, v26
  s_nop 0
  v_add_f32 v26, 1.0, v26
  v_rcp_f32 v26, v26
  s_nop 0
  v_cvt_pk_bf16_f32 v26, 0, v26
  v_lshlrev_b32 v27, 2, v2
  s_lshl_b32 s21, s18, 2
  s_add_u32 s21, s21, 0x4500000
  v_cmp_eq_u32 vcc, 0, v4
  s_and_saveexec_b64 s[22:23], vcc
  buffer_store_dword v26, v27, s[36:39], s21 offen
  s_mov_b64 exec, s[22:23]
  s_waitcnt vmcnt(0)
l0_kernel_end:
  s_endpgm
.section .rodata,"a"
.p2align 6
.amdhsa_kernel l0_kernel
  .amdhsa_next_free_vgpr 128
  .amdhsa_next_free_sgpr 64
  .amdhsa_accum_offset 128
  .amdhsa_group_segment_fixed_size 0
  .amdhsa_kernarg_size 120
  .amdhsa_user_sgpr_count 2
  .amdhsa_user_sgpr_kernarg_segment_ptr 1
  .amdhsa_system_sgpr_workgroup_id_x 1
.end_amdhsa_kernel
.text
.globl l1_kernel
.p2align 8
.type l1_kernel,@function
l1_kernel:
  s_cmp_ge_u32 s2, 512
  s_cbranch_scc1 l1_kernel_end
  s_cmp_ge_u32 s2, 256
  s_cbranch_scc1 l1_kernel_brole
  s_cmp_ge_u32 s2, 256
  s_cbranch_scc1 l1_kernel_end
  s_mov_b32 s16, s2
  s_load_dwordx4 s[40:43], s[0:1], 0
  s_load_dwordx4 s[44:47], s[0:1], 16
  s_load_dwordx2 s[48:49], s[0:1], 32
  s_load_dwordx2 s[50:51], s[0:1], 112
  s_waitcnt lgkmcnt(0)
  s_and_b32 s52, s16, 7
  s_lshr_b32 s53, s16, 3
  v_and_b32 v1, 63, v0
  v_lshrrev_b32 v2, 6, v0
  s_nop 0
  v_readfirstlane_b32 s17, v2
  s_nop 3
  s_and_b32 s18, s17, 1
  s_lshr_b32 s19, s17, 1
  s_lshl_b32 s26, s17, 12
  s_add_u32 s27, s26, 16384
  v_lshrrev_b32 v2, 4, v1
  v_and_b32 v3, 15, v1
  v_lshlrev_b32 v4, 2, v2
  v_xor_b32 v3, v3, v4
  v_lshlrev_b32 v3, 4, v3
  s_mov_b32 s28, 8192
  v_mul_lo_u32 v4, v2, s28
  v_add_u32 v10, v3, v4
  v_lshrrev_b32 v5, 3, v1
  v_and_b32 v3, 7, v1
  v_xor_b32 v3, v3, v2
  v_lshlrev_b32 v3, 4, v3
  s_mov_b32 s28, 1024
  v_mul_lo_u32 v4, v5, s28
  v_add_u32 v11, v3, v4
  v_xor_b32 v12, 64, v11
  v_lshrrev_b32 v2, 5, v1
  v_bfe_u32 v3, v1, 4, 1
  v_bfe_u32 v4, v1, 2, 2
  v_and_b32 v5, 3, v1
  v_lshlrev_b32 v6, 3, v2
  v_add_u32 v6, v6, v4
  v_lshlrev_b32 v6, 8, v6
  v_lshrrev_b32 v7, 1, v5
  v_lshlrev_b32 v8, 1, v3
  v_add_u32 v7, v7, v8
  s_lshl_b32 s28, s18, 3
  v_add_u32 v7, s28, v7
  v_lshlrev_b32 v8, 2, v4
  v_and_b32 v5, 1, v5
  v_lshlrev_b32 v5, 3, v5
  v_add_u32 v6, v6, v5
  v_add_u32 v9, 0, v7
  v_xor_b32 v9, v9, v8
  v_lshlrev_b32 v9, 4, v9
  v_add_u32 v13, v6, v9
  v_add_u32 v9, 4, v7
  v_xor_b32 v9, v9, v8
  v_lshlrev_b32 v9, 4, v9
  v_add_u32 v14, v6, v9
  v_and_b32 v3, 31, v1
  s_lshl_b32 s28, s19, 6
  v_add_u32 v4, s28, v3
  v_lshlrev_b32 v4, 7, v4
  v_bfe_u32 v5, v1, 1, 3
  v_add_u32 v6, 0, v2
  v_xor_b32 v6, v6, v5
  v_lshlrev_b32 v6, 4, v6
  v_add_u32 v15, v4, v6
  v_add_u32 v6, 2, v2
  v_xor_b32 v6, v6, v5
  v_lshlrev_b32 v6, 4, v6
  v_add_u32 v16, v4, v6
  v_add_u32 v6, 4, v2
  v_xor_b32 v6, v6, v5
  v_lshlrev_b32 v6, 4, v6
  v_add_u32 v17, v4, v6
  v_add_u32 v6, 6, v2
  v_xor_b32 v6, v6, v5
  v_lshlrev_b32 v6, 4, v6
  v_add_u32 v18, v4, v6
  s_mov_b32 s28, 256
  v_mul_lo_u32 v4, v3, s28
  v_lshlrev_b32 v5, 4, v2
  v_add_u32 v19, v4, v5
  s_mov_b32 s6, 0x200000
  s_mov_b32 s7, 0x20000
  s_mov_b32 s10, 0x400000
  s_mov_b32 s11, 0x20000
  s_mov_b32 s12, s50
  s_mov_b32 s13, s51
  s_mov_b32 s14, 0x3000000
  s_mov_b32 s15, 0x20000
  s_mov_b32 s20, 0
  s_mov_b32 s29, 0
  s_lshl_b32 s30, s29, 5
  s_add_u32 s30, s30, s53
  s_and_b32 s31, s30, 15
  s_lshr_b32 s30, s30, 4
  s_lshl_b32 s30, s30, 3
  s_add_u32 s30, s30, s52
  s_lshr_b32 s33, s30, 5
  s_and_b32 s32, s30, 31
  s_cmp_eq_u32 s33, 0
  s_cselect_b32 s4, s40, s42
  s_cselect_b32 s5, s41, s43
  s_cmp_eq_u32 s33, 1
  s_cselect_b32 s8, s46, s44
  s_cselect_b32 s9, s47, s45
  s_cmp_eq_u32 s33, 2
  s_cselect_b32 s8, s48, s8
  s_cselect_b32 s9, s49, s9
  s_lshl_b32 s28, s31, 7
  s_lshl_b32 s21, s17, 5
  s_add_u32 s21, s21, s28
  s_lshl_b32 s21, s21, 10
  s_lshl_b32 s22, s17, 17
  s_lshl_b32 s28, s32, 8
  s_add_u32 s22, s22, s28
  s_add_u32 m0, s26, 0
  s_add_u32 s28, s22, 0
  buffer_load_dwordx4 v10, s[8:11], s28 offen lds
  s_add_u32 m0, s26, 1024
  s_add_u32 s28, s22, 32768
  buffer_load_dwordx4 v10, s[8:11], s28 offen lds
  s_add_u32 m0, s26, 2048
  s_add_u32 s28, s22, 65536
  buffer_load_dwordx4 v10, s[8:11], s28 offen lds
  s_add_u32 m0, s26, 3072
  s_add_u32 s28, s22, 98304
  buffer_load_dwordx4 v10, s[8:11], s28 offen lds
  s_add_u32 m0, s27, 0
  s_add_u32 s28, s21, 0
  buffer_load_dwordx4 v11, s[4:7], s28 offen lds
  s_add_u32 m0, s27, 1024
  s_add_u32 s28, s21, 8192
  buffer_load_dwordx4 v12, s[4:7], s28 offen lds
  s_add_u32 m0, s27, 2048
  s_add_u32 s28, s21, 16384
  buffer_load_dwordx4 v11, s[4:7], s28 offen lds
  s_add_u32 m0, s27, 3072
  s_add_u32 s28, s21, 24576
  buffer_load_dwordx4 v12, s[4:7], s28 offen lds
  s_add_u32 s22, s22, 524288
  s_add_u32 s21, s21, 128
l1_kernel_tile:
  s_lshl_b32 s23, s33, 24
  s_lshl_b32 s28, s32, 19
  s_add_u32 s23, s23, s28
  s_lshl_b32 s28, s31, 15
  s_add_u32 s23, s23, s28
  s_lshl_b32 s28, s19, 14
  s_add_u32 s23, s23, s28
  s_lshl_b32 s28, s18, 7
  s_add_u32 s23, s23, s28
  s_add_u32 s24, s23, 8192
  s_cmp_eq_u32 s33, 0
  s_cselect_b32 s25, 0x3e0293ee, 0x3f800000
  s_waitcnt vmcnt(0)
  s_barrier
  s_add_u32 m0, s26, 32768
  s_add_u32 s28, s22, 0
  buffer_load_dwordx4 v10, s[8:11], s28 offen lds
  s_add_u32 m0, s26, 33792
  s_add_u32 s28, s22, 32768
  buffer_load_dwordx4 v10, s[8:11], s28 offen lds
  s_add_u32 m0, s26, 34816
  s_add_u32 s28, s22, 65536
  buffer_load_dwordx4 v10, s[8:11], s28 offen lds
  s_add_u32 m0, s26, 35840
  s_add_u32 s28, s22, 98304
  buffer_load_dwordx4 v10, s[8:11], s28 offen lds
  s_add_u32 m0, s27, 32768
  s_add_u32 s28, s21, 0
  buffer_load_dwordx4 v11, s[4:7], s28 offen lds
  s_add_u32 m0, s27, 33792
  s_add_u32 s28, s21, 8192
  buffer_load_dwordx4 v12, s[4:7], s28 offen lds
  s_add_u32 m0, s27, 34816
  s_add_u32 s28, s21, 16384
  buffer_load_dwordx4 v11, s[4:7], s28 offen lds
  s_add_u32 m0, s27, 35840
  s_add_u32 s28, s21, 24576
  buffer_load_dwordx4 v12, s[4:7], s28 offen lds
  s_add_u32 s22, s22, 524288
  s_add_u32 s21, s21, 128
  ds_read_b64_tr_b16 v[28:29], v13 offset:0
  ds_read_b64_tr_b16 v[30:31], v13 offset:1024
  ds_read_b64_tr_b16 v[32:33], v14 offset:0
  ds_read_b64_tr_b16 v[34:35], v14 offset:1024
  ds_read_b128 v[36:39], v15 offset:16384
  ds_read_b128 v[40:43], v15 offset:20480
  ds_read_b64_tr_b16 v[44:45], v13 offset:4096
  ds_read_b64_tr_b16 v[46:47], v13 offset:5120
  ds_read_b64_tr_b16 v[48:49], v14 offset:4096
  ds_read_b64_tr_b16 v[50:51], v14 offset:5120
  ds_read_b128 v[52:55], v16 offset:16384
  ds_read_b128 v[56:59], v16 offset:20480
  s_waitcnt lgkmcnt(6)
  v_mfma_f32_32x32x16_bf16 v[64:79], v[28:31], v[36:39], 0
  v_mfma_f32_32x32x16_bf16 v[80:95], v[28:31], v[40:43], 0
  v_mfma_f32_32x32x16_bf16 v[96:111], v[32:35], v[36:39], 0
  v_mfma_f32_32x32x16_bf16 v[112:127], v[32:35], v[40:43], 0
  ds_read_b64_tr_b16 v[28:29], v13 offset:8192
  ds_read_b64_tr_b16 v[30:31], v13 offset:9216
  ds_read_b64_tr_b16 v[32:33], v14 offset:8192
  ds_read_b64_tr_b16 v[34:35], v14 offset:9216
  ds_read_b128 v[36:39], v17 offset:16384
  ds_read_b128 v[40:43], v17 offset:20480
  s_waitcnt lgkmcnt(6)
  v_mfma_f32_32x32x16_bf16 v[64:79], v[44:47], v[52:55], v[64:79]
  v_mfma_f32_32x32x16_bf16 v[80:95], v[44:47], v[56:59], v[80:95]
  v_mfma_f32_32x32x16_bf16 v[96:111], v[48:51], v[52:55], v[96:111]
  v_mfma_f32_32x32x16_bf16 v[112:127], v[48:51], v[56:59], v[112:127]
  ds_read_b64_tr_b16 v[44:45], v13 offset:12288
  ds_read_b64_tr_b16 v[46:47], v13 offset:13312
  ds_read_b64_tr_b16 v[48:49], v14 offset:12288
  ds_read_b64_tr_b16 v[50:51], v14 offset:13312
  ds_read_b128 v[52:55], v18 offset:16384
  ds_read_b128 v[56:59], v18 offset:20480
  s_waitcnt lgkmcnt(6)
  v_mfma_f32_32x32x16_bf16 v[64:79], v[28:31], v[36:39], v[64:79]
  v_mfma_f32_32x32x16_bf16 v[80:95], v[28:31], v[40:43], v[80:95]
  v_mfma_f32_32x32x16_bf16 v[96:111], v[32:35], v[36:39], v[96:111]
  v_mfma_f32_32x32x16_bf16 v[112:127], v[32:35], v[40:43], v[112:127]
  s_waitcnt lgkmcnt(0)
  v_mfma_f32_32x32x16_bf16 v[64:79], v[44:47], v[52:55], v[64:79]
  v_mfma_f32_32x32x16_bf16 v[80:95], v[44:47], v[56:59], v[80:95]
  v_mfma_f32_32x32x16_bf16 v[96:111], v[48:51], v[52:55], v[96:111]
  v_mfma_f32_32x32x16_bf16 v[112:127], v[48:51], v[56:59], v[112:127]
  s_waitcnt vmcnt(0)
  s_barrier
  s_add_u32 m0, s26, 0
  s_add_u32 s28, s22, 0
  buffer_load_dwordx4 v10, s[8:11], s28 offen lds
  s_add_u32 m0, s26, 1024
  s_add_u32 s28, s22, 32768
  buffer_load_dwordx4 v10, s[8:11], s28 offen lds
  s_add_u32 m0, s26, 2048
  s_add_u32 s28, s22, 65536
  buffer_load_dwordx4 v10, s[8:11], s28 offen lds
  s_add_u32 m0, s26, 3072
  s_add_u32 s28, s22, 98304
  buffer_load_dwordx4 v10, s[8:11], s28 offen lds
  s_add_u32 m0, s27, 0
  s_add_u32 s28, s21, 0
  buffer_load_dwordx4 v11, s[4:7], s28 offen lds
  s_add_u32 m0, s27, 1024
  s_add_u32 s28, s21, 8192
  buffer_load_dwordx4 v12, s[4:7], s28 offen lds
  s_add_u32 m0, s27, 2048
  s_add_u32 s28, s21, 16384
  buffer_load_dwordx4 v11, s[4:7], s28 offen lds
  s_add_u32 m0, s27, 3072
  s_add_u32 s28, s21, 24576
  buffer_load_dwordx4 v12, s[4:7], s28 offen lds
  s_add_u32 s22, s22, 524288
  s_add_u32 s21, s21, 128
  ds_read_b64_tr_b16 v[28:29], v13 offset:32768
  ds_read_b64_tr_b16 v[30:31], v13 offset:33792
  ds_read_b64_tr_b16 v[32:33], v14 offset:32768
  ds_read_b64_tr_b16 v[34:35], v14 offset:33792
  ds_read_b128 v[36:39], v15 offset:49152
  ds_read_b128 v[40:43], v15 offset:53248
  ds_read_b64_tr_b16 v[44:45], v13 offset:36864
  ds_read_b64_tr_b16 v[46:47], v13 offset:37888
  ds_read_b64_tr_b16 v[48:49], v14 offset:36864
  ds_read_b64_tr_b16 v[50:51], v14 offset:37888
  ds_read_b128 v[52:55], v16 offset:49152
  ds_read_b128 v[56:59], v16 offset:53248
  s_waitcnt lgkmcnt(6)
  v_mfma_f32_32x32x16_bf16 v[64:79], v[28:31], v[36:39], v[64:79]
  v_mfma_f32_32x32x16_bf16 v[80:95], v[28:31], v[40:43], v[80:95]
  v_mfma_f32_32x32x16_bf16 v[96:111], v[32:35], v[36:39], v[96:111]
  v_mfma_f32_32x32x16_bf16 v[112:127], v[32:35], v[40:43], v[112:127]
  ds_read_b64_tr_b16 v[28:29], v13 offset:40960
  ds_read_b64_tr_b16 v[30:31], v13 offset:41984
  ds_read_b64_tr_b16 v[32:33], v14 offset:40960
  ds_read_b64_tr_b16 v[34:35], v14 offset:41984
  ds_read_b128 v[36:39], v17 offset:49152
  ds_read_b128 v[40:43], v17 offset:53248
  s_waitcnt lgkmcnt(6)
  v_mfma_f32_32x32x16_bf16 v[64:79], v[44:47], v[52:55], v[64:79]
  v_mfma_f32_32x32x16_bf16 v[80:95], v[44:47], v[56:59], v[80:95]
  v_mfma_f32_32x32x16_bf16 v[96:111], v[48:51], v[52:55], v[96:111]
  v_mfma_f32_32x32x16_bf16 v[112:127], v[48:51], v[56:59], v[112:127]
  ds_read_b64_tr_b16 v[44:45], v13 offset:45056
  ds_read_b64_tr_b16 v[46:47], v13 offset:46080
  ds_read_b64_tr_b16 v[48:49], v14 offset:45056
  ds_read_b64_tr_b16 v[50:51], v14 offset:46080
  ds_read_b128 v[52:55], v18 offset:49152
  ds_read_b128 v[56:59], v18 offset:53248
  s_waitcnt lgkmcnt(6)
  v_mfma_f32_32x32x16_bf16 v[64:79], v[28:31], v[36:39], v[64:79]
  v_mfma_f32_32x32x16_bf16 v[80:95], v[28:31], v[40:43], v[80:95]
  v_mfma_f32_32x32x16_bf16 v[96:111], v[32:35], v[36:39], v[96:111]
  v_mfma_f32_32x32x16_bf16 v[112:127], v[32:35], v[40:43], v[112:127]
  s_waitcnt lgkmcnt(0)
  v_mfma_f32_32x32x16_bf16 v[64:79], v[44:47], v[52:55], v[64:79]
  v_mfma_f32_32x32x16_bf16 v[80:95], v[44:47], v[56:59], v[80:95]
  v_mfma_f32_32x32x16_bf16 v[96:111], v[48:51], v[52:55], v[96:111]
  v_mfma_f32_32x32x16_bf16 v[112:127], v[48:51], v[56:59], v[112:127]
  s_waitcnt vmcnt(0)
  s_barrier
  s_add_u32 m0, s26, 32768
  s_add_u32 s28, s22, 0
  buffer_load_dwordx4 v10, s[8:11], s28 offen lds
  s_add_u32 m0, s26, 33792
  s_add_u32 s28, s22, 32768
  buffer_load_dwordx4 v10, s[8:11], s28 offen lds
  s_add_u32 m0, s26, 34816
  s_add_u32 s28, s22, 65536
  buffer_load_dwordx4 v10, s[8:11], s28 offen lds
  s_add_u32 m0, s26, 35840
  s_add_u32 s28, s22, 98304
  buffer_load_dwordx4 v10, s[8:11], s28 offen lds
  s_add_u32 m0, s27, 32768
  s_add_u32 s28, s21, 0
  buffer_load_dwordx4 v11, s[4:7], s28 offen lds
  s_add_u32 m0, s27, 33792
  s_add_u32 s28, s21, 8192
  buffer_load_dwordx4 v12, s[4:7], s28 offen lds
  s_add_u32 m0, s27, 34816
  s_add_u32 s28, s21, 16384
  buffer_load_dwordx4 v11, s[4:7], s28 offen lds
  s_add_u32 m0, s27, 35840
  s_add_u32 s28, s21, 24576
  buffer_load_dwordx4 v12, s[4:7], s28 offen lds
  s_add_u32 s22, s22, 524288
  s_add_u32 s21, s21, 128
  ds_read_b64_tr_b16 v[28:29], v13 offset:0
  ds_read_b64_tr_b16 v[30:31], v13 offset:1024
  ds_read_b64_tr_b16 v[32:33], v14 offset:0
  ds_read_b64_tr_b16 v[34:35], v14 offset:1024
  ds_read_b128 v[36:39], v15 offset:16384
  ds_read_b128 v[40:43], v15 offset:20480
  ds_read_b64_tr_b16 v[44:45], v13 offset:4096
  ds_read_b64_tr_b16 v[46:47], v13 offset:5120
  ds_read_b64_tr_b16 v[48:49], v14 offset:4096
  ds_read_b64_tr_b16 v[50:51], v14 offset:5120
  ds_read_b128 v[52:55], v16 offset:16384
  ds_read_b128 v[56:59], v16 offset:20480
  s_waitcnt lgkmcnt(6)
  v_mfma_f32_32x32x16_bf16 v[64:79], v[28:31], v[36:39], v[64:79]
  v_mfma_f32_32x32x16_bf16 v[80:95], v[28:31], v[40:43], v[80:95]
  v_mfma_f32_32x32x16_bf16 v[96:111], v[32:35], v[36:39], v[96:111]
  v_mfma_f32_32x32x16_bf16 v[112:127], v[32:35], v[40:43], v[112:127]
  ds_read_b64_tr_b16 v[28:29], v13 offset:8192
  ds_read_b64_tr_b16 v[30:31], v13 offset:9216
  ds_read_b64_tr_b16 v[32:33], v14 offset:8192
  ds_read_b64_tr_b16 v[34:35], v14 offset:9216
  ds_read_b128 v[36:39], v17 offset:16384
  ds_read_b128 v[40:43], v17 offset:20480
  s_waitcnt lgkmcnt(6)
  v_mfma_f32_32x32x16_bf16 v[64:79], v[44:47], v[52:55], v[64:79]
  v_mfma_f32_32x32x16_bf16 v[80:95], v[44:47], v[56:59], v[80:95]
  v_mfma_f32_32x32x16_bf16 v[96:111], v[48:51], v[52:55], v[96:111]
  v_mfma_f32_32x32x16_bf16 v[112:127], v[48:51], v[56:59], v[112:127]
  ds_read_b64_tr_b16 v[44:45], v13 offset:12288
  ds_read_b64_tr_b16 v[46:47], v13 offset:13312
  ds_read_b64_tr_b16 v[48:49], v14 offset:12288
  ds_read_b64_tr_b16 v[50:51], v14 offset:13312
  ds_read_b128 v[52:55], v18 offset:16384
  ds_read_b128 v[56:59], v18 offset:20480
  s_waitcnt lgkmcnt(6)
  v_mfma_f32_32x32x16_bf16 v[64:79], v[28:31], v[36:39], v[64:79]
  v_mfma_f32_32x32x16_bf16 v[80:95], v[28:31], v[40:43], v[80:95]
  v_mfma_f32_32x32x16_bf16 v[96:111], v[32:35], v[36:39], v[96:111]
  v_mfma_f32_32x32x16_bf16 v[112:127], v[32:35], v[40:43], v[112:127]
  s_waitcnt lgkmcnt(0)
  v_mfma_f32_32x32x16_bf16 v[64:79], v[44:47], v[52:55], v[64:79]
  v_mfma_f32_32x32x16_bf16 v[80:95], v[44:47], v[56:59], v[80:95]
  v_mfma_f32_32x32x16_bf16 v[96:111], v[48:51], v[52:55], v[96:111]
  v_mfma_f32_32x32x16_bf16 v[112:127], v[48:51], v[56:59], v[112:127]
  s_waitcnt vmcnt(0)
  s_barrier
  s_add_u32 m0, s26, 0
  s_add_u32 s28, s22, 0
  buffer_load_dwordx4 v10, s[8:11], s28 offen lds
  s_add_u32 m0, s26, 1024
  s_add_u32 s28, s22, 32768
  buffer_load_dwordx4 v10, s[8:11], s28 offen lds
  s_add_u32 m0, s26, 2048
  s_add_u32 s28, s22, 65536
  buffer_load_dwordx4 v10, s[8:11], s28 offen lds
  s_add_u32 m0, s26, 3072
  s_add_u32 s28, s22, 98304
  buffer_load_dwordx4 v10, s[8:11], s28 offen lds
  s_add_u32 m0, s27, 0
  s_add_u32 s28, s21, 0
  buffer_load_dwordx4 v11, s[4:7], s28 offen lds
  s_add_u32 m0, s27, 1024
  s_add_u32 s28, s21, 8192
  buffer_load_dwordx4 v12, s[4:7], s28 offen lds
  s_add_u32 m0, s27, 2048
  s_add_u32 s28, s21, 16384
  buffer_load_dwordx4 v11, s[4:7], s28 offen lds
  s_add_u32 m0, s27, 3072
  s_add_u32 s28, s21, 24576
  buffer_load_dwordx4 v12, s[4:7], s28 offen lds
  s_add_u32 s22, s22, 524288
  s_add_u32 s21, s21, 128
  ds_read_b64_tr_b16 v[28:29], v13 offset:32768
  ds_read_b64_tr_b16 v[30:31], v13 offset:33792
  ds_read_b64_tr_b16 v[32:33], v14 offset:32768
  ds_read_b64_tr_b16 v[34:35], v14 offset:33792
  ds_read_b128 v[36:39], v15 offset:49152
  ds_read_b128 v[40:43], v15 offset:53248
  ds_read_b64_tr_b16 v[44:45], v13 offset:36864
  ds_read_b64_tr_b16 v[46:47], v13 offset:37888
  ds_read_b64_tr_b16 v[48:49], v14 offset:36864
  ds_read_b64_tr_b16 v[50:51], v14 offset:37888
  ds_read_b128 v[52:55], v16 offset:49152
  ds_read_b128 v[56:59], v16 offset:53248
  s_waitcnt lgkmcnt(6)
  v_mfma_f32_32x32x16_bf16 v[64:79], v[28:31], v[36:39], v[64:79]
  v_mfma_f32_32x32x16_bf16 v[80:95], v[28:31], v[40:43], v[80:95]
  v_mfma_f32_32x32x16_bf16 v[96:111], v[32:35], v[36:39], v[96:111]
  v_mfma_f32_32x32x16_bf16 v[112:127], v[32:35], v[40:43], v[112:127]
  ds_read_b64_tr_b16 v[28:29], v13 offset:40960
  ds_read_b64_tr_b16 v[30:31], v13 offset:41984
  ds_read_b64_tr_b16 v[32:33], v14 offset:40960
  ds_read_b64_tr_b16 v[34:35], v14 offset:41984
  ds_read_b128 v[36:39], v17 offset:49152
  ds_read_b128 v[40:43], v17 offset:53248
  s_waitcnt lgkmcnt(6)
  v_mfma_f32_32x32x16_bf16 v[64:79], v[44:47], v[52:55], v[64:79]
  v_mfma_f32_32x32x16_bf16 v[80:95], v[44:47], v[56:59], v[80:95]
  v_mfma_f32_32x32x16_bf16 v[96:111], v[48:51], v[52:55], v[96:111]
  v_mfma_f32_32x32x16_bf16 v[112:127], v[48:51], v[56:59], v[112:127]
  ds_read_b64_tr_b16 v[44:45], v13 offset:45056
  ds_read_b64_tr_b16 v[46:47], v13 offset:46080
  ds_read_b64_tr_b16 v[48:49], v14 offset:45056
  ds_read_b64_tr_b16 v[50:51], v14 offset:46080
  ds_read_b128 v[52:55], v18 offset:49152
  ds_read_b128 v[56:59], v18 offset:53248
  s_waitcnt lgkmcnt(6)
  v_mfma_f32_32x32x16_bf16 v[64:79], v[28:31], v[36:39], v[64:79]
  v_mfma_f32_32x32x16_bf16 v[80:95], v[28:31], v[40:43], v[80:95]
  v_mfma_f32_32x32x16_bf16 v[96:111], v[32:35], v[36:39], v[96:111]
  v_mfma_f32_32x32x16_bf16 v[112:127], v[32:35], v[40:43], v[112:127]
  s_waitcnt lgkmcnt(0)
  v_mfma_f32_32x32x16_bf16 v[64:79], v[44:47], v[52:55], v[64:79]
  v_mfma_f32_32x32x16_bf16 v[80:95], v[44:47], v[56:59], v[80:95]
  v_mfma_f32_32x32x16_bf16 v[96:111], v[48:51], v[52:55], v[96:111]
  v_mfma_f32_32x32x16_bf16 v[112:127], v[48:51], v[56:59], v[112:127]
  s_waitcnt vmcnt(0)
  s_barrier
  s_add_u32 m0, s26, 32768
  s_add_u32 s28, s22, 0
  buffer_load_dwordx4 v10, s[8:11], s28 offen lds
  s_add_u32 m0, s26, 33792
  s_add_u32 s28, s22, 32768
  buffer_load_dwordx4 v10, s[8:11], s28 offen lds
  s_add_u32 m0, s26, 34816
  s_add_u32 s28, s22, 65536
  buffer_load_dwordx4 v10, s[8:11], s28 offen lds
  s_add_u32 m0, s26, 35840
  s_add_u32 s28, s22, 98304
  buffer_load_dwordx4 v10, s[8:11], s28 offen lds
  s_add_u32 m0, s27, 32768
  s_add_u32 s28, s21, 0
  buffer_load_dwordx4 v11, s[4:7], s28 offen lds
  s_add_u32 m0, s27, 33792
  s_add_u32 s28, s21, 8192
  buffer_load_dwordx4 v12, s[4:7], s28 offen lds
  s_add_u32 m0, s27, 34816
  s_add_u32 s28, s21, 16384
  buffer_load_dwordx4 v11, s[4:7], s28 offen lds
  s_add_u32 m0, s27, 35840
  s_add_u32 s28, s21, 24576
  buffer_load_dwordx4 v12, s[4:7], s28 offen lds
  s_add_u32 s22, s22, 524288
  s_add_u32 s21, s21, 128
  ds_read_b64_tr_b16 v[28:29], v13 offset:0
  ds_read_b64_tr_b16 v[30:31], v13 offset:1024
  ds_read_b64_tr_b16 v[32:33], v14 offset:0
  ds_read_b64_tr_b16 v[34:35], v14 offset:1024
  ds_read_b128 v[36:39], v15 offset:16384
  ds_read_b128 v[40:43], v15 offset:20480
  ds_read_b64_tr_b16 v[44:45], v13 offset:4096
  ds_read_b64_tr_b16 v[46:47], v13 offset:5120
  ds_read_b64_tr_b16 v[48:49], v14 offset:4096
  ds_read_b64_tr_b16 v[50:51], v14 offset:5120
  ds_read_b128 v[52:55], v16 offset:16384
  ds_read_b128 v[56:59], v16 offset:20480
  s_waitcnt lgkmcnt(6)
  v_mfma_f32_32x32x16_bf16 v[64:79], v[28:31], v[36:39], v[64:79]
  v_mfma_f32_32x32x16_bf16 v[80:95], v[28:31], v[40:43], v[80:95]
  v_mfma_f32_32x32x16_bf16 v[96:111], v[32:35], v[36:39], v[96:111]
  v_mfma_f32_32x32x16_bf16 v[112:127], v[32:35], v[40:43], v[112:127]
  ds_read_b64_tr_b16 v[28:29], v13 offset:8192
  ds_read_b64_tr_b16 v[30:31], v13 offset:9216
  ds_read_b64_tr_b16 v[32:33], v14 offset:8192
  ds_read_b64_tr_b16 v[34:35], v14 offset:9216
  ds_read_b128 v[36:39], v17 offset:16384
  ds_read_b128 v[40:43], v17 offset:20480
  s_waitcnt lgkmcnt(6)
  v_mfma_f32_32x32x16_bf16 v[64:79], v[44:47], v[52:55], v[64:79]
  v_mfma_f32_32x32x16_bf16 v[80:95], v[44:47], v[56:59], v[80:95]
  v_mfma_f32_32x32x16_bf16 v[96:111], v[48:51], v[52:55], v[96:111]
  v_mfma_f32_32x32x16_bf16 v[112:127], v[48:51], v[56:59], v[112:127]
  ds_read_b64_tr_b16 v[44:45], v13 offset:12288
  ds_read_b64_tr_b16 v[46:47], v13 offset:13312
  ds_read_b64_tr_b16 v[48:49], v14 offset:12288
  ds_read_b64_tr_b16 v[50:51], v14 offset:13312
  ds_read_b128 v[52:55], v18 offset:16384
  ds_read_b128 v[56:59], v18 offset:20480
  s_waitcnt lgkmcnt(6)
  v_mfma_f32_32x32x16_bf16 v[64:79], v[28:31], v[36:39], v[64:79]
  v_mfma_f32_32x32x16_bf16 v[80:95], v[28:31], v[40:43], v[80:95]
  v_mfma_f32_32x32x16_bf16 v[96:111], v[32:35], v[36:39], v[96:111]
  v_mfma_f32_32x32x16_bf16 v[112:127], v[32:35], v[40:43], v[112:127]
  s_waitcnt lgkmcnt(0)
  v_mfma_f32_32x32x16_bf16 v[64:79], v[44:47], v[52:55], v[64:79]
  v_mfma_f32_32x32x16_bf16 v[80:95], v[44:47], v[56:59], v[80:95]
  v_mfma_f32_32x32x16_bf16 v[96:111], v[48:51], v[52:55], v[96:111]
  v_mfma_f32_32x32x16_bf16 v[112:127], v[48:51], v[56:59], v[112:127]
  s_waitcnt vmcnt(0)
  s_barrier
  s_add_u32 m0, s26, 0
  s_add_u32 s28, s22, 0
  buffer_load_dwordx4 v10, s[8:11], s28 offen lds
  s_add_u32 m0, s26, 1024
  s_add_u32 s28, s22, 32768
  buffer_load_dwordx4 v10, s[8:11], s28 offen lds
  s_add_u32 m0, s26, 2048
  s_add_u32 s28, s22, 65536
  buffer_load_dwordx4 v10, s[8:11], s28 offen lds
  s_add_u32 m0, s26, 3072
  s_add_u32 s28, s22, 98304
  buffer_load_dwordx4 v10, s[8:11], s28 offen lds
  s_add_u32 m0, s27, 0
  s_add_u32 s28, s21, 0
  buffer_load_dwordx4 v11, s[4:7], s28 offen lds
  s_add_u32 m0, s27, 1024
  s_add_u32 s28, s21, 8192
  buffer_load_dwordx4 v12, s[4:7], s28 offen lds
  s_add_u32 m0, s27, 2048
  s_add_u32 s28, s21, 16384
  buffer_load_dwordx4 v11, s[4:7], s28 offen lds
  s_add_u32 m0, s27, 3072
  s_add_u32 s28, s21, 24576
  buffer_load_dwordx4 v12, s[4:7], s28 offen lds
  s_add_u32 s22, s22, 524288
  s_add_u32 s21, s21, 128
  ds_read_b64_tr_b16 v[28:29], v13 offset:32768
  ds_read_b64_tr_b16 v[30:31], v13 offset:33792
  ds_read_b64_tr_b16 v[32:33], v14 offset:32768
  ds_read_b64_tr_b16 v[34:35], v14 offset:33792
  ds_read_b128 v[36:39], v15 offset:49152
  ds_read_b128 v[40:43], v15 offset:53248
  ds_read_b64_tr_b16 v[44:45], v13 offset:36864
  ds_read_b64_tr_b16 v[46:47], v13 offset:37888
  ds_read_b64_tr_b16 v[48:49], v14 offset:36864
  ds_read_b64_tr_b16 v[50:51], v14 offset:37888
  ds_read_b128 v[52:55], v16 offset:49152
  ds_read_b128 v[56:59], v16 offset:53248
  s_waitcnt lgkmcnt(6)
  v_mfma_f32_32x32x16_bf16 v[64:79], v[28:31], v[36:39], v[64:79]
  v_mfma_f32_32x32x16_bf16 v[80:95], v[28:31], v[40:43], v[80:95]
  v_mfma_f32_32x32x16_bf16 v[96:111], v[32:35], v[36:39], v[96:111]
  v_mfma_f32_32x32x16_bf16 v[112:127], v[32:35], v[40:43], v[112:127]
  ds_read_b64_tr_b16 v[28:29], v13 offset:40960
  ds_read_b64_tr_b16 v[30:31], v13 offset:41984
  ds_read_b64_tr_b16 v[32:33], v14 offset:40960
  ds_read_b64_tr_b16 v[34:35], v14 offset:41984
  ds_read_b128 v[36:39], v17 offset:49152
  ds_read_b128 v[40:43], v17 offset:53248
  s_waitcnt lgkmcnt(6)
  v_mfma_f32_32x32x16_bf16 v[64:79], v[44:47], v[52:55], v[64:79]
  v_mfma_f32_32x32x16_bf16 v[80:95], v[44:47], v[56:59], v[80:95]
  v_mfma_f32_32x32x16_bf16 v[96:111], v[48:51], v[52:55], v[96:111]
  v_mfma_f32_32x32x16_bf16 v[112:127], v[48:51], v[56:59], v[112:127]
  ds_read_b64_tr_b16 v[44:45], v13 offset:45056
  ds_read_b64_tr_b16 v[46:47], v13 offset:46080
  ds_read_b64_tr_b16 v[48:49], v14 offset:45056
  ds_read_b64_tr_b16 v[50:51], v14 offset:46080
  ds_read_b128 v[52:55], v18 offset:49152
  ds_read_b128 v[56:59], v18 offset:53248
  s_waitcnt lgkmcnt(6)
  v_mfma_f32_32x32x16_bf16 v[64:79], v[28:31], v[36:39], v[64:79]
  v_mfma_f32_32x32x16_bf16 v[80:95], v[28:31], v[40:43], v[80:95]
  v_mfma_f32_32x32x16_bf16 v[96:111], v[32:35], v[36:39], v[96:111]
  v_mfma_f32_32x32x16_bf16 v[112:127], v[32:35], v[40:43], v[112:127]
  s_waitcnt lgkmcnt(0)
  v_mfma_f32_32x32x16_bf16 v[64:79], v[44:47], v[52:55], v[64:79]
  v_mfma_f32_32x32x16_bf16 v[80:95], v[44:47], v[56:59], v[80:95]
  v_mfma_f32_32x32x16_bf16 v[96:111], v[48:51], v[52:55], v[96:111]
  v_mfma_f32_32x32x16_bf16 v[112:127], v[48:51], v[56:59], v[112:127]
  s_waitcnt vmcnt(0)
  s_barrier
  s_add_u32 m0, s26, 32768
  s_add_u32 s28, s22, 0
  buffer_load_dwordx4 v10, s[8:11], s28 offen lds
  s_add_u32 m0, s26, 33792
  s_add_u32 s28, s22, 32768
  buffer_load_dwordx4 v10, s[8:11], s28 offen lds
  s_add_u32 m0, s26, 34816
  s_add_u32 s28, s22, 65536
  buffer_load_dwordx4 v10, s[8:11], s28 offen lds
  s_add_u32 m0, s26, 35840
  s_add_u32 s28, s22, 98304
  buffer_load_dwordx4 v10, s[8:11], s28 offen lds
  s_add_u32 m0, s27, 32768
  s_add_u32 s28, s21, 0
  buffer_load_dwordx4 v11, s[4:7], s28 offen lds
  s_add_u32 m0, s27, 33792
  s_add_u32 s28, s21, 8192
  buffer_load_dwordx4 v12, s[4:7], s28 offen lds
  s_add_u32 m0, s27, 34816
  s_add_u32 s28, s21, 16384
  buffer_load_dwordx4 v11, s[4:7], s28 offen lds
  s_add_u32 m0, s27, 35840
  s_add_u32 s28, s21, 24576
  buffer_load_dwordx4 v12, s[4:7], s28 offen lds
  s_add_u32 s22, s22, 524288
  s_add_u32 s21, s21, 128
  ds_read_b64_tr_b16 v[28:29], v13 offset:0
  ds_read_b64_tr_b16 v[30:31], v13 offset:1024
  ds_read_b64_tr_b16 v[32:33], v14 offset:0
  ds_read_b64_tr_b16 v[34:35], v14 offset:1024
  ds_read_b128 v[36:39], v15 offset:16384
  ds_read_b128 v[40:43], v15 offset:20480
  ds_read_b64_tr_b16 v[44:45], v13 offset:4096
  ds_read_b64_tr_b16 v[46:47], v13 offset:5120
  ds_read_b64_tr_b16 v[48:49], v14 offset:4096
  ds_read_b64_tr_b16 v[50:51], v14 offset:5120
  ds_read_b128 v[52:55], v16 offset:16384
  ds_read_b128 v[56:59], v16 offset:20480
  s_waitcnt lgkmcnt(6)
  v_mfma_f32_32x32x16_bf16 v[64:79], v[28:31], v[36:39], v[64:79]
  v_mfma_f32_32x32x16_bf16 v[80:95], v[28:31], v[40:43], v[80:95]
  v_mfma_f32_32x32x16_bf16 v[96:111], v[32:35], v[36:39], v[96:111]
  v_mfma_f32_32x32x16_bf16 v[112:127], v[32:35], v[40:43], v[112:127]
  ds_read_b64_tr_b16 v[28:29], v13 offset:8192
  ds_read_b64_tr_b16 v[30:31], v13 offset:9216
  ds_read_b64_tr_b16 v[32:33], v14 offset:8192
  ds_read_b64_tr_b16 v[34:35], v14 offset:9216
  ds_read_b128 v[36:39], v17 offset:16384
  ds_read_b128 v[40:43], v17 offset:20480
  s_waitcnt lgkmcnt(6)
  v_mfma_f32_32x32x16_bf16 v[64:79], v[44:47], v[52:55], v[64:79]
  v_mfma_f32_32x32x16_bf16 v[80:95], v[44:47], v[56:59], v[80:95]
  v_mfma_f32_32x32x16_bf16 v[96:111], v[48:51], v[52:55], v[96:111]
  v_mfma_f32_32x32x16_bf16 v[112:127], v[48:51], v[56:59], v[112:127]
  ds_read_b64_tr_b16 v[44:45], v13 offset:12288
  ds_read_b64_tr_b16 v[46:47], v13 offset:13312
  ds_read_b64_tr_b16 v[48:49], v14 offset:12288
  ds_read_b64_tr_b16 v[50:51], v14 offset:13312
  ds_read_b128 v[52:55], v18 offset:16384
  ds_read_b128 v[56:59], v18 offset:20480
  s_waitcnt lgkmcnt(6)
  v_mfma_f32_32x32x16_bf16 v[64:79], v[28:31], v[36:39], v[64:79]
  v_mfma_f32_32x32x16_bf16 v[80:95], v[28:31], v[40:43], v[80:95]
  v_mfma_f32_32x32x16_bf16 v[96:111], v[32:35], v[36:39], v[96:111]
  v_mfma_f32_32x32x16_bf16 v[112:127], v[32:35], v[40:43], v[112:127]
  s_waitcnt lgkmcnt(0)
  v_mfma_f32_32x32x16_bf16 v[64:79], v[44:47], v[52:55], v[64:79]
  v_mfma_f32_32x32x16_bf16 v[80:95], v[44:47], v[56:59], v[80:95]
  v_mfma_f32_32x32x16_bf16 v[96:111], v[48:51], v[52:55], v[96:111]
  v_mfma_f32_32x32x16_bf16 v[112:127], v[48:51], v[56:59], v[112:127]
  s_waitcnt vmcnt(0)
  s_barrier
  s_add_u32 s29, s20, 1
  s_cmp_lt_u32 s29, 6
  s_cselect_b32 s29, s29, s20
  s_lshl_b32 s30, s29, 5
  s_add_u32 s30, s30, s53
  s_and_b32 s31, s30, 15
  s_lshr_b32 s30, s30, 4
  s_lshl_b32 s30, s30, 3
  s_add_u32 s30, s30, s52
  s_lshr_b32 s33, s30, 5
  s_and_b32 s32, s30, 31
  s_cmp_eq_u32 s33, 0
  s_cselect_b32 s4, s40, s42
  s_cselect_b32 s5, s41, s43
  s_cmp_eq_u32 s33, 1
  s_cselect_b32 s8, s46, s44
  s_cselect_b32 s9, s47, s45
  s_cmp_eq_u32 s33, 2
  s_cselect_b32 s8, s48, s8
  s_cselect_b32 s9, s49, s9
  s_lshl_b32 s28, s31, 7
  s_lshl_b32 s21, s17, 5
  s_add_u32 s21, s21, s28
  s_lshl_b32 s21, s21, 10
  s_lshl_b32 s22, s17, 17
  s_lshl_b32 s28, s32, 8
  s_add_u32 s22, s22, s28
  s_add_u32 m0, s26, 0
  s_add_u32 s28, s22, 0
  buffer_load_dwordx4 v10, s[8:11], s28 offen lds
  s_add_u32 m0, s26, 1024
  s_add_u32 s28, s22, 32768
  buffer_load_dwordx4 v10, s[8:11], s28 offen lds
  s_add_u32 m0, s26, 2048
  s_add_u32 s28, s22, 65536
  buffer_load_dwordx4 v10, s[8:11], s28 offen lds
  s_add_u32 m0, s26, 3072
  s_add_u32 s28, s22, 98304
  buffer_load_dwordx4 v10, s[8:11], s28 offen lds
  s_add_u32 m0, s27, 0
  s_add_u32 s28, s21, 0
  buffer_load_dwordx4 v11, s[4:7], s28 offen lds
  s_add_u32 m0, s27, 1024
  s_add_u32 s28, s21, 8192
  buffer_load_dwordx4 v12, s[4:7], s28 offen lds
  s_add_u32 m0, s27, 2048
  s_add_u32 s28, s21, 16384
  buffer_load_dwordx4 v11, s[4:7], s28 offen lds
  s_add_u32 m0, s27, 3072
  s_add_u32 s28, s21, 24576
  buffer_load_dwordx4 v12, s[4:7], s28 offen lds
  s_add_u32 s22, s22, 524288
  s_add_u32 s21, s21, 128
  ds_read_b64_tr_b16 v[28:29], v13 offset:32768
  ds_read_b64_tr_b16 v[30:31], v13 offset:33792
  ds_read_b64_tr_b16 v[32:33], v14 offset:32768
  ds_read_b64_tr_b16 v[34:35], v14 offset:33792
  ds_read_b128 v[36:39], v15 offset:49152
  ds_read_b128 v[40:43], v15 offset:53248
  ds_read_b64_tr_b16 v[44:45], v13 offset:36864
  ds_read_b64_tr_b16 v[46:47], v13 offset:37888
  ds_read_b64_tr_b16 v[48:49], v14 offset:36864
  ds_read_b64_tr_b16 v[50:51], v14 offset:37888
  ds_read_b128 v[52:55], v16 offset:49152
  ds_read_b128 v[56:59], v16 offset:53248
  s_waitcnt lgkmcnt(6)
  v_mfma_f32_32x32x16_bf16 v[64:79], v[28:31], v[36:39], v[64:79]
  v_mfma_f32_32x32x16_bf16 v[80:95], v[28:31], v[40:43], v[80:95]
  v_mfma_f32_32x32x16_bf16 v[96:111], v[32:35], v[36:39], v[96:111]
  v_mfma_f32_32x32x16_bf16 v[112:127], v[32:35], v[40:43], v[112:127]
  ds_read_b64_tr_b16 v[28:29], v13 offset:40960
  ds_read_b64_tr_b16 v[30:31], v13 offset:41984
  ds_read_b64_tr_b16 v[32:33], v14 offset:40960
  ds_read_b64_tr_b16 v[34:35], v14 offset:41984
  ds_read_b128 v[36:39], v17 offset:49152
  ds_read_b128 v[40:43], v17 offset:53248
  s_waitcnt lgkmcnt(6)
  v_mfma_f32_32x32x16_bf16 v[64:79], v[44:47], v[52:55], v[64:79]
  v_mfma_f32_32x32x16_bf16 v[80:95], v[44:47], v[56:59], v[80:95]
  v_mfma_f32_32x32x16_bf16 v[96:111], v[48:51], v[52:55], v[96:111]
  v_mfma_f32_32x32x16_bf16 v[112:127], v[48:51], v[56:59], v[112:127]
  ds_read_b64_tr_b16 v[44:45], v13 offset:45056
  ds_read_b64_tr_b16 v[46:47], v13 offset:46080
  ds_read_b64_tr_b16 v[48:49], v14 offset:45056
  ds_read_b64_tr_b16 v[50:51], v14 offset:46080
  ds_read_b128 v[52:55], v18 offset:49152
  ds_read_b128 v[56:59], v18 offset:53248
  s_waitcnt lgkmcnt(6)
  v_mfma_f32_32x32x16_bf16 v[64:79], v[28:31], v[36:39], v[64:79]
  v_mfma_f32_32x32x16_bf16 v[80:95], v[28:31], v[40:43], v[80:95]
  v_mfma_f32_32x32x16_bf16 v[96:111], v[32:35], v[36:39], v[96:111]
  v_mfma_f32_32x32x16_bf16 v[112:127], v[32:35], v[40:43], v[112:127]
  s_waitcnt lgkmcnt(0)
  v_mfma_f32_32x32x16_bf16 v[64:79], v[44:47], v[52:55], v[64:79]
  v_mfma_f32_32x32x16_bf16 v[80:95], v[44:47], v[56:59], v[80:95]
  v_mfma_f32_32x32x16_bf16 v[96:111], v[48:51], v[52:55], v[96:111]
  v_mfma_f32_32x32x16_bf16 v[112:127], v[48:51], v[56:59], v[112:127]
  s_nop 15
  s_nop 3
  v_mul_f32 v64, s25, v64
  v_mul_f32 v65, s25, v65
  v_mul_f32 v66, s25, v66
  v_mul_f32 v67, s25, v67
  v_mul_f32 v68, s25, v68
  v_mul_f32 v69, s25, v69
  v_mul_f32 v70, s25, v70
  v_mul_f32 v71, s25, v71
  v_cvt_pk_bf16_f32 v20, v64, v65
  v_cvt_pk_bf16_f32 v21, v66, v67
  v_cvt_pk_bf16_f32 v22, v68, v69
  v_cvt_pk_bf16_f32 v23, v70, v71
  s_nop 1
  v_permlane32_swap_b32 v20, v22
  v_permlane32_swap_b32 v21, v23
  buffer_store_dwordx4 v[20:23], v19, s[12:15], s23 offen offset:0
  v_mul_f32 v72, s25, v72
  v_mul_f32 v73, s25, v73
  v_mul_f32 v74, s25, v74
  v_mul_f32 v75, s25, v75
  v_mul_f32 v76, s25, v76
  v_mul_f32 v77, s25, v77
  v_mul_f32 v78, s25, v78
  v_mul_f32 v79, s25, v79
  v_cvt_pk_bf16_f32 v24, v72, v73
  v_cvt_pk_bf16_f32 v25, v74, v75
  v_cvt_pk_bf16_f32 v26, v76, v77
  v_cvt_pk_bf16_f32 v27, v78, v79
  s_nop 1
  v_permlane32_swap_b32 v24, v26
  v_permlane32_swap_b32 v25, v27
  buffer_store_dwordx4 v[24:27], v19, s[12:15], s23 offen offset:32
  v_mul_f32 v96, s25, v96
  v_mul_f32 v97, s25, v97
  v_mul_f32 v98, s25, v98
  v_mul_f32 v99, s25, v99
  v_mul_f32 v100, s25, v100
  v_mul_f32 v101, s25, v101
  v_mul_f32 v102, s25, v102
  v_mul_f32 v103, s25, v103
  v_cvt_pk_bf16_f32 v20, v96, v97
  v_cvt_pk_bf16_f32 v21, v98, v99
  v_cvt_pk_bf16_f32 v22, v100, v101
  v_cvt_pk_bf16_f32 v23, v102, v103
  s_nop 1
  v_permlane32_swap_b32 v20, v22
  v_permlane32_swap_b32 v21, v23
  buffer_store_dwordx4 v[20:23], v19, s[12:15], s23 offen offset:64
  v_mul_f32 v104, s25, v104
  v_mul_f32 v105, s25, v105
  v_mul_f32 v106, s25, v106
  v_mul_f32 v107, s25, v107
  v_mul_f32 v108, s25, v108
  v_mul_f32 v109, s25, v109
  v_mul_f32 v110, s25, v110
  v_mul_f32 v111, s25, v111
  v_cvt_pk_bf16_f32 v24, v104, v105
  v_cvt_pk_bf16_f32 v25, v106, v107
  v_cvt_pk_bf16_f32 v26, v108, v109
  v_cvt_pk_bf16_f32 v27, v110, v111
  s_nop 1
  v_permlane32_swap_b32 v24, v26
  v_permlane32_swap_b32 v25, v27
  buffer_store_dwordx4 v[24:27], v19, s[12:15], s23 offen offset:96
  v_mul_f32 v80, s25, v80
  v_mul_f32 v81, s25, v81
  v_mul_f32 v82, s25, v82
  v_mul_f32 v83, s25, v83
  v_mul_f32 v84, s25, v84
  v_mul_f32 v85, s25, v85
  v_mul_f32 v86, s25, v86
  v_mul_f32 v87, s25, v87
  v_cvt_pk_bf16_f32 v20, v80, v81
  v_cvt_pk_bf16_f32 v21, v82, v83
  v_cvt_pk_bf16_f32 v22, v84, v85
  v_cvt_pk_bf16_f32 v23, v86, v87
  s_nop 1
  v_permlane32_swap_b32 v20, v22
  v_permlane32_swap_b32 v21, v23
  buffer_store_dwordx4 v[20:23], v19, s[12:15], s24 offen offset:0
  v_mul_f32 v88, s25, v88
  v_mul_f32 v89, s25, v89
  v_mul_f32 v90, s25, v90
  v_mul_f32 v91, s25, v91
  v_mul_f32 v92, s25, v92
  v_mul_f32 v93, s25, v93
  v_mul_f32 v94, s25, v94
  v_mul_f32 v95, s25, v95
  v_cvt_pk_bf16_f32 v24, v88, v89
  v_cvt_pk_bf16_f32 v25, v90, v91
  v_cvt_pk_bf16_f32 v26, v92, v93
  v_cvt_pk_bf16_f32 v27, v94, v95
  s_nop 1
  v_permlane32_swap_b32 v24, v26
  v_permlane32_swap_b32 v25, v27
  buffer_store_dwordx4 v[24:27], v19, s[12:15], s24 offen offset:32
  v_mul_f32 v112, s25, v112
  v_mul_f32 v113, s25, v113
  v_mul_f32 v114, s25, v114
  v_mul_f32 v115, s25, v115
  v_mul_f32 v116, s25, v116
  v_mul_f32 v117, s25, v117
  v_mul_f32 v118, s25, v118
  v_mul_f32 v119, s25, v119
  v_cvt_pk_bf16_f32 v20, v112, v113
  v_cvt_pk_bf16_f32 v21, v114, v115
  v_cvt_pk_bf16_f32 v22, v116, v117
  v_cvt_pk_bf16_f32 v23, v118, v119
  s_nop 1
  v_permlane32_swap_b32 v20, v22
  v_permlane32_swap_b32 v21, v23
  buffer_store_dwordx4 v[20:23], v19, s[12:15], s24 offen offset:64
  v_mul_f32 v120, s25, v120
  v_mul_f32 v121, s25, v121
  v_mul_f32 v122, s25, v122
  v_mul_f32 v123, s25, v123
  v_mul_f32 v124, s25, v124
  v_mul_f32 v125, s25, v125
  v_mul_f32 v126, s25, v126
  v_mul_f32 v127, s25, v127
  v_cvt_pk_bf16_f32 v24, v120, v121
  v_cvt_pk_bf16_f32 v25, v122, v123
  v_cvt_pk_bf16_f32 v26, v124, v125
  v_cvt_pk_bf16_f32 v27, v126, v127
  s_nop 1
  v_permlane32_swap_b32 v24, v26
  v_permlane32_swap_b32 v25, v27
  buffer_store_dwordx4 v[24:27], v19, s[12:15], s24 offen offset:96
  s_add_u32 s20, s20, 1
  s_cmp_lt_u32 s20, 6
  s_cbranch_scc1 l1_kernel_tile
  s_waitcnt vmcnt(0)
l1_kernel_end:
  s_endpgm
l1_kernel_brole:
  s_load_dwordx2 s[40:41], s[0:1], 112
  s_sub_u32 s30, s2, 256
  s_waitcnt lgkmcnt(0)
  s_mov_b32 s4, s40
  s_mov_b32 s5, s41
  s_mov_b32 s6, 0x4600000
  s_mov_b32 s7, 0x20000
  v_and_b32 v1, 63, v0
  v_lshrrev_b32 v2, 6, v0
  s_nop 0
  v_readfirstlane_b32 s16, v2
  s_nop 3
  s_lshl_b32 s14, s30, 2
  s_add_u32 s14, s14, s16
  s_lshl_b32 s14, s14, 6
  v_and_b32 v2, 31, v1
  v_lshlrev_b32 v2, 5, v2
  v_lshrrev_b32 v3, 5, v1
  v_lshlrev_b32 v3, 4, v3
  v_add_u32 v208, v2, v3
  v_lshlrev_b32 v209, 4, v1
  s_lshl_b32 s17, s14, 5
  s_add_u32 s17, s17, 0x4000000
  buffer_load_dwordx4 v[10:13], v208, s[4:7], s17 offen offset:0
  buffer_load_dwordx4 v[14:17], v208, s[4:7], s17 offen offset:1024
  s_mov_b32 s8, 0x4200000
  s_mov_b32 s9, 0x4210000
  s_mov_b32 s12, 0x3eb8aa3b
  s_mov_b32 s13, 0x3eb8aa3b
  buffer_load_dwordx4 v[18:21], v208, s[4:7], s8 offen offset:0
  buffer_load_dwordx4 v[22:25], v208, s[4:7], s8 offen offset:1024
  s_add_u32 s8, s8, 2048
  buffer_load_dwordx4 v[34:37], v209, s[4:7], s9 offen offset:0
  buffer_load_dwordx4 v[38:41], v209, s[4:7], s9 offen offset:1024
  buffer_load_dwordx4 v[42:45], v209, s[4:7], s9 offen offset:2048
  buffer_load_dwordx4 v[46:49], v209, s[4:7], s9 offen offset:3072
  s_add_u32 s9, s9, 4096
  v_mov_b32 v194, 0xff7fffff
  v_mov_b32 v195, 0xff7fffff
  v_mov_b32 v162, 0
  v_mov_b32 v163, 0
  v_mov_b32 v164, 0
  v_mov_b32 v165, 0
  v_mov_b32 v166, 0
  v_mov_b32 v167, 0
  v_mov_b32 v168, 0
  v_mov_b32 v169, 0
  v_mov_b32 v170, 0
  v_mov_b32 v171, 0
  v_mov_b32 v172, 0
  v_mov_b32 v173, 0
  v_mov_b32 v174, 0
  v_mov_b32 v175, 0
  v_mov_b32 v176, 0
  v_mov_b32 v177, 0
  v_mov_b32 v178, 0
  v_mov_b32 v179, 0
  v_mov_b32 v180, 0
  v_mov_b32 v181, 0
  v_mov_b32 v182, 0
  v_mov_b32 v183, 0
  v_mov_b32 v184, 0
  v_mov_b32 v185, 0
  v_mov_b32 v186, 0
  v_mov_b32 v187, 0
  v_mov_b32 v188, 0
  v_mov_b32 v189, 0
  v_mov_b32 v190, 0
  v_mov_b32 v191, 0
  v_mov_b32 v192, 0
  v_mov_b32 v193, 0
  v_mov_b32 v146, 0
  v_mov_b32 v147, 0
  v_mov_b32 v148, 0
  v_mov_b32 v149, 0
  v_mov_b32 v150, 0
  v_mov_b32 v151, 0
  v_mov_b32 v152, 0
  v_mov_b32 v153, 0
  v_mov_b32 v154, 0
  v_mov_b32 v155, 0
  v_mov_b32 v156, 0
  v_mov_b32 v157, 0
  v_mov_b32 v158, 0
  v_mov_b32 v159, 0
  v_mov_b32 v160, 0
  v_mov_b32 v161, 0
  v_mov_b32 v50, 0
  v_mov_b32 v51, 0
  v_mov_b32 v52, 0
  v_mov_b32 v53, 0
  v_mov_b32 v54, 0
  v_mov_b32 v55, 0
  v_mov_b32 v56, 0
  v_mov_b32 v57, 0
  v_mov_b32 v58, 0
  v_mov_b32 v59, 0
  v_mov_b32 v60, 0
  v_mov_b32 v61, 0
  v_mov_b32 v62, 0
  v_mov_b32 v63, 0
  v_mov_b32 v64, 0
  v_mov_b32 v65, 0
  s_waitcnt vmcnt(4)
  v_mfma_f32_32x32x16_bf16 v[66:81], v[18:21], v[10:13], 0
  v_mfma_f32_32x32x16_bf16 v[82:97], v[22:25], v[10:13], 0
  s_mov_b32 s10, 16
l1_kernel_bloop:
  v_cvt_pk_bf16_f32 v66, 0, v66
  v_cvt_pk_bf16_f32 v67, 0, v67
  buffer_load_dwordx4 v[26:29], v208, s[4:7], s8 offen offset:0
  buffer_load_dwordx4 v[30:33], v208, s[4:7], s8 offen offset:1024
  s_add_u32 s8, s8, 2048
  v_cvt_pk_bf16_f32 v68, 0, v68
  v_cvt_pk_bf16_f32 v69, 0, v69
  v_cvt_pk_bf16_f32 v70, 0, v70
  v_cvt_pk_bf16_f32 v71, 0, v71
  v_mfma_f32_32x32x16_bf16 v[98:113], v[18:21], v[14:17], 0
  v_cvt_pk_bf16_f32 v72, 0, v72
  v_cvt_pk_bf16_f32 v73, 0, v73
  v_cvt_pk_bf16_f32 v74, 0, v74
  v_cvt_pk_bf16_f32 v75, 0, v75
  v_cvt_pk_bf16_f32 v76, 0, v76
  v_cvt_pk_bf16_f32 v77, 0, v77
  v_cvt_pk_bf16_f32 v78, 0, v78
  v_cvt_pk_bf16_f32 v79, 0, v79
  v_cvt_pk_bf16_f32 v80, 0, v80
  v_cvt_pk_bf16_f32 v81, 0, v81
  v_cvt_pk_bf16_f32 v82, 0, v82
  v_cvt_pk_bf16_f32 v83, 0, v83
  v_cvt_pk_bf16_f32 v84, 0, v84
  v_mfma_f32_32x32x16_bf16 v[114:129], v[22:25], v[14:17], 0
  v_cvt_pk_bf16_f32 v85, 0, v85
  v_cvt_pk_bf16_f32 v86, 0, v86
  v_cvt_pk_bf16_f32 v87, 0, v87
  v_cvt_pk_bf16_f32 v88, 0, v88
  v_cvt_pk_bf16_f32 v89, 0, v89
  v_cvt_pk_bf16_f32 v90, 0, v90
  v_cvt_pk_bf16_f32 v91, 0, v91
  v_cvt_pk_bf16_f32 v92, 0, v92
  v_cvt_pk_bf16_f32 v93, 0, v93
  v_cvt_pk_bf16_f32 v94, 0, v94
  v_cvt_pk_bf16_f32 v95, 0, v95
  v_cvt_pk_bf16_f32 v96, 0, v96
  v_cvt_pk_bf16_f32 v97, 0, v97
  v_max3_f32 v200, v66, v67, v68
  v_max3_f32 v201, v69, v70, v71
  v_max3_f32 v200, v200, v72, v73
  v_max3_f32 v201, v201, v74, v75
  v_max3_f32 v200, v200, v76, v77
  v_max3_f32 v201, v201, v78, v79
  v_max3_f32 v200, v200, v80, v81
  v_mfma_f32_32x32x16_bf16 v[178:193], v[50:53], v[146:149], v[178:193]
  v_max3_f32 v201, v201, v82, v83
  v_max3_f32 v200, v200, v84, v85
  v_max3_f32 v201, v201, v86, v87
  v_max3_f32 v200, v200, v88, v89
  v_max3_f32 v201, v201, v90, v91
  v_max3_f32 v200, v200, v92, v93
  v_max3_f32 v201, v201, v94, v95
  v_max3_f32 v200, v200, v96, v97
  v_max3_f32 v200, v200, v201, v194
  v_mov_b32 v201, v200
  s_nop 1
  v_permlane32_swap_b32 v200, v201
  v_max_f32 v200, v200, v201
  v_sub_f32 v201, v194, v200
  v_mul_f32 v201, s12, v201
  v_exp_f32 v201, v201
  v_mov_b32 v194, v200
  v_mul_f32 v196, s12, v200
  v_sub_f32 v196, 0, v196
  v_mov_b32 v197, v196
  v_mfma_f32_32x32x16_bf16 v[178:193], v[54:57], v[150:153], v[178:193]
  v_mul_f32 v162, v201, v162
  v_mul_f32 v163, v201, v163
  v_mul_f32 v164, v201, v164
  v_mul_f32 v165, v201, v165
  v_mul_f32 v166, v201, v166
  v_mul_f32 v167, v201, v167
  v_mul_f32 v168, v201, v168
  v_mul_f32 v169, v201, v169
  v_mul_f32 v170, v201, v170
  v_pk_fma_f32 v[66:67], v[66:67], s[12:13], v[196:197]
  v_pk_fma_f32 v[68:69], v[68:69], s[12:13], v[196:197]
  v_pk_fma_f32 v[70:71], v[70:71], s[12:13], v[196:197]
  v_pk_fma_f32 v[72:73], v[72:73], s[12:13], v[196:197]
  v_pk_fma_f32 v[74:75], v[74:75], s[12:13], v[196:197]
  v_pk_fma_f32 v[76:77], v[76:77], s[12:13], v[196:197]
  v_pk_fma_f32 v[78:79], v[78:79], s[12:13], v[196:197]
  v_pk_fma_f32 v[80:81], v[80:81], s[12:13], v[196:197]
  v_pk_fma_f32 v[82:83], v[82:83], s[12:13], v[196:197]
  v_pk_fma_f32 v[84:85], v[84:85], s[12:13], v[196:197]
  v_pk_fma_f32 v[86:87], v[86:87], s[12:13], v[196:197]
  v_mfma_f32_32x32x16_bf16 v[178:193], v[58:61], v[154:157], v[178:193]
  v_pk_fma_f32 v[88:89], v[88:89], s[12:13], v[196:197]
  v_pk_fma_f32 v[90:91], v[90:91], s[12:13], v[196:197]
  v_pk_fma_f32 v[92:93], v[92:93], s[12:13], v[196:197]
  v_pk_fma_f32 v[94:95], v[94:95], s[12:13], v[196:197]
  v_pk_fma_f32 v[96:97], v[96:97], s[12:13], v[196:197]
  v_exp_f32 v66, v66
  v_exp_f32 v67, v67
  v_exp_f32 v68, v68
  v_exp_f32 v69, v69
  v_exp_f32 v70, v70
  v_exp_f32 v71, v71
  v_exp_f32 v72, v72
  v_exp_f32 v73, v73
  v_exp_f32 v74, v74
  v_exp_f32 v75, v75
  v_exp_f32 v76, v76
  v_exp_f32 v77, v77
  v_exp_f32 v78, v78
  v_exp_f32 v79, v79
  v_exp_f32 v80, v80
  v_mfma_f32_32x32x16_bf16 v[178:193], v[62:65], v[158:161], v[178:193]
  v_exp_f32 v81, v81
  v_exp_f32 v82, v82
  v_exp_f32 v83, v83
  v_exp_f32 v84, v84
  v_exp_f32 v85, v85
  v_exp_f32 v86, v86
  v_exp_f32 v87, v87
  v_exp_f32 v88, v88
  v_exp_f32 v89, v89
  v_exp_f32 v90, v90
  v_exp_f32 v91, v91
  v_exp_f32 v92, v92
  v_exp_f32 v93, v93
  v_exp_f32 v94, v94
  v_exp_f32 v95, v95
  v_exp_f32 v96, v96
  v_exp_f32 v97, v97
  v_cvt_pk_bf16_f32 v130, v66, v67
  v_cvt_pk_bf16_f32 v131, v68, v69
  v_cvt_pk_bf16_f32 v132, v70, v71
  v_cvt_pk_bf16_f32 v133, v72, v73
  v_cvt_pk_bf16_f32 v134, v74, v75
  v_cvt_pk_bf16_f32 v135, v76, v77
  v_cvt_pk_bf16_f32 v136, v78, v79
  v_cvt_pk_bf16_f32 v137, v80, v81
  v_cvt_pk_bf16_f32 v138, v82, v83
  v_cvt_pk_bf16_f32 v139, v84, v85
  v_cvt_pk_bf16_f32 v140, v86, v87
  v_cvt_pk_bf16_f32 v141, v88, v89
  v_cvt_pk_bf16_f32 v142, v90, v91
  v_cvt_pk_bf16_f32 v143, v92, v93
  v_cvt_pk_bf16_f32 v144, v94, v95
  v_cvt_pk_bf16_f32 v145, v96, v97
  v_cvt_pk_bf16_f32 v98, 0, v98
  v_cvt_pk_bf16_f32 v99, 0, v99
  buffer_load_dwordx4 v[50:53], v209, s[4:7], s9 offen offset:0
  buffer_load_dwordx4 v[54:57], v209, s[4:7], s9 offen offset:1024
  buffer_load_dwordx4 v[58:61], v209, s[4:7], s9 offen offset:2048
  buffer_load_dwordx4 v[62:65], v209, s[4:7], s9 offen offset:3072
  s_add_u32 s9, s9, 4096
  v_cvt_pk_bf16_f32 v100, 0, v100
  v_cvt_pk_bf16_f32 v101, 0, v101
  v_cvt_pk_bf16_f32 v102, 0, v102
  s_waitcnt vmcnt(6)
  v_mfma_f32_32x32x16_bf16 v[162:177], v[34:37], v[130:133], v[162:177]
  v_cvt_pk_bf16_f32 v103, 0, v103
  v_cvt_pk_bf16_f32 v104, 0, v104
  v_cvt_pk_bf16_f32 v105, 0, v105
  v_cvt_pk_bf16_f32 v106, 0, v106
  v_cvt_pk_bf16_f32 v107, 0, v107
  v_cvt_pk_bf16_f32 v108, 0, v108
  v_cvt_pk_bf16_f32 v109, 0, v109
  v_cvt_pk_bf16_f32 v110, 0, v110
  v_cvt_pk_bf16_f32 v111, 0, v111
  v_cvt_pk_bf16_f32 v112, 0, v112
  v_cvt_pk_bf16_f32 v113, 0, v113
  v_cvt_pk_bf16_f32 v114, 0, v114
  v_cvt_pk_bf16_f32 v115, 0, v115
  v_cvt_pk_bf16_f32 v116, 0, v116
  v_cvt_pk_bf16_f32 v117, 0, v117
  v_cvt_pk_bf16_f32 v118, 0, v118
  v_cvt_pk_bf16_f32 v119, 0, v119
  v_cvt_pk_bf16_f32 v120, 0, v120
  v_mfma_f32_32x32x16_bf16 v[162:177], v[38:41], v[134:137], v[162:177]
  v_cvt_pk_bf16_f32 v121, 0, v121
  v_cvt_pk_bf16_f32 v122, 0, v122
  v_cvt_pk_bf16_f32 v123, 0, v123
  v_cvt_pk_bf16_f32 v124, 0, v124
  v_cvt_pk_bf16_f32 v125, 0, v125
  v_cvt_pk_bf16_f32 v126, 0, v126
  v_cvt_pk_bf16_f32 v127, 0, v127
  v_cvt_pk_bf16_f32 v128, 0, v128
  v_cvt_pk_bf16_f32 v129, 0, v129
  v_max3_f32 v204, v98, v99, v100
  v_max3_f32 v205, v101, v102, v103
  v_max3_f32 v204, v204, v104, v105
  v_max3_f32 v205, v205, v106, v107
  v_max3_f32 v204, v204, v108, v109
  v_max3_f32 v205, v205, v110, v111
  v_max3_f32 v204, v204, v112, v113
  v_max3_f32 v205, v205, v114, v115
  v_max3_f32 v204, v204, v116, v117
  v_max3_f32 v205, v205, v118, v119
  v_mfma_f32_32x32x16_bf16 v[162:177], v[42:45], v[138:141], v[162:177]
  v_max3_f32 v204, v204, v120, v121
  v_max3_f32 v205, v205, v122, v123
  v_max3_f32 v204, v204, v124, v125
  v_max3_f32 v205, v205, v126, v127
  v_max3_f32 v204, v204, v128, v129
  v_max3_f32 v204, v204, v205, v195
  v_mov_b32 v205, v204
  s_nop 1
  v_permlane32_swap_b32 v204, v205
  v_max_f32 v204, v204, v205
  v_sub_f32 v205, v195, v204
  v_mul_f32 v205, s12, v205
  v_exp_f32 v205, v205
  v_mov_b32 v195, v204
  v_mul_f32 v198, s12, v204
  v_sub_f32 v198, 0, v198
  v_mov_b32 v199, v198
  v_mul_f32 v178, v205, v178
  v_mfma_f32_32x32x16_bf16 v[162:177], v[46:49], v[142:145], v[162:177]
  v_mul_f32 v179, v205, v179
  v_mul_f32 v180, v205, v180
  v_mul_f32 v181, v205, v181
  v_mul_f32 v182, v205, v182
  v_mul_f32 v183, v205, v183
  v_mul_f32 v184, v205, v184
  v_mul_f32 v185, v205, v185
  v_mul_f32 v186, v205, v186
  v_pk_fma_f32 v[98:99], v[98:99], s[12:13], v[198:199]
  v_pk_fma_f32 v[100:101], v[100:101], s[12:13], v[198:199]
  v_pk_fma_f32 v[102:103], v[102:103], s[12:13], v[198:199]
  v_pk_fma_f32 v[104:105], v[104:105], s[12:13], v[198:199]
  v_pk_fma_f32 v[106:107], v[106:107], s[12:13], v[198:199]
  v_pk_fma_f32 v[108:109], v[108:109], s[12:13], v[198:199]
  v_pk_fma_f32 v[110:111], v[110:111], s[12:13], v[198:199]
  v_pk_fma_f32 v[112:113], v[112:113], s[12:13], v[198:199]
  v_pk_fma_f32 v[114:115], v[114:115], s[12:13], v[198:199]
  v_pk_fma_f32 v[116:117], v[116:117], s[12:13], v[198:199]
  v_pk_fma_f32 v[118:119], v[118:119], s[12:13], v[198:199]
  v_pk_fma_f32 v[120:121], v[120:121], s[12:13], v[198:199]
  v_pk_fma_f32 v[122:123], v[122:123], s[12:13], v[198:199]
  s_waitcnt vmcnt(4)
  v_mfma_f32_32x32x16_bf16 v[66:81], v[26:29], v[10:13], 0
  v_pk_fma_f32 v[124:125], v[124:125], s[12:13], v[198:199]
  v_pk_fma_f32 v[126:127], v[126:127], s[12:13], v[198:199]
  v_pk_fma_f32 v[128:129], v[128:129], s[12:13], v[198:199]
  v_exp_f32 v98, v98
  v_exp_f32 v99, v99
  v_exp_f32 v100, v100
  v_exp_f32 v101, v101
  v_exp_f32 v102, v102
  v_exp_f32 v103, v103
  v_exp_f32 v104, v104
  v_exp_f32 v105, v105
  v_exp_f32 v106, v106
  v_exp_f32 v107, v107
  v_exp_f32 v108, v108
  v_exp_f32 v109, v109
  v_exp_f32 v110, v110
  v_exp_f32 v111, v111
  v_exp_f32 v112, v112
  v_exp_f32 v113, v113
  v_mfma_f32_32x32x16_bf16 v[82:97], v[30:33], v[10:13], 0
  v_exp_f32 v114, v114
  v_exp_f32 v115, v115
  v_exp_f32 v116, v116
  v_exp_f32 v117, v117
  v_exp_f32 v118, v118
  v_exp_f32 v119, v119
  v_exp_f32 v120, v120
  v_exp_f32 v121, v121
  v_exp_f32 v122, v122
  v_exp_f32 v123, v123
  v_exp_f32 v124, v124
  v_exp_f32 v125, v125
  v_exp_f32 v126, v126
  v_exp_f32 v127, v127
  v_exp_f32 v128, v128
  v_exp_f32 v129, v129
  v_cvt_pk_bf16_f32 v146, v98, v99
  v_cvt_pk_bf16_f32 v147, v100, v101
  v_cvt_pk_bf16_f32 v148, v102, v103
  v_cvt_pk_bf16_f32 v149, v104, v105
  v_cvt_pk_bf16_f32 v150, v106, v107
  v_cvt_pk_bf16_f32 v151, v108, v109
  v_cvt_pk_bf16_f32 v152, v110, v111
  v_cvt_pk_bf16_f32 v153, v112, v113
  v_cvt_pk_bf16_f32 v154, v114, v115
  v_cvt_pk_bf16_f32 v155, v116, v117
  v_cvt_pk_bf16_f32 v156, v118, v119
  v_cvt_pk_bf16_f32 v157, v120, v121
  v_cvt_pk_bf16_f32 v158, v122, v123
  v_cvt_pk_bf16_f32 v159, v124, v125
  v_cvt_pk_bf16_f32 v160, v126, v127
  v_cvt_pk_bf16_f32 v161, v128, v129
  v_cvt_pk_bf16_f32 v66, 0, v66
  v_cvt_pk_bf16_f32 v67, 0, v67
  buffer_load_dwordx4 v[18:21], v208, s[4:7], s8 offen offset:0
  buffer_load_dwordx4 v[22:25], v208, s[4:7], s8 offen offset:1024
  s_add_u32 s8, s8, 2048
  v_cvt_pk_bf16_f32 v68, 0, v68
  v_cvt_pk_bf16_f32 v69, 0, v69
  v_cvt_pk_bf16_f32 v70, 0, v70
  v_cvt_pk_bf16_f32 v71, 0, v71
  v_mfma_f32_32x32x16_bf16 v[98:113], v[26:29], v[14:17], 0
  v_cvt_pk_bf16_f32 v72, 0, v72
  v_cvt_pk_bf16_f32 v73, 0, v73
  v_cvt_pk_bf16_f32 v74, 0, v74
  v_cvt_pk_bf16_f32 v75, 0, v75
  v_cvt_pk_bf16_f32 v76, 0, v76
  v_cvt_pk_bf16_f32 v77, 0, v77
  v_cvt_pk_bf16_f32 v78, 0, v78
  v_cvt_pk_bf16_f32 v79, 0, v79
  v_cvt_pk_bf16_f32 v80, 0, v80
  v_cvt_pk_bf16_f32 v81, 0, v81
  v_cvt_pk_bf16_f32 v82, 0, v82
  v_cvt_pk_bf16_f32 v83, 0, v83
  v_cvt_pk_bf16_f32 v84, 0, v84
  v_mfma_f32_32x32x16_bf16 v[114:129], v[30:33], v[14:17], 0
  v_cvt_pk_bf16_f32 v85, 0, v85
  v_cvt_pk_bf16_f32 v86, 0, v86
  v_cvt_pk_bf16_f32 v87, 0, v87
  v_cvt_pk_bf16_f32 v88, 0, v88
  v_cvt_pk_bf16_f32 v89, 0, v89
  v_cvt_pk_bf16_f32 v90, 0, v90
  v_cvt_pk_bf16_f32 v91, 0, v91
  v_cvt_pk_bf16_f32 v92, 0, v92
  v_cvt_pk_bf16_f32 v93, 0, v93
  v_cvt_pk_bf16_f32 v94, 0, v94
  v_cvt_pk_bf16_f32 v95, 0, v95
  v_cvt_pk_bf16_f32 v96, 0, v96
  v_cvt_pk_bf16_f32 v97, 0, v97
  v_max3_f32 v200, v66, v67, v68
  v_max3_f32 v201, v69, v70, v71
  v_max3_f32 v200, v200, v72, v73
  v_max3_f32 v201, v201, v74, v75
  v_max3_f32 v200, v200, v76, v77
  v_max3_f32 v201, v201, v78, v79
  v_max3_f32 v200, v200, v80, v81
  v_mfma_f32_32x32x16_bf16 v[178:193], v[34:37], v[146:149], v[178:193]
  v_max3_f32 v201, v201, v82, v83
  v_max3_f32 v200, v200, v84, v85
  v_max3_f32 v201, v201, v86, v87
  v_max3_f32 v200, v200, v88, v89
  v_max3_f32 v201, v201, v90, v91
  v_max3_f32 v200, v200, v92, v93
  v_max3_f32 v201, v201, v94, v95
  v_max3_f32 v200, v200, v96, v97
  v_max3_f32 v200, v200, v201, v194
  v_mov_b32 v201, v200
  s_nop 1
  v_permlane32_swap_b32 v200, v201
  v_max_f32 v200, v200, v201
  v_sub_f32 v201, v194, v200
  v_mul_f32 v201, s12, v201
  v_exp_f32 v201, v201
  v_mov_b32 v194, v200
  v_mul_f32 v196, s12, v200
  v_sub_f32 v196, 0, v196
  v_mov_b32 v197, v196
  v_mfma_f32_32x32x16_bf16 v[178:193], v[38:41], v[150:153], v[178:193]
  v_mul_f32 v162, v201, v162
  v_mul_f32 v163, v201, v163
  v_mul_f32 v164, v201, v164
  v_mul_f32 v165, v201, v165
  v_mul_f32 v166, v201, v166
  v_mul_f32 v167, v201, v167
  v_mul_f32 v168, v201, v168
  v_mul_f32 v169, v201, v169
  v_mul_f32 v170, v201, v170
  v_pk_fma_f32 v[66:67], v[66:67], s[12:13], v[196:197]
  v_pk_fma_f32 v[68:69], v[68:69], s[12:13], v[196:197]
  v_pk_fma_f32 v[70:71], v[70:71], s[12:13], v[196:197]
  v_pk_fma_f32 v[72:73], v[72:73], s[12:13], v[196:197]
  v_pk_fma_f32 v[74:75], v[74:75], s[12:13], v[196:197]
  v_pk_fma_f32 v[76:77], v[76:77], s[12:13], v[196:197]
  v_pk_fma_f32 v[78:79], v[78:79], s[12:13], v[196:197]
  v_pk_fma_f32 v[80:81], v[80:81], s[12:13], v[196:197]
  v_pk_fma_f32 v[82:83], v[82:83], s[12:13], v[196:197]
  v_pk_fma_f32 v[84:85], v[84:85], s[12:13], v[196:197]
  v_pk_fma_f32 v[86:87], v[86:87], s[12:13], v[196:197]
  v_mfma_f32_32x32x16_bf16 v[178:193], v[42:45], v[154:157], v[178:193]
  v_pk_fma_f32 v[88:89], v[88:89], s[12:13], v[196:197]
  v_pk_fma_f32 v[90:91], v[90:91], s[12:13], v[196:197]
  v_pk_fma_f32 v[92:93], v[92:93], s[12:13], v[196:197]
  v_pk_fma_f32 v[94:95], v[94:95], s[12:13], v[196:197]
  v_pk_fma_f32 v[96:97], v[96:97], s[12:13], v[196:197]
  v_exp_f32 v66, v66
  v_exp_f32 v67, v67
  v_exp_f32 v68, v68
  v_exp_f32 v69, v69
  v_exp_f32 v70, v70
  v_exp_f32 v71, v71
  v_exp_f32 v72, v72
  v_exp_f32 v73, v73
  v_exp_f32 v74, v74
  v_exp_f32 v75, v75
  v_exp_f32 v76, v76
  v_exp_f32 v77, v77
  v_exp_f32 v78, v78
  v_exp_f32 v79, v79
  v_exp_f32 v80, v80
  v_mfma_f32_32x32x16_bf16 v[178:193], v[46:49], v[158:161], v[178:193]
  v_exp_f32 v81, v81
  v_exp_f32 v82, v82
  v_exp_f32 v83, v83
  v_exp_f32 v84, v84
  v_exp_f32 v85, v85
  v_exp_f32 v86, v86
  v_exp_f32 v87, v87
  v_exp_f32 v88, v88
  v_exp_f32 v89, v89
  v_exp_f32 v90, v90
  v_exp_f32 v91, v91
  v_exp_f32 v92, v92
  v_exp_f32 v93, v93
  v_exp_f32 v94, v94
  v_exp_f32 v95, v95
  v_exp_f32 v96, v96
  v_exp_f32 v97, v97
  v_cvt_pk_bf16_f32 v130, v66, v67
  v_cvt_pk_bf16_f32 v131, v68, v69
  v_cvt_pk_bf16_f32 v132, v70, v71
  v_cvt_pk_bf16_f32 v133, v72, v73
  v_cvt_pk_bf16_f32 v134, v74, v75
  v_cvt_pk_bf16_f32 v135, v76, v77
  v_cvt_pk_bf16_f32 v136, v78, v79
  v_cvt_pk_bf16_f32 v137, v80, v81
  v_cvt_pk_bf16_f32 v138, v82, v83
  v_cvt_pk_bf16_f32 v139, v84, v85
  v_cvt_pk_bf16_f32 v140, v86, v87
  v_cvt_pk_bf16_f32 v141, v88, v89
  v_cvt_pk_bf16_f32 v142, v90, v91
  v_cvt_pk_bf16_f32 v143, v92, v93
  v_cvt_pk_bf16_f32 v144, v94, v95
  v_cvt_pk_bf16_f32 v145, v96, v97
  v_cvt_pk_bf16_f32 v98, 0, v98
  v_cvt_pk_bf16_f32 v99, 0, v99
  buffer_load_dwordx4 v[34:37], v209, s[4:7], s9 offen offset:0
  buffer_load_dwordx4 v[38:41], v209, s[4:7], s9 offen offset:1024
  buffer_load_dwordx4 v[42:45], v209, s[4:7], s9 offen offset:2048
  buffer_load_dwordx4 v[46:49], v209, s[4:7], s9 offen offset:3072
  s_add_u32 s9, s9, 4096
  v_cvt_pk_bf16_f32 v100, 0, v100
  v_cvt_pk_bf16_f32 v101, 0, v101
  v_cvt_pk_bf16_f32 v102, 0, v102
  s_waitcnt vmcnt(6)
  v_mfma_f32_32x32x16_bf16 v[162:177], v[50:53], v[130:133], v[162:177]
  v_cvt_pk_bf16_f32 v103, 0, v103
  v_cvt_pk_bf16_f32 v104, 0, v104
  v_cvt_pk_bf16_f32 v105, 0, v105
  v_cvt_pk_bf16_f32 v106, 0, v106
  v_cvt_pk_bf16_f32 v107, 0, v107
  v_cvt_pk_bf16_f32 v108, 0, v108
  v_cvt_pk_bf16_f32 v109, 0, v109
  v_cvt_pk_bf16_f32 v110, 0, v110
  v_cvt_pk_bf16_f32 v111, 0, v111
  v_cvt_pk_bf16_f32 v112, 0, v112
  v_cvt_pk_bf16_f32 v113, 0, v113
  v_cvt_pk_bf16_f32 v114, 0, v114
  v_cvt_pk_bf16_f32 v115, 0, v115
  v_cvt_pk_bf16_f32 v116, 0, v116
  v_cvt_pk_bf16_f32 v117, 0, v117
  v_cvt_pk_bf16_f32 v118, 0, v118
  v_cvt_pk_bf16_f32 v119, 0, v119
  v_cvt_pk_bf16_f32 v120, 0, v120
  v_mfma_f32_32x32x16_bf16 v[162:177], v[54:57], v[134:137], v[162:177]
  v_cvt_pk_bf16_f32 v121, 0, v121
  v_cvt_pk_bf16_f32 v122, 0, v122
  v_cvt_pk_bf16_f32 v123, 0, v123
  v_cvt_pk_bf16_f32 v124, 0, v124
  v_cvt_pk_bf16_f32 v125, 0, v125
  v_cvt_pk_bf16_f32 v126, 0, v126
  v_cvt_pk_bf16_f32 v127, 0, v127
  v_cvt_pk_bf16_f32 v128, 0, v128
  v_cvt_pk_bf16_f32 v129, 0, v129
  v_max3_f32 v204, v98, v99, v100
  v_max3_f32 v205, v101, v102, v103
  v_max3_f32 v204, v204, v104, v105
  v_max3_f32 v205, v205, v106, v107
  v_max3_f32 v204, v204, v108, v109
  v_max3_f32 v205, v205, v110, v111
  v_max3_f32 v204, v204, v112, v113
  v_max3_f32 v205, v205, v114, v115
  v_max3_f32 v204, v204, v116, v117
  v_max3_f32 v205, v205, v118, v119
  v_mfma_f32_32x32x16_bf16 v[162:177], v[58:61], v[138:141], v[162:177]
  v_max3_f32 v204, v204, v120, v121
  v_max3_f32 v205, v205, v122, v123
  v_max3_f32 v204, v204, v124, v125
  v_max3_f32 v205, v205, v126, v127
  v_max3_f32 v204, v204, v128, v129
  v_max3_f32 v204, v204, v205, v195
  v_mov_b32 v205, v204
  s_nop 1
  v_permlane32_swap_b32 v204, v205
  v_max_f32 v204, v204, v205
  v_sub_f32 v205, v195, v204
  v_mul_f32 v205, s12, v205
  v_exp_f32 v205, v205
  v_mov_b32 v195, v204
  v_mul_f32 v198, s12, v204
  v_sub_f32 v198, 0, v198
  v_mov_b32 v199, v198
  v_mul_f32 v178, v205, v178
  v_mfma_f32_32x32x16_bf16 v[162:177], v[62:65], v[142:145], v[162:177]
  v_mul_f32 v179, v205, v179
  v_mul_f32 v180, v205, v180
  v_mul_f32 v181, v205, v181
  v_mul_f32 v182, v205, v182
  v_mul_f32 v183, v205, v183
  v_mul_f32 v184, v205, v184
  v_mul_f32 v185, v205, v185
  v_mul_f32 v186, v205, v186
  v_pk_fma_f32 v[98:99], v[98:99], s[12:13], v[198:199]
  v_pk_fma_f32 v[100:101], v[100:101], s[12:13], v[198:199]
  v_pk_fma_f32 v[102:103], v[102:103], s[12:13], v[198:199]
  v_pk_fma_f32 v[104:105], v[104:105], s[12:13], v[198:199]
  v_pk_fma_f32 v[106:107], v[106:107], s[12:13], v[198:199]
  v_pk_fma_f32 v[108:109], v[108:109], s[12:13], v[198:199]
  v_pk_fma_f32 v[110:111], v[110:111], s[12:13], v[198:199]
  v_pk_fma_f32 v[112:113], v[112:113], s[12:13], v[198:199]
  v_pk_fma_f32 v[114:115], v[114:115], s[12:13], v[198:199]
  v_pk_fma_f32 v[116:117], v[116:117], s[12:13], v[198:199]
  v_pk_fma_f32 v[118:119], v[118:119], s[12:13], v[198:199]
  v_pk_fma_f32 v[120:121], v[120:121], s[12:13], v[198:199]
  v_pk_fma_f32 v[122:123], v[122:123], s[12:13], v[198:199]
  s_waitcnt vmcnt(4)
  v_mfma_f32_32x32x16_bf16 v[66:81], v[18:21], v[10:13], 0
  v_pk_fma_f32 v[124:125], v[124:125], s[12:13], v[198:199]
  v_pk_fma_f32 v[126:127], v[126:127], s[12:13], v[198:199]
  v_pk_fma_f32 v[128:129], v[128:129], s[12:13], v[198:199]
  v_exp_f32 v98, v98
  v_exp_f32 v99, v99
  v_exp_f32 v100, v100
  v_exp_f32 v101, v101
  v_exp_f32 v102, v102
  v_exp_f32 v103, v103
  v_exp_f32 v104, v104
  v_exp_f32 v105, v105
  v_exp_f32 v106, v106
  v_exp_f32 v107, v107
  v_exp_f32 v108, v108
  v_exp_f32 v109, v109
  v_exp_f32 v110, v110
  v_exp_f32 v111, v111
  v_exp_f32 v112, v112
  v_exp_f32 v113, v113
  v_mfma_f32_32x32x16_bf16 v[82:97], v[22:25], v[10:13], 0
  v_exp_f32 v114, v114
  v_exp_f32 v115, v115
  v_exp_f32 v116, v116
  v_exp_f32 v117, v117
  v_exp_f32 v118, v118
  v_exp_f32 v119, v119
  v_exp_f32 v120, v120
  v_exp_f32 v121, v121
  v_exp_f32 v122, v122
  v_exp_f32 v123, v123
  v_exp_f32 v124, v124
  v_exp_f32 v125, v125
  v_exp_f32 v126, v126
  v_exp_f32 v127, v127
  v_exp_f32 v128, v128
  v_exp_f32 v129, v129
  v_cvt_pk_bf16_f32 v146, v98, v99
  v_cvt_pk_bf16_f32 v147, v100, v101
  v_cvt_pk_bf16_f32 v148, v102, v103
  v_cvt_pk_bf16_f32 v149, v104, v105
  v_cvt_pk_bf16_f32 v150, v106, v107
  v_cvt_pk_bf16_f32 v151, v108, v109
  v_cvt_pk_bf16_f32 v152, v110, v111
  v_cvt_pk_bf16_f32 v153, v112, v113
  v_cvt_pk_bf16_f32 v154, v114, v115
  v_cvt_pk_bf16_f32 v155, v116, v117
  v_cvt_pk_bf16_f32 v156, v118, v119
  v_cvt_pk_bf16_f32 v157, v120, v121
  v_cvt_pk_bf16_f32 v158, v122, v123
  v_cvt_pk_bf16_f32 v159, v124, v125
  v_cvt_pk_bf16_f32 v160, v126, v127
  v_cvt_pk_bf16_f32 v161, v128, v129
  s_sub_u32 s10, s10, 1
  s_cmp_lg_u32 s10, 0
  s_cbranch_scc1 l1_kernel_bloop
  s_nop 1
  v_mfma_f32_32x32x16_bf16 v[178:193], v[50:53], v[146:149], v[178:193]
  v_mfma_f32_32x32x16_bf16 v[178:193], v[54:57], v[150:153], v[178:193]
  v_mfma_f32_32x32x16_bf16 v[178:193], v[58:61], v[154:157], v[178:193]
  v_mfma_f32_32x32x16_bf16 v[178:193], v[62:65], v[158:161], v[178:193]
  s_nop 15
  s_nop 3
  s_lshl_b32 s17, s14, 5
  s_add_u32 s17, s17, 0x4300000
  v_and_b32 v2, 31, v1
  v_lshlrev_b32 v2, 5, v2
  v_lshrrev_b32 v3, 5, v1
  v_lshlrev_b32 v3, 3, v3
  v_add_u32 v2, v2, v3
  v_mov_b32 v200, v170
  v_mov_b32 v201, v170
  s_nop 1
  v_permlane32_swap_b32 v200, v201
  v_rcp_f32 v200, v200
  s_nop 0
  v_mul_f32 v162, v200, v162
  v_mul_f32 v163, v200, v163
  v_mul_f32 v164, v200, v164
  v_mul_f32 v165, v200, v165
  v_mul_f32 v166, v200, v166
  v_mul_f32 v167, v200, v167
  v_mul_f32 v168, v200, v168
  v_mul_f32 v169, v200, v169
  v_cvt_pk_bf16_f32 v202, v162, v163
  v_cvt_pk_bf16_f32 v203, v164, v165
  buffer_store_dwordx2 v[202:203], v2, s[4:7], s17 offen offset:0
  s_nop 1
  v_cvt_pk_bf16_f32 v202, v166, v167
  v_cvt_pk_bf16_f32 v203, v168, v169
  buffer_store_dwordx2 v[202:203], v2, s[4:7], s17 offen offset:16
  s_nop 1
  v_mov_b32 v200, v186
  v_mov_b32 v201, v186
  s_nop 1
  v_permlane32_swap_b32 v200, v201
  v_rcp_f32 v200, v200
  s_nop 0
  v_mul_f32 v178, v200, v178
  v_mul_f32 v179, v200, v179
  v_mul_f32 v180, v200, v180
  v_mul_f32 v181, v200, v181
  v_mul_f32 v182, v200, v182
  v_mul_f32 v183, v200, v183
  v_mul_f32 v184, v200, v184
  v_mul_f32 v185, v200, v185
  v_cvt_pk_bf16_f32 v202, v178, v179
  v_cvt_pk_bf16_f32 v203, v180, v181
  buffer_store_dwordx2 v[202:203], v2, s[4:7], s17 offen offset:1024
  s_nop 1
  v_cvt_pk_bf16_f32 v202, v182, v183
  v_cvt_pk_bf16_f32 v203, v184, v185
  buffer_store_dwordx2 v[202:203], v2, s[4:7], s17 offen offset:1040
  s_nop 1
  s_waitcnt vmcnt(0)
  s_endpgm
.section .rodata,"a"
.p2align 6
.amdhsa_kernel l1_kernel
  .amdhsa_next_free_vgpr 212
  .amdhsa_next_free_sgpr 64
  .amdhsa_accum_offset 212
  .amdhsa_group_segment_fixed_size 0
  .amdhsa_kernarg_size 120
  .amdhsa_user_sgpr_count 2
  .amdhsa_user_sgpr_kernarg_segment_ptr 1
  .amdhsa_system_sgpr_workgroup_id_x 1
.end_amdhsa_kernel
.text
.globl a_kernel
.p2align 8
.type a_kernel,@function
a_kernel:
  s_cmp_ge_u32 s2, 256
  s_cbranch_scc1 a_kernel_end
  s_and_b32 s33, s2, 7
  s_lshr_b32 s34, s2, 3
  s_lshl_b32 s30, s33, 2
  s_lshr_b32 s35, s34, 3
  s_add_u32 s30, s30, s35
  s_and_b32 s31, s34, 7
  s_load_dwordx2 s[40:41], s[0:1], 112
  s_waitcnt lgkmcnt(0)
  v_lshrrev_b32 v2, 8, v0
  s_nop 0
  v_readfirstlane_b32 s36, v2
  s_nop 3
  s_cmp_lg_u32 s36, 0
  s_cbranch_scc1 a_kernel_prod
  s_mov_b32 s9, s30
  s_mov_b32 s26, s31
  s_mov_b32 s4, s40
  s_mov_b32 s5, s41
  s_mov_b32 s6, 0x4000000
  s_mov_b32 s7, 0x20000
  v_and_b32 v1, 63, v0
  v_lshrrev_b32 v2, 6, v0
  s_nop 0
  v_readfirstlane_b32 s8, v2
  s_nop 3
  s_lshl_b32 s13, s8, 12
  s_add_u32 s14, s13, 16384
  v_lshrrev_b32 v2, 4, v1
  v_and_b32 v3, 15, v1
  v_xor_b32 v4, v3, v2
  v_lshlrev_b32 v4, 4, v4
  v_lshlrev_b32 v5, 8, v2
  v_add_u32 v198, v4, v5
  v_lshlrev_b32 v4, 2, v2
  v_xor_b32 v4, v3, v4
  v_lshlrev_b32 v4, 4, v4
  v_add_u32 v199, v4, v5
  v_and_b32 v4, 31, v1
  v_lshlrev_b32 v4, 8, v4
  v_lshrrev_b32 v5, 5, v1
  v_xor_b32 v6, v5, v3
  v_lshlrev_b32 v6, 4, v6
  v_add_u32 v186, v4, v6
  v_xor_b32 v187, 32, v186
  v_xor_b32 v188, 64, v186
  v_xor_b32 v189, 96, v186
  v_xor_b32 v190, 128, v186
  v_xor_b32 v191, 160, v186
  v_xor_b32 v192, 192, v186
  v_xor_b32 v193, 224, v186
  v_bfe_u32 v6, v1, 4, 1
  v_bfe_u32 v7, v1, 2, 2
  v_and_b32 v8, 3, v1
  v_lshlrev_b32 v9, 2, v5
  v_add_u32 v9, v9, v7
  v_lshlrev_b32 v9, 8, v9
  v_and_b32 v4, 1, v8
  v_lshlrev_b32 v4, 3, v4
  v_add_u32 v9, v9, v4
  v_lshrrev_b32 v8, 1, v8
  v_lshlrev_b32 v6, 1, v6
  v_add_u32 v8, v8, v6
  v_lshlrev_b32 v7, 2, v7
  v_add_u32 v4, 0, v8
  v_xor_b32 v4, v4, v7
  v_lshlrev_b32 v4, 4, v4
  v_add_u32 v194, v9, v4
  v_add_u32 v4, 4, v8
  v_xor_b32 v4, v4, v7
  v_lshlrev_b32 v4, 4, v4
  v_add_u32 v195, v9, v4
  v_add_u32 v4, 8, v8
  v_xor_b32 v4, v4, v7
  v_lshlrev_b32 v4, 4, v4
  v_add_u32 v196, v9, v4
  v_add_u32 v4, 12, v8
  v_xor_b32 v4, v4, v7
  v_lshlrev_b32 v4, 4, v4
  v_add_u32 v197, v9, v4
  v_mov_b32 v203, 0xff800000
  s_mov_b32 s28, 0x41000000
  s_mov_b32 s10, s26
  s_lshl_b32 s20, s9, 19
  s_lshl_b32 s21, s10, 7
  s_lshl_b32 s22, s8, 5
  s_add_u32 s21, s21, s22
  s_lshl_b32 s23, s21, 8
  s_add_u32 s23, s23, s20
  v_and_b32 v2, 31, v1
  v_lshlrev_b32 v3, 8, v2
  v_lshrrev_b32 v4, 5, v1
  v_lshlrev_b32 v5, 4, v4
  v_add_u32 v3, v3, v5
  buffer_load_dwordx4 v[10:13], v3, s[4:7], s23 offen offset:0
  buffer_load_dwordx4 v[14:17], v3, s[4:7], s23 offen offset:32
  buffer_load_dwordx4 v[18:21], v3, s[4:7], s23 offen offset:64
  buffer_load_dwordx4 v[22:25], v3, s[4:7], s23 offen offset:96
  buffer_load_dwordx4 v[26:29], v3, s[4:7], s23 offen offset:128
  buffer_load_dwordx4 v[30:33], v3, s[4:7], s23 offen offset:160
  buffer_load_dwordx4 v[34:37], v3, s[4:7], s23 offen offset:192
  buffer_load_dwordx4 v[38:41], v3, s[4:7], s23 offen offset:224
  v_add_u32 v202, s21, v2
  v_lshlrev_b32 v5, 2, v4
  v_sub_u32 v202, v202, v5
  s_lshl_b32 s24, s8, 12
  s_add_u32 s24, s24, s20
  s_add_u32 s11, s24, 0x1000000
  s_add_u32 s12, s24, 0x2000000
  v_mov_b32 v200, 0xff800000
  v_mov_b32 v201, 0
  v_mov_b32 v42, 0
  v_mov_b32 v43, 0
  v_mov_b32 v44, 0
  v_mov_b32 v45, 0
  v_mov_b32 v46, 0
  v_mov_b32 v47, 0
  v_mov_b32 v48, 0
  v_mov_b32 v49, 0
  v_mov_b32 v50, 0
  v_mov_b32 v51, 0
  v_mov_b32 v52, 0
  v_mov_b32 v53, 0
  v_mov_b32 v54, 0
  v_mov_b32 v55, 0
  v_mov_b32 v56, 0
  v_mov_b32 v57, 0
  v_mov_b32 v58, 0
  v_mov_b32 v59, 0
  v_mov_b32 v60, 0
  v_mov_b32 v61, 0
  v_mov_b32 v62, 0
  v_mov_b32 v63, 0
  v_mov_b32 v64, 0
  v_mov_b32 v65, 0
  v_mov_b32 v66, 0
  v_mov_b32 v67, 0
  v_mov_b32 v68, 0
  v_mov_b32 v69, 0
  v_mov_b32 v70, 0
  v_mov_b32 v71, 0
  v_mov_b32 v72, 0
  v_mov_b32 v73, 0
  v_mov_b32 v74, 0
  v_mov_b32 v75, 0
  v_mov_b32 v76, 0
  v_mov_b32 v77, 0
  v_mov_b32 v78, 0
  v_mov_b32 v79, 0
  v_mov_b32 v80, 0
  v_mov_b32 v81, 0
  v_mov_b32 v82, 0
  v_mov_b32 v83, 0
  v_mov_b32 v84, 0
  v_mov_b32 v85, 0
  v_mov_b32 v86, 0
  v_mov_b32 v87, 0
  v_mov_b32 v88, 0
  v_mov_b32 v89, 0
  v_mov_b32 v90, 0
  v_mov_b32 v91, 0
  v_mov_b32 v92, 0
  v_mov_b32 v93, 0
  v_mov_b32 v94, 0
  v_mov_b32 v95, 0
  v_mov_b32 v96, 0
  v_mov_b32 v97, 0
  v_mov_b32 v98, 0
  v_mov_b32 v99, 0
  v_mov_b32 v100, 0
  v_mov_b32 v101, 0
  v_mov_b32 v102, 0
  v_mov_b32 v103, 0
  v_mov_b32 v104, 0
  v_mov_b32 v105, 0
  s_waitcnt vmcnt(0)
  s_barrier
  ds_read_b128 v[154:157], v186 offset:0
  ds_read_b128 v[158:161], v187 offset:0
  ds_read_b128 v[162:165], v188 offset:0
  ds_read_b128 v[166:169], v189 offset:0
  s_waitcnt lgkmcnt(3)
  v_mfma_f32_32x32x16_bf16 v[106:121], v[154:157], v[10:13], 0
  ds_read_b128 v[154:157], v190 offset:0
  s_waitcnt lgkmcnt(3)
  v_mfma_f32_32x32x16_bf16 v[106:121], v[158:161], v[14:17], v[106:121]
  ds_read_b128 v[158:161], v191 offset:0
  s_waitcnt lgkmcnt(3)
  v_mfma_f32_32x32x16_bf16 v[106:121], v[162:165], v[18:21], v[106:121]
  ds_read_b128 v[162:165], v192 offset:0
  s_waitcnt lgkmcnt(3)
  v_mfma_f32_32x32x16_bf16 v[106:121], v[166:169], v[22:25], v[106:121]
  ds_read_b128 v[166:169], v193 offset:0
  s_waitcnt lgkmcnt(3)
  v_mfma_f32_32x32x16_bf16 v[106:121], v[154:157], v[26:29], v[106:121]
  ds_read_b128 v[154:157], v186 offset:8192
  s_waitcnt lgkmcnt(3)
  v_mfma_f32_32x32x16_bf16 v[106:121], v[158:161], v[30:33], v[106:121]
  ds_read_b128 v[158:161], v187 offset:8192
  s_waitcnt lgkmcnt(3)
  v_mfma_f32_32x32x16_bf16 v[106:121], v[162:165], v[34:37], v[106:121]
  ds_read_b128 v[162:165], v188 offset:8192
  s_waitcnt lgkmcnt(3)
  v_mfma_f32_32x32x16_bf16 v[106:121], v[166:169], v[38:41], v[106:121]
  ds_read_b128 v[166:169], v189 offset:8192
  s_waitcnt lgkmcnt(3)
  v_mfma_f32_32x32x16_bf16 v[122:137], v[154:157], v[10:13], 0
  ds_read_b128 v[154:157], v190 offset:8192
  s_waitcnt lgkmcnt(3)
  v_mfma_f32_32x32x16_bf16 v[122:137], v[158:161], v[14:17], v[122:137]
  ds_read_b128 v[158:161], v191 offset:8192
  s_waitcnt lgkmcnt(3)
  v_mfma_f32_32x32x16_bf16 v[122:137], v[162:165], v[18:21], v[122:137]
  ds_read_b128 v[162:165], v192 offset:8192
  s_waitcnt lgkmcnt(3)
  v_mfma_f32_32x32x16_bf16 v[122:137], v[166:169], v[22:25], v[122:137]
  ds_read_b128 v[166:169], v193 offset:8192
  s_waitcnt lgkmcnt(3)
  v_mfma_f32_32x32x16_bf16 v[122:137], v[154:157], v[26:29], v[122:137]
  s_waitcnt lgkmcnt(2)
  v_mfma_f32_32x32x16_bf16 v[122:137], v[158:161], v[30:33], v[122:137]
  s_waitcnt lgkmcnt(1)
  v_mfma_f32_32x32x16_bf16 v[122:137], v[162:165], v[34:37], v[122:137]
  s_waitcnt lgkmcnt(0)
  v_mfma_f32_32x32x16_bf16 v[122:137], v[166:169], v[38:41], v[122:137]
  s_nop 15
  s_lshl_b32 s16, s10, 1
  s_mov_b32 s15, 0
  s_cmp_ge_u32 s15, s16
  s_cbranch_scc1 a_kernel_h0_mask
a_kernel_h0_loop:
  s_barrier
  v_max3_f32 v204, v106, v107, v108
  v_max3_f32 v205, v109, v110, v111
  v_max3_f32 v204, v204, v112, v113
  v_max3_f32 v205, v205, v114, v115
  v_max3_f32 v204, v204, v116, v117
  v_max3_f32 v205, v205, v118, v119
  v_max3_f32 v204, v204, v120, v121
  v_max3_f32 v205, v205, v122, v123
  v_max3_f32 v204, v204, v124, v125
  v_max3_f32 v205, v205, v126, v127
  v_max3_f32 v204, v204, v128, v129
  v_max3_f32 v205, v205, v130, v131
  v_max3_f32 v204, v204, v132, v133
  v_max3_f32 v205, v205, v134, v135
  v_max3_f32 v204, v204, v136, v137
  v_max_f32 v204, v204, v205
  v_mov_b32 v205, v204
  s_nop 1
  v_permlane32_swap_b32 v204, v205
  v_max_f32 v204, v204, v205
  v_sub_f32 v205, v204, v200
  v_cmp_gt_f32 vcc, v205, s28
  s_cbranch_vccz a_kernel_nors_1
  s_nop 15
  s_nop 15
  s_nop 7
  v_max_f32 v204, v204, v200
  v_sub_f32 v205, v200, v204
  v_exp_f32 v205, v205
  v_mov_b32 v200, v204
  v_mul_f32 v201, v205, v201
  v_mul_f32 v42, v205, v42
  v_mul_f32 v43, v205, v43
  v_mul_f32 v44, v205, v44
  v_mul_f32 v45, v205, v45
  v_mul_f32 v46, v205, v46
  v_mul_f32 v47, v205, v47
  v_mul_f32 v48, v205, v48
  v_mul_f32 v49, v205, v49
  v_mul_f32 v50, v205, v50
  v_mul_f32 v51, v205, v51
  v_mul_f32 v52, v205, v52
  v_mul_f32 v53, v205, v53
  v_mul_f32 v54, v205, v54
  v_mul_f32 v55, v205, v55
  v_mul_f32 v56, v205, v56
  v_mul_f32 v57, v205, v57
  v_mul_f32 v58, v205, v58
  v_mul_f32 v59, v205, v59
  v_mul_f32 v60, v205, v60
  v_mul_f32 v61, v205, v61
  v_mul_f32 v62, v205, v62
  v_mul_f32 v63, v205, v63
  v_mul_f32 v64, v205, v64
  v_mul_f32 v65, v205, v65
  v_mul_f32 v66, v205, v66
  v_mul_f32 v67, v205, v67
  v_mul_f32 v68, v205, v68
  v_mul_f32 v69, v205, v69
  v_mul_f32 v70, v205, v70
  v_mul_f32 v71, v205, v71
  v_mul_f32 v72, v205, v72
  v_mul_f32 v73, v205, v73
  v_mul_f32 v74, v205, v74
  v_mul_f32 v75, v205, v75
  v_mul_f32 v76, v205, v76
  v_mul_f32 v77, v205, v77
  v_mul_f32 v78, v205, v78
  v_mul_f32 v79, v205, v79
  v_mul_f32 v80, v205, v80
  v_mul_f32 v81, v205, v81
  v_mul_f32 v82, v205, v82
  v_mul_f32 v83, v205, v83
  v_mul_f32 v84, v205, v84
  v_mul_f32 v85, v205, v85
  v_mul_f32 v86, v205, v86
  v_mul_f32 v87, v205, v87
  v_mul_f32 v88, v205, v88
  v_mul_f32 v89, v205, v89
  v_mul_f32 v90, v205, v90
  v_mul_f32 v91, v205, v91
  v_mul_f32 v92, v205, v92
  v_mul_f32 v93, v205, v93
  v_mul_f32 v94, v205, v94
  v_mul_f32 v95, v205, v95
  v_mul_f32 v96, v205, v96
  v_mul_f32 v97, v205, v97
  v_mul_f32 v98, v205, v98
  v_mul_f32 v99, v205, v99
  v_mul_f32 v100, v205, v100
  v_mul_f32 v101, v205, v101
  v_mul_f32 v102, v205, v102
  v_mul_f32 v103, v205, v103
  v_mul_f32 v104, v205, v104
  v_mul_f32 v105, v205, v105
  s_nop 1
a_kernel_nors_1:
  ds_read_b128 v[154:157], v186 offset:32768
  ds_read_b128 v[158:161], v187 offset:32768
  ds_read_b128 v[162:165], v188 offset:32768
  ds_read_b128 v[166:169], v189 offset:32768
  s_waitcnt lgkmcnt(3)
  v_mfma_f32_32x32x16_bf16 v[216:231], v[154:157], v[10:13], 0
  v_sub_f32 v106, v106, v200
  v_sub_f32 v107, v107, v200
  v_sub_f32 v108, v108, v200
  v_sub_f32 v109, v109, v200
  v_sub_f32 v110, v110, v200
  v_sub_f32 v111, v111, v200
  ds_read_b128 v[154:157], v190 offset:32768
  s_waitcnt lgkmcnt(3)
  v_mfma_f32_32x32x16_bf16 v[216:231], v[158:161], v[14:17], v[216:231]
  v_sub_f32 v112, v112, v200
  v_sub_f32 v113, v113, v200
  v_sub_f32 v114, v114, v200
  v_sub_f32 v115, v115, v200
  v_sub_f32 v116, v116, v200
  v_sub_f32 v117, v117, v200
  v_sub_f32 v118, v118, v200
  ds_read_b128 v[158:161], v191 offset:32768
  s_waitcnt lgkmcnt(3)
  v_mfma_f32_32x32x16_bf16 v[216:231], v[162:165], v[18:21], v[216:231]
  v_sub_f32 v119, v119, v200
  v_sub_f32 v120, v120, v200
  v_sub_f32 v121, v121, v200
  v_exp_f32 v106, v106
  v_exp_f32 v107, v107
  v_exp_f32 v108, v108
  ds_read_b128 v[162:165], v192 offset:32768
  s_waitcnt lgkmcnt(3)
  v_mfma_f32_32x32x16_bf16 v[216:231], v[166:169], v[22:25], v[216:231]
  v_exp_f32 v109, v109
  v_exp_f32 v110, v110
  v_exp_f32 v111, v111
  v_exp_f32 v112, v112
  v_exp_f32 v113, v113
  v_exp_f32 v114, v114
  v_exp_f32 v115, v115
  ds_read_b128 v[166:169], v193 offset:32768
  s_waitcnt lgkmcnt(3)
  v_mfma_f32_32x32x16_bf16 v[216:231], v[154:157], v[26:29], v[216:231]
  v_exp_f32 v116, v116
  v_exp_f32 v117, v117
  v_exp_f32 v118, v118
  v_exp_f32 v119, v119
  v_exp_f32 v120, v120
  v_exp_f32 v121, v121
  v_add_f32 v206, v106, v107
  ds_read_b128 v[154:157], v186 offset:40960
  s_waitcnt lgkmcnt(3)
  v_mfma_f32_32x32x16_bf16 v[216:231], v[158:161], v[30:33], v[216:231]
  v_add_f32 v207, v108, v109
  v_add_f32 v206, v206, v110
  v_add_f32 v207, v207, v111
  v_add_f32 v206, v206, v112
  v_add_f32 v207, v207, v113
  v_add_f32 v206, v206, v114
  ds_read_b128 v[158:161], v187 offset:40960
  s_waitcnt lgkmcnt(3)
  v_mfma_f32_32x32x16_bf16 v[216:231], v[162:165], v[34:37], v[216:231]
  v_add_f32 v207, v207, v115
  v_add_f32 v206, v206, v116
  v_add_f32 v207, v207, v117
  v_add_f32 v206, v206, v118
  v_add_f32 v207, v207, v119
  v_add_f32 v206, v206, v120
  v_add_f32 v207, v207, v121
  ds_read_b128 v[162:165], v188 offset:40960
  s_waitcnt lgkmcnt(3)
  v_mfma_f32_32x32x16_bf16 v[216:231], v[166:169], v[38:41], v[216:231]
  v_cvt_pk_bf16_f32 v138, v106, v107
  v_cvt_pk_bf16_f32 v139, v108, v109
  v_cvt_pk_bf16_f32 v140, v110, v111
  v_cvt_pk_bf16_f32 v141, v112, v113
  v_cvt_pk_bf16_f32 v142, v114, v115
  v_cvt_pk_bf16_f32 v143, v116, v117
  v_cvt_pk_bf16_f32 v144, v118, v119
  v_cvt_pk_bf16_f32 v145, v120, v121
  v_add_f32 v206, v206, v207
  v_add_f32 v201, v201, v206
  ds_read_b128 v[166:169], v189 offset:40960
  s_waitcnt lgkmcnt(3)
  v_mfma_f32_32x32x16_bf16 v[232:247], v[154:157], v[10:13], 0
  v_sub_f32 v122, v122, v200
  v_sub_f32 v123, v123, v200
  v_sub_f32 v124, v124, v200
  v_sub_f32 v125, v125, v200
  v_sub_f32 v126, v126, v200
  v_sub_f32 v127, v127, v200
  ds_read_b128 v[154:157], v190 offset:40960
  s_waitcnt lgkmcnt(3)
  v_mfma_f32_32x32x16_bf16 v[232:247], v[158:161], v[14:17], v[232:247]
  v_sub_f32 v128, v128, v200
  v_sub_f32 v129, v129, v200
  v_sub_f32 v130, v130, v200
  v_sub_f32 v131, v131, v200
  v_sub_f32 v132, v132, v200
  v_sub_f32 v133, v133, v200
  v_sub_f32 v134, v134, v200
  ds_read_b128 v[158:161], v191 offset:40960
  s_waitcnt lgkmcnt(3)
  v_mfma_f32_32x32x16_bf16 v[232:247], v[162:165], v[18:21], v[232:247]
  v_sub_f32 v135, v135, v200
  v_sub_f32 v136, v136, v200
  v_sub_f32 v137, v137, v200
  v_exp_f32 v122, v122
  v_exp_f32 v123, v123
  v_exp_f32 v124, v124
  ds_read_b128 v[162:165], v192 offset:40960
  s_waitcnt lgkmcnt(3)
  v_mfma_f32_32x32x16_bf16 v[232:247], v[166:169], v[22:25], v[232:247]
  v_exp_f32 v125, v125
  v_exp_f32 v126, v126
  v_exp_f32 v127, v127
  v_exp_f32 v128, v128
  v_exp_f32 v129, v129
  v_exp_f32 v130, v130
  v_exp_f32 v131, v131
  ds_read_b128 v[166:169], v193 offset:40960
  s_waitcnt lgkmcnt(3)
  v_mfma_f32_32x32x16_bf16 v[232:247], v[154:157], v[26:29], v[232:247]
  v_exp_f32 v132, v132
  v_exp_f32 v133, v133
  v_exp_f32 v134, v134
  v_exp_f32 v135, v135
  v_exp_f32 v136, v136
  v_exp_f32 v137, v137
  v_add_f32 v206, v122, v123
  s_waitcnt lgkmcnt(2)
  v_mfma_f32_32x32x16_bf16 v[232:247], v[158:161], v[30:33], v[232:247]
  v_add_f32 v207, v124, v125
  v_add_f32 v206, v206, v126
  v_add_f32 v207, v207, v127
  v_add_f32 v206, v206, v128
  v_add_f32 v207, v207, v129
  v_add_f32 v206, v206, v130
  s_waitcnt lgkmcnt(1)
  v_mfma_f32_32x32x16_bf16 v[232:247], v[162:165], v[34:37], v[232:247]
  v_add_f32 v207, v207, v131
  v_add_f32 v206, v206, v132
  v_add_f32 v207, v207, v133
  v_add_f32 v206, v206, v134
  v_add_f32 v207, v207, v135
  v_add_f32 v206, v206, v136
  v_add_f32 v207, v207, v137
  s_waitcnt lgkmcnt(0)
  v_mfma_f32_32x32x16_bf16 v[232:247], v[166:169], v[38:41], v[232:247]
  v_cvt_pk_bf16_f32 v146, v122, v123
  v_cvt_pk_bf16_f32 v147, v124, v125
  v_cvt_pk_bf16_f32 v148, v126, v127
  v_cvt_pk_bf16_f32 v149, v128, v129
  v_cvt_pk_bf16_f32 v150, v130, v131
  v_cvt_pk_bf16_f32 v151, v132, v133
  v_cvt_pk_bf16_f32 v152, v134, v135
  v_cvt_pk_bf16_f32 v153, v136, v137
  v_add_f32 v206, v206, v207
  v_add_f32 v201, v201, v206
  s_nop 1
  ds_read_b64_tr_b16 v[154:155], v194 offset:16384
  ds_read_b64_tr_b16 v[156:157], v194 offset:18432
  ds_read_b64_tr_b16 v[158:159], v195 offset:16384
  ds_read_b64_tr_b16 v[160:161], v195 offset:18432
  ds_read_b64_tr_b16 v[162:163], v196 offset:16384
  ds_read_b64_tr_b16 v[164:165], v196 offset:18432
  ds_read_b64_tr_b16 v[166:167], v197 offset:16384
  ds_read_b64_tr_b16 v[168:169], v197 offset:18432
  ds_read_b64_tr_b16 v[170:171], v194 offset:20480
  ds_read_b64_tr_b16 v[172:173], v194 offset:22528
  ds_read_b64_tr_b16 v[174:175], v195 offset:20480
  ds_read_b64_tr_b16 v[176:177], v195 offset:22528
  ds_read_b64_tr_b16 v[178:179], v196 offset:20480
  ds_read_b64_tr_b16 v[180:181], v196 offset:22528
  ds_read_b64_tr_b16 v[182:183], v197 offset:20480
  ds_read_b64_tr_b16 v[184:185], v197 offset:22528
  s_waitcnt lgkmcnt(14)
  v_mfma_f32_32x32x16_bf16 v[42:57], v[154:157], v[138:141], v[42:57]
  ds_read_b64_tr_b16 v[154:155], v194 offset:24576
  ds_read_b64_tr_b16 v[156:157], v194 offset:26624
  s_waitcnt lgkmcnt(14)
  v_mfma_f32_32x32x16_bf16 v[58:73], v[158:161], v[138:141], v[58:73]
  ds_read_b64_tr_b16 v[158:159], v195 offset:24576
  ds_read_b64_tr_b16 v[160:161], v195 offset:26624
  s_waitcnt lgkmcnt(14)
  v_mfma_f32_32x32x16_bf16 v[74:89], v[162:165], v[138:141], v[74:89]
  ds_read_b64_tr_b16 v[162:163], v196 offset:24576
  ds_read_b64_tr_b16 v[164:165], v196 offset:26624
  s_waitcnt lgkmcnt(14)
  v_mfma_f32_32x32x16_bf16 v[90:105], v[166:169], v[138:141], v[90:105]
  ds_read_b64_tr_b16 v[166:167], v197 offset:24576
  ds_read_b64_tr_b16 v[168:169], v197 offset:26624
  s_waitcnt lgkmcnt(14)
  v_mfma_f32_32x32x16_bf16 v[42:57], v[170:173], v[142:145], v[42:57]
  ds_read_b64_tr_b16 v[170:171], v194 offset:28672
  ds_read_b64_tr_b16 v[172:173], v194 offset:30720
  s_waitcnt lgkmcnt(14)
  v_mfma_f32_32x32x16_bf16 v[58:73], v[174:177], v[142:145], v[58:73]
  ds_read_b64_tr_b16 v[174:175], v195 offset:28672
  ds_read_b64_tr_b16 v[176:177], v195 offset:30720
  s_waitcnt lgkmcnt(14)
  v_mfma_f32_32x32x16_bf16 v[74:89], v[178:181], v[142:145], v[74:89]
  ds_read_b64_tr_b16 v[178:179], v196 offset:28672
  ds_read_b64_tr_b16 v[180:181], v196 offset:30720
  s_waitcnt lgkmcnt(14)
  v_mfma_f32_32x32x16_bf16 v[90:105], v[182:185], v[142:145], v[90:105]
  ds_read_b64_tr_b16 v[182:183], v197 offset:28672
  ds_read_b64_tr_b16 v[184:185], v197 offset:30720
  s_waitcnt lgkmcnt(14)
  v_mfma_f32_32x32x16_bf16 v[42:57], v[154:157], v[146:149], v[42:57]
  s_waitcnt lgkmcnt(12)
  v_mfma_f32_32x32x16_bf16 v[58:73], v[158:161], v[146:149], v[58:73]
  s_waitcnt lgkmcnt(10)
  v_mfma_f32_32x32x16_bf16 v[74:89], v[162:165], v[146:149], v[74:89]
  s_waitcnt lgkmcnt(8)
  v_mfma_f32_32x32x16_bf16 v[90:105], v[166:169], v[146:149], v[90:105]
  s_waitcnt lgkmcnt(6)
  v_mfma_f32_32x32x16_bf16 v[42:57], v[170:173], v[150:153], v[42:57]
  s_waitcnt lgkmcnt(4)
  v_mfma_f32_32x32x16_bf16 v[58:73], v[174:177], v[150:153], v[58:73]
  s_waitcnt lgkmcnt(2)
  v_mfma_f32_32x32x16_bf16 v[74:89], v[178:181], v[150:153], v[74:89]
  s_waitcnt lgkmcnt(0)
  v_mfma_f32_32x32x16_bf16 v[90:105], v[182:185], v[150:153], v[90:105]
  s_barrier
  v_max3_f32 v204, v216, v217, v218
  v_max3_f32 v205, v219, v220, v221
  v_max3_f32 v204, v204, v222, v223
  v_max3_f32 v205, v205, v224, v225
  v_max3_f32 v204, v204, v226, v227
  v_max3_f32 v205, v205, v228, v229
  v_max3_f32 v204, v204, v230, v231
  v_max3_f32 v205, v205, v232, v233
  v_max3_f32 v204, v204, v234, v235
  v_max3_f32 v205, v205, v236, v237
  v_max3_f32 v204, v204, v238, v239
  v_max3_f32 v205, v205, v240, v241
  v_max3_f32 v204, v204, v242, v243
  v_max3_f32 v205, v205, v244, v245
  v_max3_f32 v204, v204, v246, v247
  v_max_f32 v204, v204, v205
  v_mov_b32 v205, v204
  s_nop 1
  v_permlane32_swap_b32 v204, v205
  v_max_f32 v204, v204, v205
  v_sub_f32 v205, v204, v200
  v_cmp_gt_f32 vcc, v205, s28
  s_cbranch_vccz a_kernel_nors_2
  s_nop 15
  s_nop 15
  s_nop 7
  v_max_f32 v204, v204, v200
  v_sub_f32 v205, v200, v204
  v_exp_f32 v205, v205
  v_mov_b32 v200, v204
  v_mul_f32 v201, v205, v201
  v_mul_f32 v42, v205, v42
  v_mul_f32 v43, v205, v43
  v_mul_f32 v44, v205, v44
  v_mul_f32 v45, v205, v45
  v_mul_f32 v46, v205, v46
  v_mul_f32 v47, v205, v47
  v_mul_f32 v48, v205, v48
  v_mul_f32 v49, v205, v49
  v_mul_f32 v50, v205, v50
  v_mul_f32 v51, v205, v51
  v_mul_f32 v52, v205, v52
  v_mul_f32 v53, v205, v53
  v_mul_f32 v54, v205, v54
  v_mul_f32 v55, v205, v55
  v_mul_f32 v56, v205, v56
  v_mul_f32 v57, v205, v57
  v_mul_f32 v58, v205, v58
  v_mul_f32 v59, v205, v59
  v_mul_f32 v60, v205, v60
  v_mul_f32 v61, v205, v61
  v_mul_f32 v62, v205, v62
  v_mul_f32 v63, v205, v63
  v_mul_f32 v64, v205, v64
  v_mul_f32 v65, v205, v65
  v_mul_f32 v66, v205, v66
  v_mul_f32 v67, v205, v67
  v_mul_f32 v68, v205, v68
  v_mul_f32 v69, v205, v69
  v_mul_f32 v70, v205, v70
  v_mul_f32 v71, v205, v71
  v_mul_f32 v72, v205, v72
  v_mul_f32 v73, v205, v73
  v_mul_f32 v74, v205, v74
  v_mul_f32 v75, v205, v75
  v_mul_f32 v76, v205, v76
  v_mul_f32 v77, v205, v77
  v_mul_f32 v78, v205, v78
  v_mul_f32 v79, v205, v79
  v_mul_f32 v80, v205, v80
  v_mul_f32 v81, v205, v81
  v_mul_f32 v82, v205, v82
  v_mul_f32 v83, v205, v83
  v_mul_f32 v84, v205, v84
  v_mul_f32 v85, v205, v85
  v_mul_f32 v86, v205, v86
  v_mul_f32 v87, v205, v87
  v_mul_f32 v88, v205, v88
  v_mul_f32 v89, v205, v89
  v_mul_f32 v90, v205, v90
  v_mul_f32 v91, v205, v91
  v_mul_f32 v92, v205, v92
  v_mul_f32 v93, v205, v93
  v_mul_f32 v94, v205, v94
  v_mul_f32 v95, v205, v95
  v_mul_f32 v96, v205, v96
  v_mul_f32 v97, v205, v97
  v_mul_f32 v98, v205, v98
  v_mul_f32 v99, v205, v99
  v_mul_f32 v100, v205, v100
  v_mul_f32 v101, v205, v101
  v_mul_f32 v102, v205, v102
  v_mul_f32 v103, v205, v103
  v_mul_f32 v104, v205, v104
  v_mul_f32 v105, v205, v105
  s_nop 1
a_kernel_nors_2:
  ds_read_b128 v[154:157], v186 offset:0
  ds_read_b128 v[158:161], v187 offset:0
  ds_read_b128 v[162:165], v188 offset:0
  ds_read_b128 v[166:169], v189 offset:0
  s_waitcnt lgkmcnt(3)
  v_mfma_f32_32x32x16_bf16 v[106:121], v[154:157], v[10:13], 0
  v_sub_f32 v216, v216, v200
  v_sub_f32 v217, v217, v200
  v_sub_f32 v218, v218, v200
  v_sub_f32 v219, v219, v200
  v_sub_f32 v220, v220, v200
  v_sub_f32 v221, v221, v200
  ds_read_b128 v[154:157], v190 offset:0
  s_waitcnt lgkmcnt(3)
  v_mfma_f32_32x32x16_bf16 v[106:121], v[158:161], v[14:17], v[106:121]
  v_sub_f32 v222, v222, v200
  v_sub_f32 v223, v223, v200
  v_sub_f32 v224, v224, v200
  v_sub_f32 v225, v225, v200
  v_sub_f32 v226, v226, v200
  v_sub_f32 v227, v227, v200
  v_sub_f32 v228, v228, v200
  ds_read_b128 v[158:161], v191 offset:0
  s_waitcnt lgkmcnt(3)
  v_mfma_f32_32x32x16_bf16 v[106:121], v[162:165], v[18:21], v[106:121]
  v_sub_f32 v229, v229, v200
  v_sub_f32 v230, v230, v200
  v_sub_f32 v231, v231, v200
  v_exp_f32 v216, v216
  v_exp_f32 v217, v217
  v_exp_f32 v218, v218
  ds_read_b128 v[162:165], v192 offset:0
  s_waitcnt lgkmcnt(3)
  v_mfma_f32_32x32x16_bf16 v[106:121], v[166:169], v[22:25], v[106:121]
  v_exp_f32 v219, v219
  v_exp_f32 v220, v220
  v_exp_f32 v221, v221
  v_exp_f32 v222, v222
  v_exp_f32 v223, v223
  v_exp_f32 v224, v224
  v_exp_f32 v225, v225
  ds_read_b128 v[166:169], v193 offset:0
  s_waitcnt lgkmcnt(3)
  v_mfma_f32_32x32x16_bf16 v[106:121], v[154:157], v[26:29], v[106:121]
  v_exp_f32 v226, v226
  v_exp_f32 v227, v227
  v_exp_f32 v228, v228
  v_exp_f32 v229, v229
  v_exp_f32 v230, v230
  v_exp_f32 v231, v231
  v_add_f32 v206, v216, v217
  ds_read_b128 v[154:157], v186 offset:8192
  s_waitcnt lgkmcnt(3)
  v_mfma_f32_32x32x16_bf16 v[106:121], v[158:161], v[30:33], v[106:121]
  v_add_f32 v207, v218, v219
  v_add_f32 v206, v206, v220
  v_add_f32 v207, v207, v221
  v_add_f32 v206, v206, v222
  v_add_f32 v207, v207, v223
  v_add_f32 v206, v206, v224
  ds_read_b128 v[158:161], v187 offset:8192
  s_waitcnt lgkmcnt(3)
  v_mfma_f32_32x32x16_bf16 v[106:121], v[162:165], v[34:37], v[106:121]
  v_add_f32 v207, v207, v225
  v_add_f32 v206, v206, v226
  v_add_f32 v207, v207, v227
  v_add_f32 v206, v206, v228
  v_add_f32 v207, v207, v229
  v_add_f32 v206, v206, v230
  v_add_f32 v207, v207, v231
  ds_read_b128 v[162:165], v188 offset:8192
  s_waitcnt lgkmcnt(3)
  v_mfma_f32_32x32x16_bf16 v[106:121], v[166:169], v[38:41], v[106:121]
  v_cvt_pk_bf16_f32 v138, v216, v217
  v_cvt_pk_bf16_f32 v139, v218, v219
  v_cvt_pk_bf16_f32 v140, v220, v221
  v_cvt_pk_bf16_f32 v141, v222, v223
  v_cvt_pk_bf16_f32 v142, v224, v225
  v_cvt_pk_bf16_f32 v143, v226, v227
  v_cvt_pk_bf16_f32 v144, v228, v229
  v_cvt_pk_bf16_f32 v145, v230, v231
  v_add_f32 v206, v206, v207
  v_add_f32 v201, v201, v206
  ds_read_b128 v[166:169], v189 offset:8192
  s_waitcnt lgkmcnt(3)
  v_mfma_f32_32x32x16_bf16 v[122:137], v[154:157], v[10:13], 0
  v_sub_f32 v232, v232, v200
  v_sub_f32 v233, v233, v200
  v_sub_f32 v234, v234, v200
  v_sub_f32 v235, v235, v200
  v_sub_f32 v236, v236, v200
  v_sub_f32 v237, v237, v200
  ds_read_b128 v[154:157], v190 offset:8192
  s_waitcnt lgkmcnt(3)
  v_mfma_f32_32x32x16_bf16 v[122:137], v[158:161], v[14:17], v[122:137]
  v_sub_f32 v238, v238, v200
  v_sub_f32 v239, v239, v200
  v_sub_f32 v240, v240, v200
  v_sub_f32 v241, v241, v200
  v_sub_f32 v242, v242, v200
  v_sub_f32 v243, v243, v200
  v_sub_f32 v244, v244, v200
  ds_read_b128 v[158:161], v191 offset:8192
  s_waitcnt lgkmcnt(3)
  v_mfma_f32_32x32x16_bf16 v[122:137], v[162:165], v[18:21], v[122:137]
  v_sub_f32 v245, v245, v200
  v_sub_f32 v246, v246, v200
  v_sub_f32 v247, v247, v200
  v_exp_f32 v232, v232
  v_exp_f32 v233, v233
  v_exp_f32 v234, v234
  ds_read_b128 v[162:165], v192 offset:8192
  s_waitcnt lgkmcnt(3)
  v_mfma_f32_32x32x16_bf16 v[122:137], v[166:169], v[22:25], v[122:137]
  v_exp_f32 v235, v235
  v_exp_f32 v236, v236
  v_exp_f32 v237, v237
  v_exp_f32 v238, v238
  v_exp_f32 v239, v239
  v_exp_f32 v240, v240
  v_exp_f32 v241, v241
  ds_read_b128 v[166:169], v193 offset:8192
  s_waitcnt lgkmcnt(3)
  v_mfma_f32_32x32x16_bf16 v[122:137], v[154:157], v[26:29], v[122:137]
  v_exp_f32 v242, v242
  v_exp_f32 v243, v243
  v_exp_f32 v244, v244
  v_exp_f32 v245, v245
  v_exp_f32 v246, v246
  v_exp_f32 v247, v247
  v_add_f32 v206, v232, v233
  s_waitcnt lgkmcnt(2)
  v_mfma_f32_32x32x16_bf16 v[122:137], v[158:161], v[30:33], v[122:137]
  v_add_f32 v207, v234, v235
  v_add_f32 v206, v206, v236
  v_add_f32 v207, v207, v237
  v_add_f32 v206, v206, v238
  v_add_f32 v207, v207, v239
  v_add_f32 v206, v206, v240
  s_waitcnt lgkmcnt(1)
  v_mfma_f32_32x32x16_bf16 v[122:137], v[162:165], v[34:37], v[122:137]
  v_add_f32 v207, v207, v241
  v_add_f32 v206, v206, v242
  v_add_f32 v207, v207, v243
  v_add_f32 v206, v206, v244
  v_add_f32 v207, v207, v245
  v_add_f32 v206, v206, v246
  v_add_f32 v207, v207, v247
  s_waitcnt lgkmcnt(0)
  v_mfma_f32_32x32x16_bf16 v[122:137], v[166:169], v[38:41], v[122:137]
  v_cvt_pk_bf16_f32 v146, v232, v233
  v_cvt_pk_bf16_f32 v147, v234, v235
  v_cvt_pk_bf16_f32 v148, v236, v237
  v_cvt_pk_bf16_f32 v149, v238, v239
  v_cvt_pk_bf16_f32 v150, v240, v241
  v_cvt_pk_bf16_f32 v151, v242, v243
  v_cvt_pk_bf16_f32 v152, v244, v245
  v_cvt_pk_bf16_f32 v153, v246, v247
  v_add_f32 v206, v206, v207
  v_add_f32 v201, v201, v206
  s_nop 1
  ds_read_b64_tr_b16 v[154:155], v194 offset:49152
  ds_read_b64_tr_b16 v[156:157], v194 offset:51200
  ds_read_b64_tr_b16 v[158:159], v195 offset:49152
  ds_read_b64_tr_b16 v[160:161], v195 offset:51200
  ds_read_b64_tr_b16 v[162:163], v196 offset:49152
  ds_read_b64_tr_b16 v[164:165], v196 offset:51200
  ds_read_b64_tr_b16 v[166:167], v197 offset:49152
  ds_read_b64_tr_b16 v[168:169], v197 offset:51200
  ds_read_b64_tr_b16 v[170:171], v194 offset:53248
  ds_read_b64_tr_b16 v[172:173], v194 offset:55296
  ds_read_b64_tr_b16 v[174:175], v195 offset:53248
  ds_read_b64_tr_b16 v[176:177], v195 offset:55296
  ds_read_b64_tr_b16 v[178:179], v196 offset:53248
  ds_read_b64_tr_b16 v[180:181], v196 offset:55296
  ds_read_b64_tr_b16 v[182:183], v197 offset:53248
  ds_read_b64_tr_b16 v[184:185], v197 offset:55296
  s_waitcnt lgkmcnt(14)
  v_mfma_f32_32x32x16_bf16 v[42:57], v[154:157], v[138:141], v[42:57]
  ds_read_b64_tr_b16 v[154:155], v194 offset:57344
  ds_read_b64_tr_b16 v[156:157], v194 offset:59392
  s_waitcnt lgkmcnt(14)
  v_mfma_f32_32x32x16_bf16 v[58:73], v[158:161], v[138:141], v[58:73]
  ds_read_b64_tr_b16 v[158:159], v195 offset:57344
  ds_read_b64_tr_b16 v[160:161], v195 offset:59392
  s_waitcnt lgkmcnt(14)
  v_mfma_f32_32x32x16_bf16 v[74:89], v[162:165], v[138:141], v[74:89]
  ds_read_b64_tr_b16 v[162:163], v196 offset:57344
  ds_read_b64_tr_b16 v[164:165], v196 offset:59392
  s_waitcnt lgkmcnt(14)
  v_mfma_f32_32x32x16_bf16 v[90:105], v[166:169], v[138:141], v[90:105]
  ds_read_b64_tr_b16 v[166:167], v197 offset:57344
  ds_read_b64_tr_b16 v[168:169], v197 offset:59392
  s_waitcnt lgkmcnt(14)
  v_mfma_f32_32x32x16_bf16 v[42:57], v[170:173], v[142:145], v[42:57]
  ds_read_b64_tr_b16 v[170:171], v194 offset:61440
  ds_read_b64_tr_b16 v[172:173], v194 offset:63488
  s_waitcnt lgkmcnt(14)
  v_mfma_f32_32x32x16_bf16 v[58:73], v[174:177], v[142:145], v[58:73]
  ds_read_b64_tr_b16 v[174:175], v195 offset:61440
  ds_read_b64_tr_b16 v[176:177], v195 offset:63488
  s_waitcnt lgkmcnt(14)
  v_mfma_f32_32x32x16_bf16 v[74:89], v[178:181], v[142:145], v[74:89]
  ds_read_b64_tr_b16 v[178:179], v196 offset:61440
  ds_read_b64_tr_b16 v[180:181], v196 offset:63488
  s_waitcnt lgkmcnt(14)
  v_mfma_f32_32x32x16_bf16 v[90:105], v[182:185], v[142:145], v[90:105]
  ds_read_b64_tr_b16 v[182:183], v197 offset:61440
  ds_read_b64_tr_b16 v[184:185], v197 offset:63488
  s_waitcnt lgkmcnt(14)
  v_mfma_f32_32x32x16_bf16 v[42:57], v[154:157], v[146:149], v[42:57]
  s_waitcnt lgkmcnt(12)
  v_mfma_f32_32x32x16_bf16 v[58:73], v[158:161], v[146:149], v[58:73]
  s_waitcnt lgkmcnt(10)
  v_mfma_f32_32x32x16_bf16 v[74:89], v[162:165], v[146:149], v[74:89]
  s_waitcnt lgkmcnt(8)
  v_mfma_f32_32x32x16_bf16 v[90:105], v[166:169], v[146:149], v[90:105]
  s_waitcnt lgkmcnt(6)
  v_mfma_f32_32x32x16_bf16 v[42:57], v[170:173], v[150:153], v[42:57]
  s_waitcnt lgkmcnt(4)
  v_mfma_f32_32x32x16_bf16 v[58:73], v[174:177], v[150:153], v[58:73]
  s_waitcnt lgkmcnt(2)
  v_mfma_f32_32x32x16_bf16 v[74:89], v[178:181], v[150:153], v[74:89]
  s_waitcnt lgkmcnt(0)
  v_mfma_f32_32x32x16_bf16 v[90:105], v[182:185], v[150:153], v[90:105]
  s_add_u32 s15, s15, 2
  s_cmp_lt_u32 s15, s16
  s_cbranch_scc1 a_kernel_h0_loop
a_kernel_h0_mask:
  s_lshl_b32 s17, s10, 7
  v_subrev_u32 v202, s17, v202
  s_barrier
  v_cmp_lt_i32 vcc, v202, 0
  s_nop 1
  v_cndmask_b32 v106, v106, v203, vcc
  v_cmp_lt_i32 vcc, v202, 1
  s_nop 1
  v_cndmask_b32 v107, v107, v203, vcc
  v_cmp_lt_i32 vcc, v202, 2
  s_nop 1
  v_cndmask_b32 v108, v108, v203, vcc
  v_cmp_lt_i32 vcc, v202, 3
  s_nop 1
  v_cndmask_b32 v109, v109, v203, vcc
  v_cmp_lt_i32 vcc, v202, 8
  s_nop 1
  v_cndmask_b32 v110, v110, v203, vcc
  v_cmp_lt_i32 vcc, v202, 9
  s_nop 1
  v_cndmask_b32 v111, v111, v203, vcc
  v_cmp_lt_i32 vcc, v202, 10
  s_nop 1
  v_cndmask_b32 v112, v112, v203, vcc
  v_cmp_lt_i32 vcc, v202, 11
  s_nop 1
  v_cndmask_b32 v113, v113, v203, vcc
  v_cmp_lt_i32 vcc, v202, 16
  s_nop 1
  v_cndmask_b32 v114, v114, v203, vcc
  v_cmp_lt_i32 vcc, v202, 17
  s_nop 1
  v_cndmask_b32 v115, v115, v203, vcc
  v_cmp_lt_i32 vcc, v202, 18
  s_nop 1
  v_cndmask_b32 v116, v116, v203, vcc
  v_cmp_lt_i32 vcc, v202, 19
  s_nop 1
  v_cndmask_b32 v117, v117, v203, vcc
  v_cmp_lt_i32 vcc, v202, 24
  s_nop 1
  v_cndmask_b32 v118, v118, v203, vcc
  v_cmp_lt_i32 vcc, v202, 25
  s_nop 1
  v_cndmask_b32 v119, v119, v203, vcc
  v_cmp_lt_i32 vcc, v202, 26
  s_nop 1
  v_cndmask_b32 v120, v120, v203, vcc
  v_cmp_lt_i32 vcc, v202, 27
  s_nop 1
  v_cndmask_b32 v121, v121, v203, vcc
  v_cmp_lt_i32 vcc, v202, 32
  s_nop 1
  v_cndmask_b32 v122, v122, v203, vcc
  v_cmp_lt_i32 vcc, v202, 33
  s_nop 1
  v_cndmask_b32 v123, v123, v203, vcc
  v_cmp_lt_i32 vcc, v202, 34
  s_nop 1
  v_cndmask_b32 v124, v124, v203, vcc
  v_cmp_lt_i32 vcc, v202, 35
  s_nop 1
  v_cndmask_b32 v125, v125, v203, vcc
  v_cmp_lt_i32 vcc, v202, 40
  s_nop 1
  v_cndmask_b32 v126, v126, v203, vcc
  v_cmp_lt_i32 vcc, v202, 41
  s_nop 1
  v_cndmask_b32 v127, v127, v203, vcc
  v_cmp_lt_i32 vcc, v202, 42
  s_nop 1
  v_cndmask_b32 v128, v128, v203, vcc
  v_cmp_lt_i32 vcc, v202, 43
  s_nop 1
  v_cndmask_b32 v129, v129, v203, vcc
  v_cmp_lt_i32 vcc, v202, 48
  s_nop 1
  v_cndmask_b32 v130, v130, v203, vcc
  v_cmp_lt_i32 vcc, v202, 49
  s_nop 1
  v_cndmask_b32 v131, v131, v203, vcc
  v_cmp_lt_i32 vcc, v202, 50
  s_nop 1
  v_cndmask_b32 v132, v132, v203, vcc
  v_cmp_lt_i32 vcc, v202, 51
  s_nop 1
  v_cndmask_b32 v133, v133, v203, vcc
  v_cmp_lt_i32 vcc, v202, 56
  s_nop 1
  v_cndmask_b32 v134, v134, v203, vcc
  v_cmp_lt_i32 vcc, v202, 57
  s_nop 1
  v_cndmask_b32 v135, v135, v203, vcc
  v_cmp_lt_i32 vcc, v202, 58
  s_nop 1
  v_cndmask_b32 v136, v136, v203, vcc
  v_cmp_lt_i32 vcc, v202, 59
  s_nop 1
  v_cndmask_b32 v137, v137, v203, vcc
  v_max3_f32 v204, v106, v107, v108
  v_max3_f32 v205, v109, v110, v111
  v_max3_f32 v204, v204, v112, v113
  v_max3_f32 v205, v205, v114, v115
  v_max3_f32 v204, v204, v116, v117
  v_max3_f32 v205, v205, v118, v119
  v_max3_f32 v204, v204, v120, v121
  v_max3_f32 v205, v205, v122, v123
  v_max3_f32 v204, v204, v124, v125
  v_max3_f32 v205, v205, v126, v127
  v_max3_f32 v204, v204, v128, v129
  v_max3_f32 v205, v205, v130, v131
  v_max3_f32 v204, v204, v132, v133
  v_max3_f32 v205, v205, v134, v135
  v_max3_f32 v204, v204, v136, v137
  v_max_f32 v204, v204, v205
  v_mov_b32 v205, v204
  s_nop 1
  v_permlane32_swap_b32 v204, v205
  v_max_f32 v204, v204, v205
  v_sub_f32 v205, v204, v200
  v_cmp_gt_f32 vcc, v205, s28
  s_cbranch_vccz a_kernel_nors_3
  s_nop 15
  s_nop 15
  s_nop 7
  v_max_f32 v204, v204, v200
  v_sub_f32 v205, v200, v204
  v_exp_f32 v205, v205
  v_mov_b32 v200, v204
  v_mul_f32 v201, v205, v201
  v_mul_f32 v42, v205, v42
  v_mul_f32 v43, v205, v43
  v_mul_f32 v44, v205, v44
  v_mul_f32 v45, v205, v45
  v_mul_f32 v46, v205, v46
  v_mul_f32 v47, v205, v47
  v_mul_f32 v48, v205, v48
  v_mul_f32 v49, v205, v49
  v_mul_f32 v50, v205, v50
  v_mul_f32 v51, v205, v51
  v_mul_f32 v52, v205, v52
  v_mul_f32 v53, v205, v53
  v_mul_f32 v54, v205, v54
  v_mul_f32 v55, v205, v55
  v_mul_f32 v56, v205, v56
  v_mul_f32 v57, v205, v57
  v_mul_f32 v58, v205, v58
  v_mul_f32 v59, v205, v59
  v_mul_f32 v60, v205, v60
  v_mul_f32 v61, v205, v61
  v_mul_f32 v62, v205, v62
  v_mul_f32 v63, v205, v63
  v_mul_f32 v64, v205, v64
  v_mul_f32 v65, v205, v65
  v_mul_f32 v66, v205, v66
  v_mul_f32 v67, v205, v67
  v_mul_f32 v68, v205, v68
  v_mul_f32 v69, v205, v69
  v_mul_f32 v70, v205, v70
  v_mul_f32 v71, v205, v71
  v_mul_f32 v72, v205, v72
  v_mul_f32 v73, v205, v73
  v_mul_f32 v74, v205, v74
  v_mul_f32 v75, v205, v75
  v_mul_f32 v76, v205, v76
  v_mul_f32 v77, v205, v77
  v_mul_f32 v78, v205, v78
  v_mul_f32 v79, v205, v79
  v_mul_f32 v80, v205, v80
  v_mul_f32 v81, v205, v81
  v_mul_f32 v82, v205, v82
  v_mul_f32 v83, v205, v83
  v_mul_f32 v84, v205, v84
  v_mul_f32 v85, v205, v85
  v_mul_f32 v86, v205, v86
  v_mul_f32 v87, v205, v87
  v_mul_f32 v88, v205, v88
  v_mul_f32 v89, v205, v89
  v_mul_f32 v90, v205, v90
  v_mul_f32 v91, v205, v91
  v_mul_f32 v92, v205, v92
  v_mul_f32 v93, v205, v93
  v_mul_f32 v94, v205, v94
  v_mul_f32 v95, v205, v95
  v_mul_f32 v96, v205, v96
  v_mul_f32 v97, v205, v97
  v_mul_f32 v98, v205, v98
  v_mul_f32 v99, v205, v99
  v_mul_f32 v100, v205, v100
  v_mul_f32 v101, v205, v101
  v_mul_f32 v102, v205, v102
  v_mul_f32 v103, v205, v103
  v_mul_f32 v104, v205, v104
  v_mul_f32 v105, v205, v105
  s_nop 1
a_kernel_nors_3:
  ds_read_b128 v[154:157], v186 offset:32768
  ds_read_b128 v[158:161], v187 offset:32768
  ds_read_b128 v[162:165], v188 offset:32768
  ds_read_b128 v[166:169], v189 offset:32768
  s_waitcnt lgkmcnt(3)
  v_mfma_f32_32x32x16_bf16 v[216:231], v[154:157], v[10:13], 0
  v_sub_f32 v106, v106, v200
  v_sub_f32 v107, v107, v200
  v_sub_f32 v108, v108, v200
  v_sub_f32 v109, v109, v200
  v_sub_f32 v110, v110, v200
  v_sub_f32 v111, v111, v200
  ds_read_b128 v[154:157], v190 offset:32768
  s_waitcnt lgkmcnt(3)
  v_mfma_f32_32x32x16_bf16 v[216:231], v[158:161], v[14:17], v[216:231]
  v_sub_f32 v112, v112, v200
  v_sub_f32 v113, v113, v200
  v_sub_f32 v114, v114, v200
  v_sub_f32 v115, v115, v200
  v_sub_f32 v116, v116, v200
  v_sub_f32 v117, v117, v200
  v_sub_f32 v118, v118, v200
  ds_read_b128 v[158:161], v191 offset:32768
  s_waitcnt lgkmcnt(3)
  v_mfma_f32_32x32x16_bf16 v[216:231], v[162:165], v[18:21], v[216:231]
  v_sub_f32 v119, v119, v200
  v_sub_f32 v120, v120, v200
  v_sub_f32 v121, v121, v200
  v_exp_f32 v106, v106
  v_exp_f32 v107, v107
  v_exp_f32 v108, v108
  ds_read_b128 v[162:165], v192 offset:32768
  s_waitcnt lgkmcnt(3)
  v_mfma_f32_32x32x16_bf16 v[216:231], v[166:169], v[22:25], v[216:231]
  v_exp_f32 v109, v109
  v_exp_f32 v110, v110
  v_exp_f32 v111, v111
  v_exp_f32 v112, v112
  v_exp_f32 v113, v113
  v_exp_f32 v114, v114
  v_exp_f32 v115, v115
  ds_read_b128 v[166:169], v193 offset:32768
  s_waitcnt lgkmcnt(3)
  v_mfma_f32_32x32x16_bf16 v[216:231], v[154:157], v[26:29], v[216:231]
  v_exp_f32 v116, v116
  v_exp_f32 v117, v117
  v_exp_f32 v118, v118
  v_exp_f32 v119, v119
  v_exp_f32 v120, v120
  v_exp_f32 v121, v121
  v_add_f32 v206, v106, v107
  ds_read_b128 v[154:157], v186 offset:40960
  s_waitcnt lgkmcnt(3)
  v_mfma_f32_32x32x16_bf16 v[216:231], v[158:161], v[30:33], v[216:231]
  v_add_f32 v207, v108, v109
  v_add_f32 v206, v206, v110
  v_add_f32 v207, v207, v111
  v_add_f32 v206, v206, v112
  v_add_f32 v207, v207, v113
  v_add_f32 v206, v206, v114
  ds_read_b128 v[158:161], v187 offset:40960
  s_waitcnt lgkmcnt(3)
  v_mfma_f32_32x32x16_bf16 v[216:231], v[162:165], v[34:37], v[216:231]
  v_add_f32 v207, v207, v115
  v_add_f32 v206, v206, v116
  v_add_f32 v207, v207, v117
  v_add_f32 v206, v206, v118
  v_add_f32 v207, v207, v119
  v_add_f32 v206, v206, v120
  v_add_f32 v207, v207, v121
  ds_read_b128 v[162:165], v188 offset:40960
  s_waitcnt lgkmcnt(3)
  v_mfma_f32_32x32x16_bf16 v[216:231], v[166:169], v[38:41], v[216:231]
  v_cvt_pk_bf16_f32 v138, v106, v107
  v_cvt_pk_bf16_f32 v139, v108, v109
  v_cvt_pk_bf16_f32 v140, v110, v111
  v_cvt_pk_bf16_f32 v141, v112, v113
  v_cvt_pk_bf16_f32 v142, v114, v115
  v_cvt_pk_bf16_f32 v143, v116, v117
  v_cvt_pk_bf16_f32 v144, v118, v119
  v_cvt_pk_bf16_f32 v145, v120, v121
  v_add_f32 v206, v206, v207
  v_add_f32 v201, v201, v206
  ds_read_b128 v[166:169], v189 offset:40960
  s_waitcnt lgkmcnt(3)
  v_mfma_f32_32x32x16_bf16 v[232:247], v[154:157], v[10:13], 0
  v_sub_f32 v122, v122, v200
  v_sub_f32 v123, v123, v200
  v_sub_f32 v124, v124, v200
  v_sub_f32 v125, v125, v200
  v_sub_f32 v126, v126, v200
  v_sub_f32 v127, v127, v200
  ds_read_b128 v[154:157], v190 offset:40960
  s_waitcnt lgkmcnt(3)
  v_mfma_f32_32x32x16_bf16 v[232:247], v[158:161], v[14:17], v[232:247]
  v_sub_f32 v128, v128, v200
  v_sub_f32 v129, v129, v200
  v_sub_f32 v130, v130, v200
  v_sub_f32 v131, v131, v200
  v_sub_f32 v132, v132, v200
  v_sub_f32 v133, v133, v200
  v_sub_f32 v134, v134, v200
  ds_read_b128 v[158:161], v191 offset:40960
  s_waitcnt lgkmcnt(3)
  v_mfma_f32_32x32x16_bf16 v[232:247], v[162:165], v[18:21], v[232:247]
  v_sub_f32 v135, v135, v200
  v_sub_f32 v136, v136, v200
  v_sub_f32 v137, v137, v200
  v_exp_f32 v122, v122
  v_exp_f32 v123, v123
  v_exp_f32 v124, v124
  ds_read_b128 v[162:165], v192 offset:40960
  s_waitcnt lgkmcnt(3)
  v_mfma_f32_32x32x16_bf16 v[232:247], v[166:169], v[22:25], v[232:247]
  v_exp_f32 v125, v125
  v_exp_f32 v126, v126
  v_exp_f32 v127, v127
  v_exp_f32 v128, v128
  v_exp_f32 v129, v129
  v_exp_f32 v130, v130
  v_exp_f32 v131, v131
  ds_read_b128 v[166:169], v193 offset:40960
  s_waitcnt lgkmcnt(3)
  v_mfma_f32_32x32x16_bf16 v[232:247], v[154:157], v[26:29], v[232:247]
  v_exp_f32 v132, v132
  v_exp_f32 v133, v133
  v_exp_f32 v134, v134
  v_exp_f32 v135, v135
  v_exp_f32 v136, v136
  v_exp_f32 v137, v137
  v_add_f32 v206, v122, v123
  s_waitcnt lgkmcnt(2)
  v_mfma_f32_32x32x16_bf16 v[232:247], v[158:161], v[30:33], v[232:247]
  v_add_f32 v207, v124, v125
  v_add_f32 v206, v206, v126
  v_add_f32 v207, v207, v127
  v_add_f32 v206, v206, v128
  v_add_f32 v207, v207, v129
  v_add_f32 v206, v206, v130
  s_waitcnt lgkmcnt(1)
  v_mfma_f32_32x32x16_bf16 v[232:247], v[162:165], v[34:37], v[232:247]
  v_add_f32 v207, v207, v131
  v_add_f32 v206, v206, v132
  v_add_f32 v207, v207, v133
  v_add_f32 v206, v206, v134
  v_add_f32 v207, v207, v135
  v_add_f32 v206, v206, v136
  v_add_f32 v207, v207, v137
  s_waitcnt lgkmcnt(0)
  v_mfma_f32_32x32x16_bf16 v[232:247], v[166:169], v[38:41], v[232:247]
  v_cvt_pk_bf16_f32 v146, v122, v123
  v_cvt_pk_bf16_f32 v147, v124, v125
  v_cvt_pk_bf16_f32 v148, v126, v127
  v_cvt_pk_bf16_f32 v149, v128, v129
  v_cvt_pk_bf16_f32 v150, v130, v131
  v_cvt_pk_bf16_f32 v151, v132, v133
  v_cvt_pk_bf16_f32 v152, v134, v135
  v_cvt_pk_bf16_f32 v153, v136, v137
  v_add_f32 v206, v206, v207
  v_add_f32 v201, v201, v206
  s_nop 1
  ds_read_b64_tr_b16 v[154:155], v194 offset:16384
  ds_read_b64_tr_b16 v[156:157], v194 offset:18432
  ds_read_b64_tr_b16 v[158:159], v195 offset:16384
  ds_read_b64_tr_b16 v[160:161], v195 offset:18432
  ds_read_b64_tr_b16 v[162:163], v196 offset:16384
  ds_read_b64_tr_b16 v[164:165], v196 offset:18432
  ds_read_b64_tr_b16 v[166:167], v197 offset:16384
  ds_read_b64_tr_b16 v[168:169], v197 offset:18432
  ds_read_b64_tr_b16 v[170:171], v194 offset:20480
  ds_read_b64_tr_b16 v[172:173], v194 offset:22528
  ds_read_b64_tr_b16 v[174:175], v195 offset:20480
  ds_read_b64_tr_b16 v[176:177], v195 offset:22528
  ds_read_b64_tr_b16 v[178:179], v196 offset:20480
  ds_read_b64_tr_b16 v[180:181], v196 offset:22528
  ds_read_b64_tr_b16 v[182:183], v197 offset:20480
  ds_read_b64_tr_b16 v[184:185], v197 offset:22528
  s_waitcnt lgkmcnt(14)
  v_mfma_f32_32x32x16_bf16 v[42:57], v[154:157], v[138:141], v[42:57]
  ds_read_b64_tr_b16 v[154:155], v194 offset:24576
  ds_read_b64_tr_b16 v[156:157], v194 offset:26624
  s_waitcnt lgkmcnt(14)
  v_mfma_f32_32x32x16_bf16 v[58:73], v[158:161], v[138:141], v[58:73]
  ds_read_b64_tr_b16 v[158:159], v195 offset:24576
  ds_read_b64_tr_b16 v[160:161], v195 offset:26624
  s_waitcnt lgkmcnt(14)
  v_mfma_f32_32x32x16_bf16 v[74:89], v[162:165], v[138:141], v[74:89]
  ds_read_b64_tr_b16 v[162:163], v196 offset:24576
  ds_read_b64_tr_b16 v[164:165], v196 offset:26624
  s_waitcnt lgkmcnt(14)
  v_mfma_f32_32x32x16_bf16 v[90:105], v[166:169], v[138:141], v[90:105]
  ds_read_b64_tr_b16 v[166:167], v197 offset:24576
  ds_read_b64_tr_b16 v[168:169], v197 offset:26624
  s_waitcnt lgkmcnt(14)
  v_mfma_f32_32x32x16_bf16 v[42:57], v[170:173], v[142:145], v[42:57]
  ds_read_b64_tr_b16 v[170:171], v194 offset:28672
  ds_read_b64_tr_b16 v[172:173], v194 offset:30720
  s_waitcnt lgkmcnt(14)
  v_mfma_f32_32x32x16_bf16 v[58:73], v[174:177], v[142:145], v[58:73]
  ds_read_b64_tr_b16 v[174:175], v195 offset:28672
  ds_read_b64_tr_b16 v[176:177], v195 offset:30720
  s_waitcnt lgkmcnt(14)
  v_mfma_f32_32x32x16_bf16 v[74:89], v[178:181], v[142:145], v[74:89]
  ds_read_b64_tr_b16 v[178:179], v196 offset:28672
  ds_read_b64_tr_b16 v[180:181], v196 offset:30720
  s_waitcnt lgkmcnt(14)
  v_mfma_f32_32x32x16_bf16 v[90:105], v[182:185], v[142:145], v[90:105]
  ds_read_b64_tr_b16 v[182:183], v197 offset:28672
  ds_read_b64_tr_b16 v[184:185], v197 offset:30720
  s_waitcnt lgkmcnt(14)
  v_mfma_f32_32x32x16_bf16 v[42:57], v[154:157], v[146:149], v[42:57]
  s_waitcnt lgkmcnt(12)
  v_mfma_f32_32x32x16_bf16 v[58:73], v[158:161], v[146:149], v[58:73]
  s_waitcnt lgkmcnt(10)
  v_mfma_f32_32x32x16_bf16 v[74:89], v[162:165], v[146:149], v[74:89]
  s_waitcnt lgkmcnt(8)
  v_mfma_f32_32x32x16_bf16 v[90:105], v[166:169], v[146:149], v[90:105]
  s_waitcnt lgkmcnt(6)
  v_mfma_f32_32x32x16_bf16 v[42:57], v[170:173], v[150:153], v[42:57]
  s_waitcnt lgkmcnt(4)
  v_mfma_f32_32x32x16_bf16 v[58:73], v[174:177], v[150:153], v[58:73]
  s_waitcnt lgkmcnt(2)
  v_mfma_f32_32x32x16_bf16 v[74:89], v[178:181], v[150:153], v[74:89]
  s_waitcnt lgkmcnt(0)
  v_mfma_f32_32x32x16_bf16 v[90:105], v[182:185], v[150:153], v[90:105]
  v_subrev_u32 v202, 64, v202
  s_barrier
  v_cmp_lt_i32 vcc, v202, 0
  s_nop 1
  v_cndmask_b32 v216, v216, v203, vcc
  v_cmp_lt_i32 vcc, v202, 1
  s_nop 1
  v_cndmask_b32 v217, v217, v203, vcc
  v_cmp_lt_i32 vcc, v202, 2
  s_nop 1
  v_cndmask_b32 v218, v218, v203, vcc
  v_cmp_lt_i32 vcc, v202, 3
  s_nop 1
  v_cndmask_b32 v219, v219, v203, vcc
  v_cmp_lt_i32 vcc, v202, 8
  s_nop 1
  v_cndmask_b32 v220, v220, v203, vcc
  v_cmp_lt_i32 vcc, v202, 9
  s_nop 1
  v_cndmask_b32 v221, v221, v203, vcc
  v_cmp_lt_i32 vcc, v202, 10
  s_nop 1
  v_cndmask_b32 v222, v222, v203, vcc
  v_cmp_lt_i32 vcc, v202, 11
  s_nop 1
  v_cndmask_b32 v223, v223, v203, vcc
  v_cmp_lt_i32 vcc, v202, 16
  s_nop 1
  v_cndmask_b32 v224, v224, v203, vcc
  v_cmp_lt_i32 vcc, v202, 17
  s_nop 1
  v_cndmask_b32 v225, v225, v203, vcc
  v_cmp_lt_i32 vcc, v202, 18
  s_nop 1
  v_cndmask_b32 v226, v226, v203, vcc
  v_cmp_lt_i32 vcc, v202, 19
  s_nop 1
  v_cndmask_b32 v227, v227, v203, vcc
  v_cmp_lt_i32 vcc, v202, 24
  s_nop 1
  v_cndmask_b32 v228, v228, v203, vcc
  v_cmp_lt_i32 vcc, v202, 25
  s_nop 1
  v_cndmask_b32 v229, v229, v203, vcc
  v_cmp_lt_i32 vcc, v202, 26
  s_nop 1
  v_cndmask_b32 v230, v230, v203, vcc
  v_cmp_lt_i32 vcc, v202, 27
  s_nop 1
  v_cndmask_b32 v231, v231, v203, vcc
  v_cmp_lt_i32 vcc, v202, 32
  s_nop 1
  v_cndmask_b32 v232, v232, v203, vcc
  v_cmp_lt_i32 vcc, v202, 33
  s_nop 1
  v_cndmask_b32 v233, v233, v203, vcc
  v_cmp_lt_i32 vcc, v202, 34
  s_nop 1
  v_cndmask_b32 v234, v234, v203, vcc
  v_cmp_lt_i32 vcc, v202, 35
  s_nop 1
  v_cndmask_b32 v235, v235, v203, vcc
  v_cmp_lt_i32 vcc, v202, 40
  s_nop 1
  v_cndmask_b32 v236, v236, v203, vcc
  v_cmp_lt_i32 vcc, v202, 41
  s_nop 1
  v_cndmask_b32 v237, v237, v203, vcc
  v_cmp_lt_i32 vcc, v202, 42
  s_nop 1
  v_cndmask_b32 v238, v238, v203, vcc
  v_cmp_lt_i32 vcc, v202, 43
  s_nop 1
  v_cndmask_b32 v239, v239, v203, vcc
  v_cmp_lt_i32 vcc, v202, 48
  s_nop 1
  v_cndmask_b32 v240, v240, v203, vcc
  v_cmp_lt_i32 vcc, v202, 49
  s_nop 1
  v_cndmask_b32 v241, v241, v203, vcc
  v_cmp_lt_i32 vcc, v202, 50
  s_nop 1
  v_cndmask_b32 v242, v242, v203, vcc
  v_cmp_lt_i32 vcc, v202, 51
  s_nop 1
  v_cndmask_b32 v243, v243, v203, vcc
  v_cmp_lt_i32 vcc, v202, 56
  s_nop 1
  v_cndmask_b32 v244, v244, v203, vcc
  v_cmp_lt_i32 vcc, v202, 57
  s_nop 1
  v_cndmask_b32 v245, v245, v203, vcc
  v_cmp_lt_i32 vcc, v202, 58
  s_nop 1
  v_cndmask_b32 v246, v246, v203, vcc
  v_cmp_lt_i32 vcc, v202, 59
  s_nop 1
  v_cndmask_b32 v247, v247, v203, vcc
  v_max3_f32 v204, v216, v217, v218
  v_max3_f32 v205, v219, v220, v221
  v_max3_f32 v204, v204, v222, v223
  v_max3_f32 v205, v205, v224, v225
  v_max3_f32 v204, v204, v226, v227
  v_max3_f32 v205, v205, v228, v229
  v_max3_f32 v204, v204, v230, v231
  v_max3_f32 v205, v205, v232, v233
  v_max3_f32 v204, v204, v234, v235
  v_max3_f32 v205, v205, v236, v237
  v_max3_f32 v204, v204, v238, v239
  v_max3_f32 v205, v205, v240, v241
  v_max3_f32 v204, v204, v242, v243
  v_max3_f32 v205, v205, v244, v245
  v_max3_f32 v204, v204, v246, v247
  v_max_f32 v204, v204, v205
  v_mov_b32 v205, v204
  s_nop 1
  v_permlane32_swap_b32 v204, v205
  v_max_f32 v204, v204, v205
  v_sub_f32 v205, v204, v200
  v_cmp_gt_f32 vcc, v205, s28
  s_cbranch_vccz a_kernel_nors_4
  s_nop 15
  s_nop 15
  s_nop 7
  v_max_f32 v204, v204, v200
  v_sub_f32 v205, v200, v204
  v_exp_f32 v205, v205
  v_mov_b32 v200, v204
  v_mul_f32 v201, v205, v201
  v_mul_f32 v42, v205, v42
  v_mul_f32 v43, v205, v43
  v_mul_f32 v44, v205, v44
  v_mul_f32 v45, v205, v45
  v_mul_f32 v46, v205, v46
  v_mul_f32 v47, v205, v47
  v_mul_f32 v48, v205, v48
  v_mul_f32 v49, v205, v49
  v_mul_f32 v50, v205, v50
  v_mul_f32 v51, v205, v51
  v_mul_f32 v52, v205, v52
  v_mul_f32 v53, v205, v53
  v_mul_f32 v54, v205, v54
  v_mul_f32 v55, v205, v55
  v_mul_f32 v56, v205, v56
  v_mul_f32 v57, v205, v57
  v_mul_f32 v58, v205, v58
  v_mul_f32 v59, v205, v59
  v_mul_f32 v60, v205, v60
  v_mul_f32 v61, v205, v61
  v_mul_f32 v62, v205, v62
  v_mul_f32 v63, v205, v63
  v_mul_f32 v64, v205, v64
  v_mul_f32 v65, v205, v65
  v_mul_f32 v66, v205, v66
  v_mul_f32 v67, v205, v67
  v_mul_f32 v68, v205, v68
  v_mul_f32 v69, v205, v69
  v_mul_f32 v70, v205, v70
  v_mul_f32 v71, v205, v71
  v_mul_f32 v72, v205, v72
  v_mul_f32 v73, v205, v73
  v_mul_f32 v74, v205, v74
  v_mul_f32 v75, v205, v75
  v_mul_f32 v76, v205, v76
  v_mul_f32 v77, v205, v77
  v_mul_f32 v78, v205, v78
  v_mul_f32 v79, v205, v79
  v_mul_f32 v80, v205, v80
  v_mul_f32 v81, v205, v81
  v_mul_f32 v82, v205, v82
  v_mul_f32 v83, v205, v83
  v_mul_f32 v84, v205, v84
  v_mul_f32 v85, v205, v85
  v_mul_f32 v86, v205, v86
  v_mul_f32 v87, v205, v87
  v_mul_f32 v88, v205, v88
  v_mul_f32 v89, v205, v89
  v_mul_f32 v90, v205, v90
  v_mul_f32 v91, v205, v91
  v_mul_f32 v92, v205, v92
  v_mul_f32 v93, v205, v93
  v_mul_f32 v94, v205, v94
  v_mul_f32 v95, v205, v95
  v_mul_f32 v96, v205, v96
  v_mul_f32 v97, v205, v97
  v_mul_f32 v98, v205, v98
  v_mul_f32 v99, v205, v99
  v_mul_f32 v100, v205, v100
  v_mul_f32 v101, v205, v101
  v_mul_f32 v102, v205, v102
  v_mul_f32 v103, v205, v103
  v_mul_f32 v104, v205, v104
  v_mul_f32 v105, v205, v105
  s_nop 1
a_kernel_nors_4:
  v_sub_f32 v216, v216, v200
  v_sub_f32 v217, v217, v200
  v_sub_f32 v218, v218, v200
  v_sub_f32 v219, v219, v200
  v_sub_f32 v220, v220, v200
  v_sub_f32 v221, v221, v200
  v_sub_f32 v222, v222, v200
  v_sub_f32 v223, v223, v200
  v_sub_f32 v224, v224, v200
  v_sub_f32 v225, v225, v200
  v_sub_f32 v226, v226, v200
  v_sub_f32 v227, v227, v200
  v_sub_f32 v228, v228, v200
  v_sub_f32 v229, v229, v200
  v_sub_f32 v230, v230, v200
  v_sub_f32 v231, v231, v200
  v_exp_f32 v216, v216
  v_exp_f32 v217, v217
  v_exp_f32 v218, v218
  v_exp_f32 v219, v219
  v_exp_f32 v220, v220
  v_exp_f32 v221, v221
  v_exp_f32 v222, v222
  v_exp_f32 v223, v223
  v_exp_f32 v224, v224
  v_exp_f32 v225, v225
  v_exp_f32 v226, v226
  v_exp_f32 v227, v227
  v_exp_f32 v228, v228
  v_exp_f32 v229, v229
  v_exp_f32 v230, v230
  v_exp_f32 v231, v231
  v_add_f32 v206, v216, v217
  v_add_f32 v207, v218, v219
  v_add_f32 v206, v206, v220
  v_add_f32 v207, v207, v221
  v_add_f32 v206, v206, v222
  v_add_f32 v207, v207, v223
  v_add_f32 v206, v206, v224
  v_add_f32 v207, v207, v225
  v_add_f32 v206, v206, v226
  v_add_f32 v207, v207, v227
  v_add_f32 v206, v206, v228
  v_add_f32 v207, v207, v229
  v_add_f32 v206, v206, v230
  v_add_f32 v207, v207, v231
  v_cvt_pk_bf16_f32 v138, v216, v217
  v_cvt_pk_bf16_f32 v139, v218, v219
  v_cvt_pk_bf16_f32 v140, v220, v221
  v_cvt_pk_bf16_f32 v141, v222, v223
  v_cvt_pk_bf16_f32 v142, v224, v225
  v_cvt_pk_bf16_f32 v143, v226, v227
  v_cvt_pk_bf16_f32 v144, v228, v229
  v_cvt_pk_bf16_f32 v145, v230, v231
  v_add_f32 v206, v206, v207
  v_add_f32 v201, v201, v206
  v_sub_f32 v232, v232, v200
  v_sub_f32 v233, v233, v200
  v_sub_f32 v234, v234, v200
  v_sub_f32 v235, v235, v200
  v_sub_f32 v236, v236, v200
  v_sub_f32 v237, v237, v200
  v_sub_f32 v238, v238, v200
  v_sub_f32 v239, v239, v200
  v_sub_f32 v240, v240, v200
  v_sub_f32 v241, v241, v200
  v_sub_f32 v242, v242, v200
  v_sub_f32 v243, v243, v200
  v_sub_f32 v244, v244, v200
  v_sub_f32 v245, v245, v200
  v_sub_f32 v246, v246, v200
  v_sub_f32 v247, v247, v200
  v_exp_f32 v232, v232
  v_exp_f32 v233, v233
  v_exp_f32 v234, v234
  v_exp_f32 v235, v235
  v_exp_f32 v236, v236
  v_exp_f32 v237, v237
  v_exp_f32 v238, v238
  v_exp_f32 v239, v239
  v_exp_f32 v240, v240
  v_exp_f32 v241, v241
  v_exp_f32 v242, v242
  v_exp_f32 v243, v243
  v_exp_f32 v244, v244
  v_exp_f32 v245, v245
  v_exp_f32 v246, v246
  v_exp_f32 v247, v247
  v_add_f32 v206, v232, v233
  v_add_f32 v207, v234, v235
  v_add_f32 v206, v206, v236
  v_add_f32 v207, v207, v237
  v_add_f32 v206, v206, v238
  v_add_f32 v207, v207, v239
  v_add_f32 v206, v206, v240
  v_add_f32 v207, v207, v241
  v_add_f32 v206, v206, v242
  v_add_f32 v207, v207, v243
  v_add_f32 v206, v206, v244
  v_add_f32 v207, v207, v245
  v_add_f32 v206, v206, v246
  v_add_f32 v207, v207, v247
  v_cvt_pk_bf16_f32 v146, v232, v233
  v_cvt_pk_bf16_f32 v147, v234, v235
  v_cvt_pk_bf16_f32 v148, v236, v237
  v_cvt_pk_bf16_f32 v149, v238, v239
  v_cvt_pk_bf16_f32 v150, v240, v241
  v_cvt_pk_bf16_f32 v151, v242, v243
  v_cvt_pk_bf16_f32 v152, v244, v245
  v_cvt_pk_bf16_f32 v153, v246, v247
  v_add_f32 v206, v206, v207
  v_add_f32 v201, v201, v206
  s_nop 1
  ds_read_b64_tr_b16 v[154:155], v194 offset:49152
  ds_read_b64_tr_b16 v[156:157], v194 offset:51200
  ds_read_b64_tr_b16 v[158:159], v195 offset:49152
  ds_read_b64_tr_b16 v[160:161], v195 offset:51200
  ds_read_b64_tr_b16 v[162:163], v196 offset:49152
  ds_read_b64_tr_b16 v[164:165], v196 offset:51200
  ds_read_b64_tr_b16 v[166:167], v197 offset:49152
  ds_read_b64_tr_b16 v[168:169], v197 offset:51200
  ds_read_b64_tr_b16 v[170:171], v194 offset:53248
  ds_read_b64_tr_b16 v[172:173], v194 offset:55296
  ds_read_b64_tr_b16 v[174:175], v195 offset:53248
  ds_read_b64_tr_b16 v[176:177], v195 offset:55296
  ds_read_b64_tr_b16 v[178:179], v196 offset:53248
  ds_read_b64_tr_b16 v[180:181], v196 offset:55296
  ds_read_b64_tr_b16 v[182:183], v197 offset:53248
  ds_read_b64_tr_b16 v[184:185], v197 offset:55296
  s_waitcnt lgkmcnt(14)
  v_mfma_f32_32x32x16_bf16 v[42:57], v[154:157], v[138:141], v[42:57]
  ds_read_b64_tr_b16 v[154:155], v194 offset:57344
  ds_read_b64_tr_b16 v[156:157], v194 offset:59392
  s_waitcnt lgkmcnt(14)
  v_mfma_f32_32x32x16_bf16 v[58:73], v[158:161], v[138:141], v[58:73]
  ds_read_b64_tr_b16 v[158:159], v195 offset:57344
  ds_read_b64_tr_b16 v[160:161], v195 offset:59392
  s_waitcnt lgkmcnt(14)
  v_mfma_f32_32x32x16_bf16 v[74:89], v[162:165], v[138:141], v[74:89]
  ds_read_b64_tr_b16 v[162:163], v196 offset:57344
  ds_read_b64_tr_b16 v[164:165], v196 offset:59392
  s_waitcnt lgkmcnt(14)
  v_mfma_f32_32x32x16_bf16 v[90:105], v[166:169], v[138:141], v[90:105]
  ds_read_b64_tr_b16 v[166:167], v197 offset:57344
  ds_read_b64_tr_b16 v[168:169], v197 offset:59392
  s_waitcnt lgkmcnt(14)
  v_mfma_f32_32x32x16_bf16 v[42:57], v[170:173], v[142:145], v[42:57]
  ds_read_b64_tr_b16 v[170:171], v194 offset:61440
  ds_read_b64_tr_b16 v[172:173], v194 offset:63488
  s_waitcnt lgkmcnt(14)
  v_mfma_f32_32x32x16_bf16 v[58:73], v[174:177], v[142:145], v[58:73]
  ds_read_b64_tr_b16 v[174:175], v195 offset:61440
  ds_read_b64_tr_b16 v[176:177], v195 offset:63488
  s_waitcnt lgkmcnt(14)
  v_mfma_f32_32x32x16_bf16 v[74:89], v[178:181], v[142:145], v[74:89]
  ds_read_b64_tr_b16 v[178:179], v196 offset:61440
  ds_read_b64_tr_b16 v[180:181], v196 offset:63488
  s_waitcnt lgkmcnt(14)
  v_mfma_f32_32x32x16_bf16 v[90:105], v[182:185], v[142:145], v[90:105]
  ds_read_b64_tr_b16 v[182:183], v197 offset:61440
  ds_read_b64_tr_b16 v[184:185], v197 offset:63488
  s_waitcnt lgkmcnt(14)
  v_mfma_f32_32x32x16_bf16 v[42:57], v[154:157], v[146:149], v[42:57]
  s_waitcnt lgkmcnt(12)
  v_mfma_f32_32x32x16_bf16 v[58:73], v[158:161], v[146:149], v[58:73]
  s_waitcnt lgkmcnt(10)
  v_mfma_f32_32x32x16_bf16 v[74:89], v[162:165], v[146:149], v[74:89]
  s_waitcnt lgkmcnt(8)
  v_mfma_f32_32x32x16_bf16 v[90:105], v[166:169], v[146:149], v[90:105]
  s_waitcnt lgkmcnt(6)
  v_mfma_f32_32x32x16_bf16 v[42:57], v[170:173], v[150:153], v[42:57]
  s_waitcnt lgkmcnt(4)
  v_mfma_f32_32x32x16_bf16 v[58:73], v[174:177], v[150:153], v[58:73]
  s_waitcnt lgkmcnt(2)
  v_mfma_f32_32x32x16_bf16 v[74:89], v[178:181], v[150:153], v[74:89]
  s_waitcnt lgkmcnt(0)
  v_mfma_f32_32x32x16_bf16 v[90:105], v[182:185], v[150:153], v[90:105]
  s_nop 15
  s_nop 3
  v_mov_b32 v204, v201
  v_mov_b32 v205, v201
  s_nop 1
  v_permlane32_swap_b32 v204, v205
  v_add_f32 v204, v204, v205
  v_rcp_f32 v204, v204
  v_and_b32 v2, 31, v1
  v_lshlrev_b32 v3, 13, v2
  v_lshrrev_b32 v4, 5, v1
  v_lshlrev_b32 v4, 4, v4
  v_add_u32 v212, v3, v4
  s_lshl_b32 s21, s10, 7
  s_lshl_b32 s22, s8, 5
  s_add_u32 s21, s21, s22
  s_lshl_b32 s21, s21, 13
  s_lshl_b32 s22, s9, 8
  s_add_u32 s21, s21, s22
  s_add_u32 s21, s21, 0x3000000
  v_mul_f32 v42, v204, v42
  v_mul_f32 v43, v204, v43
  v_mul_f32 v44, v204, v44
  v_mul_f32 v45, v204, v45
  v_mul_f32 v46, v204, v46
  v_mul_f32 v47, v204, v47
  v_mul_f32 v48, v204, v48
  v_mul_f32 v49, v204, v49
  v_cvt_pk_bf16_f32 v106, v42, v43
  v_cvt_pk_bf16_f32 v107, v44, v45
  v_cvt_pk_bf16_f32 v108, v46, v47
  v_cvt_pk_bf16_f32 v109, v48, v49
  s_nop 1
  v_permlane32_swap_b32 v106, v108
  v_permlane32_swap_b32 v107, v109
  buffer_store_dwordx4 v[106:109], v212, s[4:7], s21 offen offset:0
  v_mul_f32 v50, v204, v50
  v_mul_f32 v51, v204, v51
  v_mul_f32 v52, v204, v52
  v_mul_f32 v53, v204, v53
  v_mul_f32 v54, v204, v54
  v_mul_f32 v55, v204, v55
  v_mul_f32 v56, v204, v56
  v_mul_f32 v57, v204, v57
  v_cvt_pk_bf16_f32 v110, v50, v51
  v_cvt_pk_bf16_f32 v111, v52, v53
  v_cvt_pk_bf16_f32 v112, v54, v55
  v_cvt_pk_bf16_f32 v113, v56, v57
  s_nop 1
  v_permlane32_swap_b32 v110, v112
  v_permlane32_swap_b32 v111, v113
  buffer_store_dwordx4 v[110:113], v212, s[4:7], s21 offen offset:32
  v_mul_f32 v58, v204, v58
  v_mul_f32 v59, v204, v59
  v_mul_f32 v60, v204, v60
  v_mul_f32 v61, v204, v61
  v_mul_f32 v62, v204, v62
  v_mul_f32 v63, v204, v63
  v_mul_f32 v64, v204, v64
  v_mul_f32 v65, v204, v65
  v_cvt_pk_bf16_f32 v106, v58, v59
  v_cvt_pk_bf16_f32 v107, v60, v61
  v_cvt_pk_bf16_f32 v108, v62, v63
  v_cvt_pk_bf16_f32 v109, v64, v65
  s_nop 1
  v_permlane32_swap_b32 v106, v108
  v_permlane32_swap_b32 v107, v109
  buffer_store_dwordx4 v[106:109], v212, s[4:7], s21 offen offset:64
  v_mul_f32 v66, v204, v66
  v_mul_f32 v67, v204, v67
  v_mul_f32 v68, v204, v68
  v_mul_f32 v69, v204, v69
  v_mul_f32 v70, v204, v70
  v_mul_f32 v71, v204, v71
  v_mul_f32 v72, v204, v72
  v_mul_f32 v73, v204, v73
  v_cvt_pk_bf16_f32 v110, v66, v67
  v_cvt_pk_bf16_f32 v111, v68, v69
  v_cvt_pk_bf16_f32 v112, v70, v71
  v_cvt_pk_bf16_f32 v113, v72, v73
  s_nop 1
  v_permlane32_swap_b32 v110, v112
  v_permlane32_swap_b32 v111, v113
  buffer_store_dwordx4 v[110:113], v212, s[4:7], s21 offen offset:96
  v_mul_f32 v74, v204, v74
  v_mul_f32 v75, v204, v75
  v_mul_f32 v76, v204, v76
  v_mul_f32 v77, v204, v77
  v_mul_f32 v78, v204, v78
  v_mul_f32 v79, v204, v79
  v_mul_f32 v80, v204, v80
  v_mul_f32 v81, v204, v81
  v_cvt_pk_bf16_f32 v106, v74, v75
  v_cvt_pk_bf16_f32 v107, v76, v77
  v_cvt_pk_bf16_f32 v108, v78, v79
  v_cvt_pk_bf16_f32 v109, v80, v81
  s_nop 1
  v_permlane32_swap_b32 v106, v108
  v_permlane32_swap_b32 v107, v109
  buffer_store_dwordx4 v[106:109], v212, s[4:7], s21 offen offset:128
  v_mul_f32 v82, v204, v82
  v_mul_f32 v83, v204, v83
  v_mul_f32 v84, v204, v84
  v_mul_f32 v85, v204, v85
  v_mul_f32 v86, v204, v86
  v_mul_f32 v87, v204, v87
  v_mul_f32 v88, v204, v88
  v_mul_f32 v89, v204, v89
  v_cvt_pk_bf16_f32 v110, v82, v83
  v_cvt_pk_bf16_f32 v111, v84, v85
  v_cvt_pk_bf16_f32 v112, v86, v87
  v_cvt_pk_bf16_f32 v113, v88, v89
  s_nop 1
  v_permlane32_swap_b32 v110, v112
  v_permlane32_swap_b32 v111, v113
  buffer_store_dwordx4 v[110:113], v212, s[4:7], s21 offen offset:160
  v_mul_f32 v90, v204, v90
  v_mul_f32 v91, v204, v91
  v_mul_f32 v92, v204, v92
  v_mul_f32 v93, v204, v93
  v_mul_f32 v94, v204, v94
  v_mul_f32 v95, v204, v95
  v_mul_f32 v96, v204, v96
  v_mul_f32 v97, v204, v97
  v_cvt_pk_bf16_f32 v106, v90, v91
  v_cvt_pk_bf16_f32 v107, v92, v93
  v_cvt_pk_bf16_f32 v108, v94, v95
  v_cvt_pk_bf16_f32 v109, v96, v97
  s_nop 1
  v_permlane32_swap_b32 v106, v108
  v_permlane32_swap_b32 v107, v109
  buffer_store_dwordx4 v[106:109], v212, s[4:7], s21 offen offset:192
  v_mul_f32 v98, v204, v98
  v_mul_f32 v99, v204, v99
  v_mul_f32 v100, v204, v100
  v_mul_f32 v101, v204, v101
  v_mul_f32 v102, v204, v102
  v_mul_f32 v103, v204, v103
  v_mul_f32 v104, v204, v104
  v_mul_f32 v105, v204, v105
  v_cvt_pk_bf16_f32 v110, v98, v99
  v_cvt_pk_bf16_f32 v111, v100, v101
  v_cvt_pk_bf16_f32 v112, v102, v103
  v_cvt_pk_bf16_f32 v113, v104, v105
  s_nop 1
  v_permlane32_swap_b32 v110, v112
  v_permlane32_swap_b32 v111, v113
  buffer_store_dwordx4 v[110:113], v212, s[4:7], s21 offen offset:224
  s_sub_u32 s10, 15, s26
  s_waitcnt vmcnt(0)
  s_barrier
  s_lshl_b32 s20, s9, 19
  s_lshl_b32 s21, s10, 7
  s_lshl_b32 s22, s8, 5
  s_add_u32 s21, s21, s22
  s_lshl_b32 s23, s21, 8
  s_add_u32 s23, s23, s20
  v_and_b32 v2, 31, v1
  v_lshlrev_b32 v3, 8, v2
  v_lshrrev_b32 v4, 5, v1
  v_lshlrev_b32 v5, 4, v4
  v_add_u32 v3, v3, v5
  buffer_load_dwordx4 v[10:13], v3, s[4:7], s23 offen offset:0
  buffer_load_dwordx4 v[14:17], v3, s[4:7], s23 offen offset:32
  buffer_load_dwordx4 v[18:21], v3, s[4:7], s23 offen offset:64
  buffer_load_dwordx4 v[22:25], v3, s[4:7], s23 offen offset:96
  buffer_load_dwordx4 v[26:29], v3, s[4:7], s23 offen offset:128
  buffer_load_dwordx4 v[30:33], v3, s[4:7], s23 offen offset:160
  buffer_load_dwordx4 v[34:37], v3, s[4:7], s23 offen offset:192
  buffer_load_dwordx4 v[38:41], v3, s[4:7], s23 offen offset:224
  v_add_u32 v202, s21, v2
  v_lshlrev_b32 v5, 2, v4
  v_sub_u32 v202, v202, v5
  s_lshl_b32 s24, s8, 12
  s_add_u32 s24, s24, s20
  s_add_u32 s11, s24, 0x1000000
  s_add_u32 s12, s24, 0x2000000
  v_mov_b32 v200, 0xff800000
  v_mov_b32 v201, 0
  v_mov_b32 v42, 0
  v_mov_b32 v43, 0
  v_mov_b32 v44, 0
  v_mov_b32 v45, 0
  v_mov_b32 v46, 0
  v_mov_b32 v47, 0
  v_mov_b32 v48, 0
  v_mov_b32 v49, 0
  v_mov_b32 v50, 0
  v_mov_b32 v51, 0
  v_mov_b32 v52, 0
  v_mov_b32 v53, 0
  v_mov_b32 v54, 0
  v_mov_b32 v55, 0
  v_mov_b32 v56, 0
  v_mov_b32 v57, 0
  v_mov_b32 v58, 0
  v_mov_b32 v59, 0
  v_mov_b32 v60, 0
  v_mov_b32 v61, 0
  v_mov_b32 v62, 0
  v_mov_b32 v63, 0
  v_mov_b32 v64, 0
  v_mov_b32 v65, 0
  v_mov_b32 v66, 0
  v_mov_b32 v67, 0
  v_mov_b32 v68, 0
  v_mov_b32 v69, 0
  v_mov_b32 v70, 0
  v_mov_b32 v71, 0
  v_mov_b32 v72, 0
  v_mov_b32 v73, 0
  v_mov_b32 v74, 0
  v_mov_b32 v75, 0
  v_mov_b32 v76, 0
  v_mov_b32 v77, 0
  v_mov_b32 v78, 0
  v_mov_b32 v79, 0
  v_mov_b32 v80, 0
  v_mov_b32 v81, 0
  v_mov_b32 v82, 0
  v_mov_b32 v83, 0
  v_mov_b32 v84, 0
  v_mov_b32 v85, 0
  v_mov_b32 v86, 0
  v_mov_b32 v87, 0
  v_mov_b32 v88, 0
  v_mov_b32 v89, 0
  v_mov_b32 v90, 0
  v_mov_b32 v91, 0
  v_mov_b32 v92, 0
  v_mov_b32 v93, 0
  v_mov_b32 v94, 0
  v_mov_b32 v95, 0
  v_mov_b32 v96, 0
  v_mov_b32 v97, 0
  v_mov_b32 v98, 0
  v_mov_b32 v99, 0
  v_mov_b32 v100, 0
  v_mov_b32 v101, 0
  v_mov_b32 v102, 0
  v_mov_b32 v103, 0
  v_mov_b32 v104, 0
  v_mov_b32 v105, 0
  s_waitcnt vmcnt(0)
  s_barrier
  ds_read_b128 v[154:157], v186 offset:0
  ds_read_b128 v[158:161], v187 offset:0
  ds_read_b128 v[162:165], v188 offset:0
  ds_read_b128 v[166:169], v189 offset:0
  s_waitcnt lgkmcnt(3)
  v_mfma_f32_32x32x16_bf16 v[106:121], v[154:157], v[10:13], 0
  ds_read_b128 v[154:157], v190 offset:0
  s_waitcnt lgkmcnt(3)
  v_mfma_f32_32x32x16_bf16 v[106:121], v[158:161], v[14:17], v[106:121]
  ds_read_b128 v[158:161], v191 offset:0
  s_waitcnt lgkmcnt(3)
  v_mfma_f32_32x32x16_bf16 v[106:121], v[162:165], v[18:21], v[106:121]
  ds_read_b128 v[162:165], v192 offset:0
  s_waitcnt lgkmcnt(3)
  v_mfma_f32_32x32x16_bf16 v[106:121], v[166:169], v[22:25], v[106:121]
  ds_read_b128 v[166:169], v193 offset:0
  s_waitcnt lgkmcnt(3)
  v_mfma_f32_32x32x16_bf16 v[106:121], v[154:157], v[26:29], v[106:121]
  ds_read_b128 v[154:157], v186 offset:8192
  s_waitcnt lgkmcnt(3)
  v_mfma_f32_32x32x16_bf16 v[106:121], v[158:161], v[30:33], v[106:121]
  ds_read_b128 v[158:161], v187 offset:8192
  s_waitcnt lgkmcnt(3)
  v_mfma_f32_32x32x16_bf16 v[106:121], v[162:165], v[34:37], v[106:121]
  ds_read_b128 v[162:165], v188 offset:8192
  s_waitcnt lgkmcnt(3)
  v_mfma_f32_32x32x16_bf16 v[106:121], v[166:169], v[38:41], v[106:121]
  ds_read_b128 v[166:169], v189 offset:8192
  s_waitcnt lgkmcnt(3)
  v_mfma_f32_32x32x16_bf16 v[122:137], v[154:157], v[10:13], 0
  ds_read_b128 v[154:157], v190 offset:8192
  s_waitcnt lgkmcnt(3)
  v_mfma_f32_32x32x16_bf16 v[122:137], v[158:161], v[14:17], v[122:137]
  ds_read_b128 v[158:161], v191 offset:8192
  s_waitcnt lgkmcnt(3)
  v_mfma_f32_32x32x16_bf16 v[122:137], v[162:165], v[18:21], v[122:137]
  ds_read_b128 v[162:165], v192 offset:8192
  s_waitcnt lgkmcnt(3)
  v_mfma_f32_32x32x16_bf16 v[122:137], v[166:169], v[22:25], v[122:137]
  ds_read_b128 v[166:169], v193 offset:8192
  s_waitcnt lgkmcnt(3)
  v_mfma_f32_32x32x16_bf16 v[122:137], v[154:157], v[26:29], v[122:137]
  s_waitcnt lgkmcnt(2)
  v_mfma_f32_32x32x16_bf16 v[122:137], v[158:161], v[30:33], v[122:137]
  s_waitcnt lgkmcnt(1)
  v_mfma_f32_32x32x16_bf16 v[122:137], v[162:165], v[34:37], v[122:137]
  s_waitcnt lgkmcnt(0)
  v_mfma_f32_32x32x16_bf16 v[122:137], v[166:169], v[38:41], v[122:137]
  s_nop 15
  s_lshl_b32 s16, s10, 1
  s_mov_b32 s15, 0
  s_cmp_ge_u32 s15, s16
  s_cbranch_scc1 a_kernel_h1_mask
a_kernel_h1_loop:
  s_barrier
  v_max3_f32 v204, v106, v107, v108
  v_max3_f32 v205, v109, v110, v111
  v_max3_f32 v204, v204, v112, v113
  v_max3_f32 v205, v205, v114, v115
  v_max3_f32 v204, v204, v116, v117
  v_max3_f32 v205, v205, v118, v119
  v_max3_f32 v204, v204, v120, v121
  v_max3_f32 v205, v205, v122, v123
  v_max3_f32 v204, v204, v124, v125
  v_max3_f32 v205, v205, v126, v127
  v_max3_f32 v204, v204, v128, v129
  v_max3_f32 v205, v205, v130, v131
  v_max3_f32 v204, v204, v132, v133
  v_max3_f32 v205, v205, v134, v135
  v_max3_f32 v204, v204, v136, v137
  v_max_f32 v204, v204, v205
  v_mov_b32 v205, v204
  s_nop 1
  v_permlane32_swap_b32 v204, v205
  v_max_f32 v204, v204, v205
  v_sub_f32 v205, v204, v200
  v_cmp_gt_f32 vcc, v205, s28
  s_cbranch_vccz a_kernel_nors_5
  s_nop 15
  s_nop 15
  s_nop 7
  v_max_f32 v204, v204, v200
  v_sub_f32 v205, v200, v204
  v_exp_f32 v205, v205
  v_mov_b32 v200, v204
  v_mul_f32 v201, v205, v201
  v_mul_f32 v42, v205, v42
  v_mul_f32 v43, v205, v43
  v_mul_f32 v44, v205, v44
  v_mul_f32 v45, v205, v45
  v_mul_f32 v46, v205, v46
  v_mul_f32 v47, v205, v47
  v_mul_f32 v48, v205, v48
  v_mul_f32 v49, v205, v49
  v_mul_f32 v50, v205, v50
  v_mul_f32 v51, v205, v51
  v_mul_f32 v52, v205, v52
  v_mul_f32 v53, v205, v53
  v_mul_f32 v54, v205, v54
  v_mul_f32 v55, v205, v55
  v_mul_f32 v56, v205, v56
  v_mul_f32 v57, v205, v57
  v_mul_f32 v58, v205, v58
  v_mul_f32 v59, v205, v59
  v_mul_f32 v60, v205, v60
  v_mul_f32 v61, v205, v61
  v_mul_f32 v62, v205, v62
  v_mul_f32 v63, v205, v63
  v_mul_f32 v64, v205, v64
  v_mul_f32 v65, v205, v65
  v_mul_f32 v66, v205, v66
  v_mul_f32 v67, v205, v67
  v_mul_f32 v68, v205, v68
  v_mul_f32 v69, v205, v69
  v_mul_f32 v70, v205, v70
  v_mul_f32 v71, v205, v71
  v_mul_f32 v72, v205, v72
  v_mul_f32 v73, v205, v73
  v_mul_f32 v74, v205, v74
  v_mul_f32 v75, v205, v75
  v_mul_f32 v76, v205, v76
  v_mul_f32 v77, v205, v77
  v_mul_f32 v78, v205, v78
  v_mul_f32 v79, v205, v79
  v_mul_f32 v80, v205, v80
  v_mul_f32 v81, v205, v81
  v_mul_f32 v82, v205, v82
  v_mul_f32 v83, v205, v83
  v_mul_f32 v84, v205, v84
  v_mul_f32 v85, v205, v85
  v_mul_f32 v86, v205, v86
  v_mul_f32 v87, v205, v87
  v_mul_f32 v88, v205, v88
  v_mul_f32 v89, v205, v89
  v_mul_f32 v90, v205, v90
  v_mul_f32 v91, v205, v91
  v_mul_f32 v92, v205, v92
  v_mul_f32 v93, v205, v93
  v_mul_f32 v94, v205, v94
  v_mul_f32 v95, v205, v95
  v_mul_f32 v96, v205, v96
  v_mul_f32 v97, v205, v97
  v_mul_f32 v98, v205, v98
  v_mul_f32 v99, v205, v99
  v_mul_f32 v100, v205, v100
  v_mul_f32 v101, v205, v101
  v_mul_f32 v102, v205, v102
  v_mul_f32 v103, v205, v103
  v_mul_f32 v104, v205, v104
  v_mul_f32 v105, v205, v105
  s_nop 1
a_kernel_nors_5:
  ds_read_b128 v[154:157], v186 offset:32768
  ds_read_b128 v[158:161], v187 offset:32768
  ds_read_b128 v[162:165], v188 offset:32768
  ds_read_b128 v[166:169], v189 offset:32768
  s_waitcnt lgkmcnt(3)
  v_mfma_f32_32x32x16_bf16 v[216:231], v[154:157], v[10:13], 0
  v_sub_f32 v106, v106, v200
  v_sub_f32 v107, v107, v200
  v_sub_f32 v108, v108, v200
  v_sub_f32 v109, v109, v200
  v_sub_f32 v110, v110, v200
  v_sub_f32 v111, v111, v200
  ds_read_b128 v[154:157], v190 offset:32768
  s_waitcnt lgkmcnt(3)
  v_mfma_f32_32x32x16_bf16 v[216:231], v[158:161], v[14:17], v[216:231]
  v_sub_f32 v112, v112, v200
  v_sub_f32 v113, v113, v200
  v_sub_f32 v114, v114, v200
  v_sub_f32 v115, v115, v200
  v_sub_f32 v116, v116, v200
  v_sub_f32 v117, v117, v200
  v_sub_f32 v118, v118, v200
  ds_read_b128 v[158:161], v191 offset:32768
  s_waitcnt lgkmcnt(3)
  v_mfma_f32_32x32x16_bf16 v[216:231], v[162:165], v[18:21], v[216:231]
  v_sub_f32 v119, v119, v200
  v_sub_f32 v120, v120, v200
  v_sub_f32 v121, v121, v200
  v_exp_f32 v106, v106
  v_exp_f32 v107, v107
  v_exp_f32 v108, v108
  ds_read_b128 v[162:165], v192 offset:32768
  s_waitcnt lgkmcnt(3)
  v_mfma_f32_32x32x16_bf16 v[216:231], v[166:169], v[22:25], v[216:231]
  v_exp_f32 v109, v109
  v_exp_f32 v110, v110
  v_exp_f32 v111, v111
  v_exp_f32 v112, v112
  v_exp_f32 v113, v113
  v_exp_f32 v114, v114
  v_exp_f32 v115, v115
  ds_read_b128 v[166:169], v193 offset:32768
  s_waitcnt lgkmcnt(3)
  v_mfma_f32_32x32x16_bf16 v[216:231], v[154:157], v[26:29], v[216:231]
  v_exp_f32 v116, v116
  v_exp_f32 v117, v117
  v_exp_f32 v118, v118
  v_exp_f32 v119, v119
  v_exp_f32 v120, v120
  v_exp_f32 v121, v121
  v_add_f32 v206, v106, v107
  ds_read_b128 v[154:157], v186 offset:40960
  s_waitcnt lgkmcnt(3)
  v_mfma_f32_32x32x16_bf16 v[216:231], v[158:161], v[30:33], v[216:231]
  v_add_f32 v207, v108, v109
  v_add_f32 v206, v206, v110
  v_add_f32 v207, v207, v111
  v_add_f32 v206, v206, v112
  v_add_f32 v207, v207, v113
  v_add_f32 v206, v206, v114
  ds_read_b128 v[158:161], v187 offset:40960
  s_waitcnt lgkmcnt(3)
  v_mfma_f32_32x32x16_bf16 v[216:231], v[162:165], v[34:37], v[216:231]
  v_add_f32 v207, v207, v115
  v_add_f32 v206, v206, v116
  v_add_f32 v207, v207, v117
  v_add_f32 v206, v206, v118
  v_add_f32 v207, v207, v119
  v_add_f32 v206, v206, v120
  v_add_f32 v207, v207, v121
  ds_read_b128 v[162:165], v188 offset:40960
  s_waitcnt lgkmcnt(3)
  v_mfma_f32_32x32x16_bf16 v[216:231], v[166:169], v[38:41], v[216:231]
  v_cvt_pk_bf16_f32 v138, v106, v107
  v_cvt_pk_bf16_f32 v139, v108, v109
  v_cvt_pk_bf16_f32 v140, v110, v111
  v_cvt_pk_bf16_f32 v141, v112, v113
  v_cvt_pk_bf16_f32 v142, v114, v115
  v_cvt_pk_bf16_f32 v143, v116, v117
  v_cvt_pk_bf16_f32 v144, v118, v119
  v_cvt_pk_bf16_f32 v145, v120, v121
  v_add_f32 v206, v206, v207
  v_add_f32 v201, v201, v206
  ds_read_b128 v[166:169], v189 offset:40960
  s_waitcnt lgkmcnt(3)
  v_mfma_f32_32x32x16_bf16 v[232:247], v[154:157], v[10:13], 0
  v_sub_f32 v122, v122, v200
  v_sub_f32 v123, v123, v200
  v_sub_f32 v124, v124, v200
  v_sub_f32 v125, v125, v200
  v_sub_f32 v126, v126, v200
  v_sub_f32 v127, v127, v200
  ds_read_b128 v[154:157], v190 offset:40960
  s_waitcnt lgkmcnt(3)
  v_mfma_f32_32x32x16_bf16 v[232:247], v[158:161], v[14:17], v[232:247]
  v_sub_f32 v128, v128, v200
  v_sub_f32 v129, v129, v200
  v_sub_f32 v130, v130, v200
  v_sub_f32 v131, v131, v200
  v_sub_f32 v132, v132, v200
  v_sub_f32 v133, v133, v200
  v_sub_f32 v134, v134, v200
  ds_read_b128 v[158:161], v191 offset:40960
  s_waitcnt lgkmcnt(3)
  v_mfma_f32_32x32x16_bf16 v[232:247], v[162:165], v[18:21], v[232:247]
  v_sub_f32 v135, v135, v200
  v_sub_f32 v136, v136, v200
  v_sub_f32 v137, v137, v200
  v_exp_f32 v122, v122
  v_exp_f32 v123, v123
  v_exp_f32 v124, v124
  ds_read_b128 v[162:165], v192 offset:40960
  s_waitcnt lgkmcnt(3)
  v_mfma_f32_32x32x16_bf16 v[232:247], v[166:169], v[22:25], v[232:247]
  v_exp_f32 v125, v125
  v_exp_f32 v126, v126
  v_exp_f32 v127, v127
  v_exp_f32 v128, v128
  v_exp_f32 v129, v129
  v_exp_f32 v130, v130
  v_exp_f32 v131, v131
  ds_read_b128 v[166:169], v193 offset:40960
  s_waitcnt lgkmcnt(3)
  v_mfma_f32_32x32x16_bf16 v[232:247], v[154:157], v[26:29], v[232:247]
  v_exp_f32 v132, v132
  v_exp_f32 v133, v133
  v_exp_f32 v134, v134
  v_exp_f32 v135, v135
  v_exp_f32 v136, v136
  v_exp_f32 v137, v137
  v_add_f32 v206, v122, v123
  s_waitcnt lgkmcnt(2)
  v_mfma_f32_32x32x16_bf16 v[232:247], v[158:161], v[30:33], v[232:247]
  v_add_f32 v207, v124, v125
  v_add_f32 v206, v206, v126
  v_add_f32 v207, v207, v127
  v_add_f32 v206, v206, v128
  v_add_f32 v207, v207, v129
  v_add_f32 v206, v206, v130
  s_waitcnt lgkmcnt(1)
  v_mfma_f32_32x32x16_bf16 v[232:247], v[162:165], v[34:37], v[232:247]
  v_add_f32 v207, v207, v131
  v_add_f32 v206, v206, v132
  v_add_f32 v207, v207, v133
  v_add_f32 v206, v206, v134
  v_add_f32 v207, v207, v135
  v_add_f32 v206, v206, v136
  v_add_f32 v207, v207, v137
  s_waitcnt lgkmcnt(0)
  v_mfma_f32_32x32x16_bf16 v[232:247], v[166:169], v[38:41], v[232:247]
  v_cvt_pk_bf16_f32 v146, v122, v123
  v_cvt_pk_bf16_f32 v147, v124, v125
  v_cvt_pk_bf16_f32 v148, v126, v127
  v_cvt_pk_bf16_f32 v149, v128, v129
  v_cvt_pk_bf16_f32 v150, v130, v131
  v_cvt_pk_bf16_f32 v151, v132, v133
  v_cvt_pk_bf16_f32 v152, v134, v135
  v_cvt_pk_bf16_f32 v153, v136, v137
  v_add_f32 v206, v206, v207
  v_add_f32 v201, v201, v206
  s_nop 1
  ds_read_b64_tr_b16 v[154:155], v194 offset:16384
  ds_read_b64_tr_b16 v[156:157], v194 offset:18432
  ds_read_b64_tr_b16 v[158:159], v195 offset:16384
  ds_read_b64_tr_b16 v[160:161], v195 offset:18432
  ds_read_b64_tr_b16 v[162:163], v196 offset:16384
  ds_read_b64_tr_b16 v[164:165], v196 offset:18432
  ds_read_b64_tr_b16 v[166:167], v197 offset:16384
  ds_read_b64_tr_b16 v[168:169], v197 offset:18432
  ds_read_b64_tr_b16 v[170:171], v194 offset:20480
  ds_read_b64_tr_b16 v[172:173], v194 offset:22528
  ds_read_b64_tr_b16 v[174:175], v195 offset:20480
  ds_read_b64_tr_b16 v[176:177], v195 offset:22528
  ds_read_b64_tr_b16 v[178:179], v196 offset:20480
  ds_read_b64_tr_b16 v[180:181], v196 offset:22528
  ds_read_b64_tr_b16 v[182:183], v197 offset:20480
  ds_read_b64_tr_b16 v[184:185], v197 offset:22528
  s_waitcnt lgkmcnt(14)
  v_mfma_f32_32x32x16_bf16 v[42:57], v[154:157], v[138:141], v[42:57]
  ds_read_b64_tr_b16 v[154:155], v194 offset:24576
  ds_read_b64_tr_b16 v[156:157], v194 offset:26624
  s_waitcnt lgkmcnt(14)
  v_mfma_f32_32x32x16_bf16 v[58:73], v[158:161], v[138:141], v[58:73]
  ds_read_b64_tr_b16 v[158:159], v195 offset:24576
  ds_read_b64_tr_b16 v[160:161], v195 offset:26624
  s_waitcnt lgkmcnt(14)
  v_mfma_f32_32x32x16_bf16 v[74:89], v[162:165], v[138:141], v[74:89]
  ds_read_b64_tr_b16 v[162:163], v196 offset:24576
  ds_read_b64_tr_b16 v[164:165], v196 offset:26624
  s_waitcnt lgkmcnt(14)
  v_mfma_f32_32x32x16_bf16 v[90:105], v[166:169], v[138:141], v[90:105]
  ds_read_b64_tr_b16 v[166:167], v197 offset:24576
  ds_read_b64_tr_b16 v[168:169], v197 offset:26624
  s_waitcnt lgkmcnt(14)
  v_mfma_f32_32x32x16_bf16 v[42:57], v[170:173], v[142:145], v[42:57]
  ds_read_b64_tr_b16 v[170:171], v194 offset:28672
  ds_read_b64_tr_b16 v[172:173], v194 offset:30720
  s_waitcnt lgkmcnt(14)
  v_mfma_f32_32x32x16_bf16 v[58:73], v[174:177], v[142:145], v[58:73]
  ds_read_b64_tr_b16 v[174:175], v195 offset:28672
  ds_read_b64_tr_b16 v[176:177], v195 offset:30720
  s_waitcnt lgkmcnt(14)
  v_mfma_f32_32x32x16_bf16 v[74:89], v[178:181], v[142:145], v[74:89]
  ds_read_b64_tr_b16 v[178:179], v196 offset:28672
  ds_read_b64_tr_b16 v[180:181], v196 offset:30720
  s_waitcnt lgkmcnt(14)
  v_mfma_f32_32x32x16_bf16 v[90:105], v[182:185], v[142:145], v[90:105]
  ds_read_b64_tr_b16 v[182:183], v197 offset:28672
  ds_read_b64_tr_b16 v[184:185], v197 offset:30720
  s_waitcnt lgkmcnt(14)
  v_mfma_f32_32x32x16_bf16 v[42:57], v[154:157], v[146:149], v[42:57]
  s_waitcnt lgkmcnt(12)
  v_mfma_f32_32x32x16_bf16 v[58:73], v[158:161], v[146:149], v[58:73]
  s_waitcnt lgkmcnt(10)
  v_mfma_f32_32x32x16_bf16 v[74:89], v[162:165], v[146:149], v[74:89]
  s_waitcnt lgkmcnt(8)
  v_mfma_f32_32x32x16_bf16 v[90:105], v[166:169], v[146:149], v[90:105]
  s_waitcnt lgkmcnt(6)
  v_mfma_f32_32x32x16_bf16 v[42:57], v[170:173], v[150:153], v[42:57]
  s_waitcnt lgkmcnt(4)
  v_mfma_f32_32x32x16_bf16 v[58:73], v[174:177], v[150:153], v[58:73]
  s_waitcnt lgkmcnt(2)
  v_mfma_f32_32x32x16_bf16 v[74:89], v[178:181], v[150:153], v[74:89]
  s_waitcnt lgkmcnt(0)
  v_mfma_f32_32x32x16_bf16 v[90:105], v[182:185], v[150:153], v[90:105]
  s_barrier
  v_max3_f32 v204, v216, v217, v218
  v_max3_f32 v205, v219, v220, v221
  v_max3_f32 v204, v204, v222, v223
  v_max3_f32 v205, v205, v224, v225
  v_max3_f32 v204, v204, v226, v227
  v_max3_f32 v205, v205, v228, v229
  v_max3_f32 v204, v204, v230, v231
  v_max3_f32 v205, v205, v232, v233
  v_max3_f32 v204, v204, v234, v235
  v_max3_f32 v205, v205, v236, v237
  v_max3_f32 v204, v204, v238, v239
  v_max3_f32 v205, v205, v240, v241
  v_max3_f32 v204, v204, v242, v243
  v_max3_f32 v205, v205, v244, v245
  v_max3_f32 v204, v204, v246, v247
  v_max_f32 v204, v204, v205
  v_mov_b32 v205, v204
  s_nop 1
  v_permlane32_swap_b32 v204, v205
  v_max_f32 v204, v204, v205
  v_sub_f32 v205, v204, v200
  v_cmp_gt_f32 vcc, v205, s28
  s_cbranch_vccz a_kernel_nors_6
  s_nop 15
  s_nop 15
  s_nop 7
  v_max_f32 v204, v204, v200
  v_sub_f32 v205, v200, v204
  v_exp_f32 v205, v205
  v_mov_b32 v200, v204
  v_mul_f32 v201, v205, v201
  v_mul_f32 v42, v205, v42
  v_mul_f32 v43, v205, v43
  v_mul_f32 v44, v205, v44
  v_mul_f32 v45, v205, v45
  v_mul_f32 v46, v205, v46
  v_mul_f32 v47, v205, v47
  v_mul_f32 v48, v205, v48
  v_mul_f32 v49, v205, v49
  v_mul_f32 v50, v205, v50
  v_mul_f32 v51, v205, v51
  v_mul_f32 v52, v205, v52
  v_mul_f32 v53, v205, v53
  v_mul_f32 v54, v205, v54
  v_mul_f32 v55, v205, v55
  v_mul_f32 v56, v205, v56
  v_mul_f32 v57, v205, v57
  v_mul_f32 v58, v205, v58
  v_mul_f32 v59, v205, v59
  v_mul_f32 v60, v205, v60
  v_mul_f32 v61, v205, v61
  v_mul_f32 v62, v205, v62
  v_mul_f32 v63, v205, v63
  v_mul_f32 v64, v205, v64
  v_mul_f32 v65, v205, v65
  v_mul_f32 v66, v205, v66
  v_mul_f32 v67, v205, v67
  v_mul_f32 v68, v205, v68
  v_mul_f32 v69, v205, v69
  v_mul_f32 v70, v205, v70
  v_mul_f32 v71, v205, v71
  v_mul_f32 v72, v205, v72
  v_mul_f32 v73, v205, v73
  v_mul_f32 v74, v205, v74
  v_mul_f32 v75, v205, v75
  v_mul_f32 v76, v205, v76
  v_mul_f32 v77, v205, v77
  v_mul_f32 v78, v205, v78
  v_mul_f32 v79, v205, v79
  v_mul_f32 v80, v205, v80
  v_mul_f32 v81, v205, v81
  v_mul_f32 v82, v205, v82
  v_mul_f32 v83, v205, v83
  v_mul_f32 v84, v205, v84
  v_mul_f32 v85, v205, v85
  v_mul_f32 v86, v205, v86
  v_mul_f32 v87, v205, v87
  v_mul_f32 v88, v205, v88
  v_mul_f32 v89, v205, v89
  v_mul_f32 v90, v205, v90
  v_mul_f32 v91, v205, v91
  v_mul_f32 v92, v205, v92
  v_mul_f32 v93, v205, v93
  v_mul_f32 v94, v205, v94
  v_mul_f32 v95, v205, v95
  v_mul_f32 v96, v205, v96
  v_mul_f32 v97, v205, v97
  v_mul_f32 v98, v205, v98
  v_mul_f32 v99, v205, v99
  v_mul_f32 v100, v205, v100
  v_mul_f32 v101, v205, v101
  v_mul_f32 v102, v205, v102
  v_mul_f32 v103, v205, v103
  v_mul_f32 v104, v205, v104
  v_mul_f32 v105, v205, v105
  s_nop 1
a_kernel_nors_6:
  ds_read_b128 v[154:157], v186 offset:0
  ds_read_b128 v[158:161], v187 offset:0
  ds_read_b128 v[162:165], v188 offset:0
  ds_read_b128 v[166:169], v189 offset:0
  s_waitcnt lgkmcnt(3)
  v_mfma_f32_32x32x16_bf16 v[106:121], v[154:157], v[10:13], 0
  v_sub_f32 v216, v216, v200
  v_sub_f32 v217, v217, v200
  v_sub_f32 v218, v218, v200
  v_sub_f32 v219, v219, v200
  v_sub_f32 v220, v220, v200
  v_sub_f32 v221, v221, v200
  ds_read_b128 v[154:157], v190 offset:0
  s_waitcnt lgkmcnt(3)
  v_mfma_f32_32x32x16_bf16 v[106:121], v[158:161], v[14:17], v[106:121]
  v_sub_f32 v222, v222, v200
  v_sub_f32 v223, v223, v200
  v_sub_f32 v224, v224, v200
  v_sub_f32 v225, v225, v200
  v_sub_f32 v226, v226, v200
  v_sub_f32 v227, v227, v200
  v_sub_f32 v228, v228, v200
  ds_read_b128 v[158:161], v191 offset:0
  s_waitcnt lgkmcnt(3)
  v_mfma_f32_32x32x16_bf16 v[106:121], v[162:165], v[18:21], v[106:121]
  v_sub_f32 v229, v229, v200
  v_sub_f32 v230, v230, v200
  v_sub_f32 v231, v231, v200
  v_exp_f32 v216, v216
  v_exp_f32 v217, v217
  v_exp_f32 v218, v218
  ds_read_b128 v[162:165], v192 offset:0
  s_waitcnt lgkmcnt(3)
  v_mfma_f32_32x32x16_bf16 v[106:121], v[166:169], v[22:25], v[106:121]
  v_exp_f32 v219, v219
  v_exp_f32 v220, v220
  v_exp_f32 v221, v221
  v_exp_f32 v222, v222
  v_exp_f32 v223, v223
  v_exp_f32 v224, v224
  v_exp_f32 v225, v225
  ds_read_b128 v[166:169], v193 offset:0
  s_waitcnt lgkmcnt(3)
  v_mfma_f32_32x32x16_bf16 v[106:121], v[154:157], v[26:29], v[106:121]
  v_exp_f32 v226, v226
  v_exp_f32 v227, v227
  v_exp_f32 v228, v228
  v_exp_f32 v229, v229
  v_exp_f32 v230, v230
  v_exp_f32 v231, v231
  v_add_f32 v206, v216, v217
  ds_read_b128 v[154:157], v186 offset:8192
  s_waitcnt lgkmcnt(3)
  v_mfma_f32_32x32x16_bf16 v[106:121], v[158:161], v[30:33], v[106:121]
  v_add_f32 v207, v218, v219
  v_add_f32 v206, v206, v220
  v_add_f32 v207, v207, v221
  v_add_f32 v206, v206, v222
  v_add_f32 v207, v207, v223
  v_add_f32 v206, v206, v224
  ds_read_b128 v[158:161], v187 offset:8192
  s_waitcnt lgkmcnt(3)
  v_mfma_f32_32x32x16_bf16 v[106:121], v[162:165], v[34:37], v[106:121]
  v_add_f32 v207, v207, v225
  v_add_f32 v206, v206, v226
  v_add_f32 v207, v207, v227
  v_add_f32 v206, v206, v228
  v_add_f32 v207, v207, v229
  v_add_f32 v206, v206, v230
  v_add_f32 v207, v207, v231
  ds_read_b128 v[162:165], v188 offset:8192
  s_waitcnt lgkmcnt(3)
  v_mfma_f32_32x32x16_bf16 v[106:121], v[166:169], v[38:41], v[106:121]
  v_cvt_pk_bf16_f32 v138, v216, v217
  v_cvt_pk_bf16_f32 v139, v218, v219
  v_cvt_pk_bf16_f32 v140, v220, v221
  v_cvt_pk_bf16_f32 v141, v222, v223
  v_cvt_pk_bf16_f32 v142, v224, v225
  v_cvt_pk_bf16_f32 v143, v226, v227
  v_cvt_pk_bf16_f32 v144, v228, v229
  v_cvt_pk_bf16_f32 v145, v230, v231
  v_add_f32 v206, v206, v207
  v_add_f32 v201, v201, v206
  ds_read_b128 v[166:169], v189 offset:8192
  s_waitcnt lgkmcnt(3)
  v_mfma_f32_32x32x16_bf16 v[122:137], v[154:157], v[10:13], 0
  v_sub_f32 v232, v232, v200
  v_sub_f32 v233, v233, v200
  v_sub_f32 v234, v234, v200
  v_sub_f32 v235, v235, v200
  v_sub_f32 v236, v236, v200
  v_sub_f32 v237, v237, v200
  ds_read_b128 v[154:157], v190 offset:8192
  s_waitcnt lgkmcnt(3)
  v_mfma_f32_32x32x16_bf16 v[122:137], v[158:161], v[14:17], v[122:137]
  v_sub_f32 v238, v238, v200
  v_sub_f32 v239, v239, v200
  v_sub_f32 v240, v240, v200
  v_sub_f32 v241, v241, v200
  v_sub_f32 v242, v242, v200
  v_sub_f32 v243, v243, v200
  v_sub_f32 v244, v244, v200
  ds_read_b128 v[158:161], v191 offset:8192
  s_waitcnt lgkmcnt(3)
  v_mfma_f32_32x32x16_bf16 v[122:137], v[162:165], v[18:21], v[122:137]
  v_sub_f32 v245, v245, v200
  v_sub_f32 v246, v246, v200
  v_sub_f32 v247, v247, v200
  v_exp_f32 v232, v232
  v_exp_f32 v233, v233
  v_exp_f32 v234, v234
  ds_read_b128 v[162:165], v192 offset:8192
  s_waitcnt lgkmcnt(3)
  v_mfma_f32_32x32x16_bf16 v[122:137], v[166:169], v[22:25], v[122:137]
  v_exp_f32 v235, v235
  v_exp_f32 v236, v236
  v_exp_f32 v237, v237
  v_exp_f32 v238, v238
  v_exp_f32 v239, v239
  v_exp_f32 v240, v240
  v_exp_f32 v241, v241
  ds_read_b128 v[166:169], v193 offset:8192
  s_waitcnt lgkmcnt(3)
  v_mfma_f32_32x32x16_bf16 v[122:137], v[154:157], v[26:29], v[122:137]
  v_exp_f32 v242, v242
  v_exp_f32 v243, v243
  v_exp_f32 v244, v244
  v_exp_f32 v245, v245
  v_exp_f32 v246, v246
  v_exp_f32 v247, v247
  v_add_f32 v206, v232, v233
  s_waitcnt lgkmcnt(2)
  v_mfma_f32_32x32x16_bf16 v[122:137], v[158:161], v[30:33], v[122:137]
  v_add_f32 v207, v234, v235
  v_add_f32 v206, v206, v236
  v_add_f32 v207, v207, v237
  v_add_f32 v206, v206, v238
  v_add_f32 v207, v207, v239
  v_add_f32 v206, v206, v240
  s_waitcnt lgkmcnt(1)
  v_mfma_f32_32x32x16_bf16 v[122:137], v[162:165], v[34:37], v[122:137]
  v_add_f32 v207, v207, v241
  v_add_f32 v206, v206, v242
  v_add_f32 v207, v207, v243
  v_add_f32 v206, v206, v244
  v_add_f32 v207, v207, v245
  v_add_f32 v206, v206, v246
  v_add_f32 v207, v207, v247
  s_waitcnt lgkmcnt(0)
  v_mfma_f32_32x32x16_bf16 v[122:137], v[166:169], v[38:41], v[122:137]
  v_cvt_pk_bf16_f32 v146, v232, v233
  v_cvt_pk_bf16_f32 v147, v234, v235
  v_cvt_pk_bf16_f32 v148, v236, v237
  v_cvt_pk_bf16_f32 v149, v238, v239
  v_cvt_pk_bf16_f32 v150, v240, v241
  v_cvt_pk_bf16_f32 v151, v242, v243
  v_cvt_pk_bf16_f32 v152, v244, v245
  v_cvt_pk_bf16_f32 v153, v246, v247
  v_add_f32 v206, v206, v207
  v_add_f32 v201, v201, v206
  s_nop 1
  ds_read_b64_tr_b16 v[154:155], v194 offset:49152
  ds_read_b64_tr_b16 v[156:157], v194 offset:51200
  ds_read_b64_tr_b16 v[158:159], v195 offset:49152
  ds_read_b64_tr_b16 v[160:161], v195 offset:51200
  ds_read_b64_tr_b16 v[162:163], v196 offset:49152
  ds_read_b64_tr_b16 v[164:165], v196 offset:51200
  ds_read_b64_tr_b16 v[166:167], v197 offset:49152
  ds_read_b64_tr_b16 v[168:169], v197 offset:51200
  ds_read_b64_tr_b16 v[170:171], v194 offset:53248
  ds_read_b64_tr_b16 v[172:173], v194 offset:55296
  ds_read_b64_tr_b16 v[174:175], v195 offset:53248
  ds_read_b64_tr_b16 v[176:177], v195 offset:55296
  ds_read_b64_tr_b16 v[178:179], v196 offset:53248
  ds_read_b64_tr_b16 v[180:181], v196 offset:55296
  ds_read_b64_tr_b16 v[182:183], v197 offset:53248
  ds_read_b64_tr_b16 v[184:185], v197 offset:55296
  s_waitcnt lgkmcnt(14)
  v_mfma_f32_32x32x16_bf16 v[42:57], v[154:157], v[138:141], v[42:57]
  ds_read_b64_tr_b16 v[154:155], v194 offset:57344
  ds_read_b64_tr_b16 v[156:157], v194 offset:59392
  s_waitcnt lgkmcnt(14)
  v_mfma_f32_32x32x16_bf16 v[58:73], v[158:161], v[138:141], v[58:73]
  ds_read_b64_tr_b16 v[158:159], v195 offset:57344
  ds_read_b64_tr_b16 v[160:161], v195 offset:59392
  s_waitcnt lgkmcnt(14)
  v_mfma_f32_32x32x16_bf16 v[74:89], v[162:165], v[138:141], v[74:89]
  ds_read_b64_tr_b16 v[162:163], v196 offset:57344
  ds_read_b64_tr_b16 v[164:165], v196 offset:59392
  s_waitcnt lgkmcnt(14)
  v_mfma_f32_32x32x16_bf16 v[90:105], v[166:169], v[138:141], v[90:105]
  ds_read_b64_tr_b16 v[166:167], v197 offset:57344
  ds_read_b64_tr_b16 v[168:169], v197 offset:59392
  s_waitcnt lgkmcnt(14)
  v_mfma_f32_32x32x16_bf16 v[42:57], v[170:173], v[142:145], v[42:57]
  ds_read_b64_tr_b16 v[170:171], v194 offset:61440
  ds_read_b64_tr_b16 v[172:173], v194 offset:63488
  s_waitcnt lgkmcnt(14)
  v_mfma_f32_32x32x16_bf16 v[58:73], v[174:177], v[142:145], v[58:73]
  ds_read_b64_tr_b16 v[174:175], v195 offset:61440
  ds_read_b64_tr_b16 v[176:177], v195 offset:63488
  s_waitcnt lgkmcnt(14)
  v_mfma_f32_32x32x16_bf16 v[74:89], v[178:181], v[142:145], v[74:89]
  ds_read_b64_tr_b16 v[178:179], v196 offset:61440
  ds_read_b64_tr_b16 v[180:181], v196 offset:63488
  s_waitcnt lgkmcnt(14)
  v_mfma_f32_32x32x16_bf16 v[90:105], v[182:185], v[142:145], v[90:105]
  ds_read_b64_tr_b16 v[182:183], v197 offset:61440
  ds_read_b64_tr_b16 v[184:185], v197 offset:63488
  s_waitcnt lgkmcnt(14)
  v_mfma_f32_32x32x16_bf16 v[42:57], v[154:157], v[146:149], v[42:57]
  s_waitcnt lgkmcnt(12)
  v_mfma_f32_32x32x16_bf16 v[58:73], v[158:161], v[146:149], v[58:73]
  s_waitcnt lgkmcnt(10)
  v_mfma_f32_32x32x16_bf16 v[74:89], v[162:165], v[146:149], v[74:89]
  s_waitcnt lgkmcnt(8)
  v_mfma_f32_32x32x16_bf16 v[90:105], v[166:169], v[146:149], v[90:105]
  s_waitcnt lgkmcnt(6)
  v_mfma_f32_32x32x16_bf16 v[42:57], v[170:173], v[150:153], v[42:57]
  s_waitcnt lgkmcnt(4)
  v_mfma_f32_32x32x16_bf16 v[58:73], v[174:177], v[150:153], v[58:73]
  s_waitcnt lgkmcnt(2)
  v_mfma_f32_32x32x16_bf16 v[74:89], v[178:181], v[150:153], v[74:89]
  s_waitcnt lgkmcnt(0)
  v_mfma_f32_32x32x16_bf16 v[90:105], v[182:185], v[150:153], v[90:105]
  s_add_u32 s15, s15, 2
  s_cmp_lt_u32 s15, s16
  s_cbranch_scc1 a_kernel_h1_loop
a_kernel_h1_mask:
  s_lshl_b32 s17, s10, 7
  v_subrev_u32 v202, s17, v202
  s_barrier
  v_cmp_lt_i32 vcc, v202, 0
  s_nop 1
  v_cndmask_b32 v106, v106, v203, vcc
  v_cmp_lt_i32 vcc, v202, 1
  s_nop 1
  v_cndmask_b32 v107, v107, v203, vcc
  v_cmp_lt_i32 vcc, v202, 2
  s_nop 1
  v_cndmask_b32 v108, v108, v203, vcc
  v_cmp_lt_i32 vcc, v202, 3
  s_nop 1
  v_cndmask_b32 v109, v109, v203, vcc
  v_cmp_lt_i32 vcc, v202, 8
  s_nop 1
  v_cndmask_b32 v110, v110, v203, vcc
  v_cmp_lt_i32 vcc, v202, 9
  s_nop 1
  v_cndmask_b32 v111, v111, v203, vcc
  v_cmp_lt_i32 vcc, v202, 10
  s_nop 1
  v_cndmask_b32 v112, v112, v203, vcc
  v_cmp_lt_i32 vcc, v202, 11
  s_nop 1
  v_cndmask_b32 v113, v113, v203, vcc
  v_cmp_lt_i32 vcc, v202, 16
  s_nop 1
  v_cndmask_b32 v114, v114, v203, vcc
  v_cmp_lt_i32 vcc, v202, 17
  s_nop 1
  v_cndmask_b32 v115, v115, v203, vcc
  v_cmp_lt_i32 vcc, v202, 18
  s_nop 1
  v_cndmask_b32 v116, v116, v203, vcc
  v_cmp_lt_i32 vcc, v202, 19
  s_nop 1
  v_cndmask_b32 v117, v117, v203, vcc
  v_cmp_lt_i32 vcc, v202, 24
  s_nop 1
  v_cndmask_b32 v118, v118, v203, vcc
  v_cmp_lt_i32 vcc, v202, 25
  s_nop 1
  v_cndmask_b32 v119, v119, v203, vcc
  v_cmp_lt_i32 vcc, v202, 26
  s_nop 1
  v_cndmask_b32 v120, v120, v203, vcc
  v_cmp_lt_i32 vcc, v202, 27
  s_nop 1
  v_cndmask_b32 v121, v121, v203, vcc
  v_cmp_lt_i32 vcc, v202, 32
  s_nop 1
  v_cndmask_b32 v122, v122, v203, vcc
  v_cmp_lt_i32 vcc, v202, 33
  s_nop 1
  v_cndmask_b32 v123, v123, v203, vcc
  v_cmp_lt_i32 vcc, v202, 34
  s_nop 1
  v_cndmask_b32 v124, v124, v203, vcc
  v_cmp_lt_i32 vcc, v202, 35
  s_nop 1
  v_cndmask_b32 v125, v125, v203, vcc
  v_cmp_lt_i32 vcc, v202, 40
  s_nop 1
  v_cndmask_b32 v126, v126, v203, vcc
  v_cmp_lt_i32 vcc, v202, 41
  s_nop 1
  v_cndmask_b32 v127, v127, v203, vcc
  v_cmp_lt_i32 vcc, v202, 42
  s_nop 1
  v_cndmask_b32 v128, v128, v203, vcc
  v_cmp_lt_i32 vcc, v202, 43
  s_nop 1
  v_cndmask_b32 v129, v129, v203, vcc
  v_cmp_lt_i32 vcc, v202, 48
  s_nop 1
  v_cndmask_b32 v130, v130, v203, vcc
  v_cmp_lt_i32 vcc, v202, 49
  s_nop 1
  v_cndmask_b32 v131, v131, v203, vcc
  v_cmp_lt_i32 vcc, v202, 50
  s_nop 1
  v_cndmask_b32 v132, v132, v203, vcc
  v_cmp_lt_i32 vcc, v202, 51
  s_nop 1
  v_cndmask_b32 v133, v133, v203, vcc
  v_cmp_lt_i32 vcc, v202, 56
  s_nop 1
  v_cndmask_b32 v134, v134, v203, vcc
  v_cmp_lt_i32 vcc, v202, 57
  s_nop 1
  v_cndmask_b32 v135, v135, v203, vcc
  v_cmp_lt_i32 vcc, v202, 58
  s_nop 1
  v_cndmask_b32 v136, v136, v203, vcc
  v_cmp_lt_i32 vcc, v202, 59
  s_nop 1
  v_cndmask_b32 v137, v137, v203, vcc
  v_max3_f32 v204, v106, v107, v108
  v_max3_f32 v205, v109, v110, v111
  v_max3_f32 v204, v204, v112, v113
  v_max3_f32 v205, v205, v114, v115
  v_max3_f32 v204, v204, v116, v117
  v_max3_f32 v205, v205, v118, v119
  v_max3_f32 v204, v204, v120, v121
  v_max3_f32 v205, v205, v122, v123
  v_max3_f32 v204, v204, v124, v125
  v_max3_f32 v205, v205, v126, v127
  v_max3_f32 v204, v204, v128, v129
  v_max3_f32 v205, v205, v130, v131
  v_max3_f32 v204, v204, v132, v133
  v_max3_f32 v205, v205, v134, v135
  v_max3_f32 v204, v204, v136, v137
  v_max_f32 v204, v204, v205
  v_mov_b32 v205, v204
  s_nop 1
  v_permlane32_swap_b32 v204, v205
  v_max_f32 v204, v204, v205
  v_sub_f32 v205, v204, v200
  v_cmp_gt_f32 vcc, v205, s28
  s_cbranch_vccz a_kernel_nors_7
  s_nop 15
  s_nop 15
  s_nop 7
  v_max_f32 v204, v204, v200
  v_sub_f32 v205, v200, v204
  v_exp_f32 v205, v205
  v_mov_b32 v200, v204
  v_mul_f32 v201, v205, v201
  v_mul_f32 v42, v205, v42
  v_mul_f32 v43, v205, v43
  v_mul_f32 v44, v205, v44
  v_mul_f32 v45, v205, v45
  v_mul_f32 v46, v205, v46
  v_mul_f32 v47, v205, v47
  v_mul_f32 v48, v205, v48
  v_mul_f32 v49, v205, v49
  v_mul_f32 v50, v205, v50
  v_mul_f32 v51, v205, v51
  v_mul_f32 v52, v205, v52
  v_mul_f32 v53, v205, v53
  v_mul_f32 v54, v205, v54
  v_mul_f32 v55, v205, v55
  v_mul_f32 v56, v205, v56
  v_mul_f32 v57, v205, v57
  v_mul_f32 v58, v205, v58
  v_mul_f32 v59, v205, v59
  v_mul_f32 v60, v205, v60
  v_mul_f32 v61, v205, v61
  v_mul_f32 v62, v205, v62
  v_mul_f32 v63, v205, v63
  v_mul_f32 v64, v205, v64
  v_mul_f32 v65, v205, v65
  v_mul_f32 v66, v205, v66
  v_mul_f32 v67, v205, v67
  v_mul_f32 v68, v205, v68
  v_mul_f32 v69, v205, v69
  v_mul_f32 v70, v205, v70
  v_mul_f32 v71, v205, v71
  v_mul_f32 v72, v205, v72
  v_mul_f32 v73, v205, v73
  v_mul_f32 v74, v205, v74
  v_mul_f32 v75, v205, v75
  v_mul_f32 v76, v205, v76
  v_mul_f32 v77, v205, v77
  v_mul_f32 v78, v205, v78
  v_mul_f32 v79, v205, v79
  v_mul_f32 v80, v205, v80
  v_mul_f32 v81, v205, v81
  v_mul_f32 v82, v205, v82
  v_mul_f32 v83, v205, v83
  v_mul_f32 v84, v205, v84
  v_mul_f32 v85, v205, v85
  v_mul_f32 v86, v205, v86
  v_mul_f32 v87, v205, v87
  v_mul_f32 v88, v205, v88
  v_mul_f32 v89, v205, v89
  v_mul_f32 v90, v205, v90
  v_mul_f32 v91, v205, v91
  v_mul_f32 v92, v205, v92
  v_mul_f32 v93, v205, v93
  v_mul_f32 v94, v205, v94
  v_mul_f32 v95, v205, v95
  v_mul_f32 v96, v205, v96
  v_mul_f32 v97, v205, v97
  v_mul_f32 v98, v205, v98
  v_mul_f32 v99, v205, v99
  v_mul_f32 v100, v205, v100
  v_mul_f32 v101, v205, v101
  v_mul_f32 v102, v205, v102
  v_mul_f32 v103, v205, v103
  v_mul_f32 v104, v205, v104
  v_mul_f32 v105, v205, v105
  s_nop 1
a_kernel_nors_7:
  ds_read_b128 v[154:157], v186 offset:32768
  ds_read_b128 v[158:161], v187 offset:32768
  ds_read_b128 v[162:165], v188 offset:32768
  ds_read_b128 v[166:169], v189 offset:32768
  s_waitcnt lgkmcnt(3)
  v_mfma_f32_32x32x16_bf16 v[216:231], v[154:157], v[10:13], 0
  v_sub_f32 v106, v106, v200
  v_sub_f32 v107, v107, v200
  v_sub_f32 v108, v108, v200
  v_sub_f32 v109, v109, v200
  v_sub_f32 v110, v110, v200
  v_sub_f32 v111, v111, v200
  ds_read_b128 v[154:157], v190 offset:32768
  s_waitcnt lgkmcnt(3)
  v_mfma_f32_32x32x16_bf16 v[216:231], v[158:161], v[14:17], v[216:231]
  v_sub_f32 v112, v112, v200
  v_sub_f32 v113, v113, v200
  v_sub_f32 v114, v114, v200
  v_sub_f32 v115, v115, v200
  v_sub_f32 v116, v116, v200
  v_sub_f32 v117, v117, v200
  v_sub_f32 v118, v118, v200
  ds_read_b128 v[158:161], v191 offset:32768
  s_waitcnt lgkmcnt(3)
  v_mfma_f32_32x32x16_bf16 v[216:231], v[162:165], v[18:21], v[216:231]
  v_sub_f32 v119, v119, v200
  v_sub_f32 v120, v120, v200
  v_sub_f32 v121, v121, v200
  v_exp_f32 v106, v106
  v_exp_f32 v107, v107
  v_exp_f32 v108, v108
  ds_read_b128 v[162:165], v192 offset:32768
  s_waitcnt lgkmcnt(3)
  v_mfma_f32_32x32x16_bf16 v[216:231], v[166:169], v[22:25], v[216:231]
  v_exp_f32 v109, v109
  v_exp_f32 v110, v110
  v_exp_f32 v111, v111
  v_exp_f32 v112, v112
  v_exp_f32 v113, v113
  v_exp_f32 v114, v114
  v_exp_f32 v115, v115
  ds_read_b128 v[166:169], v193 offset:32768
  s_waitcnt lgkmcnt(3)
  v_mfma_f32_32x32x16_bf16 v[216:231], v[154:157], v[26:29], v[216:231]
  v_exp_f32 v116, v116
  v_exp_f32 v117, v117
  v_exp_f32 v118, v118
  v_exp_f32 v119, v119
  v_exp_f32 v120, v120
  v_exp_f32 v121, v121
  v_add_f32 v206, v106, v107
  ds_read_b128 v[154:157], v186 offset:40960
  s_waitcnt lgkmcnt(3)
  v_mfma_f32_32x32x16_bf16 v[216:231], v[158:161], v[30:33], v[216:231]
  v_add_f32 v207, v108, v109
  v_add_f32 v206, v206, v110
  v_add_f32 v207, v207, v111
  v_add_f32 v206, v206, v112
  v_add_f32 v207, v207, v113
  v_add_f32 v206, v206, v114
  ds_read_b128 v[158:161], v187 offset:40960
  s_waitcnt lgkmcnt(3)
  v_mfma_f32_32x32x16_bf16 v[216:231], v[162:165], v[34:37], v[216:231]
  v_add_f32 v207, v207, v115
  v_add_f32 v206, v206, v116
  v_add_f32 v207, v207, v117
  v_add_f32 v206, v206, v118
  v_add_f32 v207, v207, v119
  v_add_f32 v206, v206, v120
  v_add_f32 v207, v207, v121
  ds_read_b128 v[162:165], v188 offset:40960
  s_waitcnt lgkmcnt(3)
  v_mfma_f32_32x32x16_bf16 v[216:231], v[166:169], v[38:41], v[216:231]
  v_cvt_pk_bf16_f32 v138, v106, v107
  v_cvt_pk_bf16_f32 v139, v108, v109
  v_cvt_pk_bf16_f32 v140, v110, v111
  v_cvt_pk_bf16_f32 v141, v112, v113
  v_cvt_pk_bf16_f32 v142, v114, v115
  v_cvt_pk_bf16_f32 v143, v116, v117
  v_cvt_pk_bf16_f32 v144, v118, v119
  v_cvt_pk_bf16_f32 v145, v120, v121
  v_add_f32 v206, v206, v207
  v_add_f32 v201, v201, v206
  ds_read_b128 v[166:169], v189 offset:40960
  s_waitcnt lgkmcnt(3)
  v_mfma_f32_32x32x16_bf16 v[232:247], v[154:157], v[10:13], 0
  v_sub_f32 v122, v122, v200
  v_sub_f32 v123, v123, v200
  v_sub_f32 v124, v124, v200
  v_sub_f32 v125, v125, v200
  v_sub_f32 v126, v126, v200
  v_sub_f32 v127, v127, v200
  ds_read_b128 v[154:157], v190 offset:40960
  s_waitcnt lgkmcnt(3)
  v_mfma_f32_32x32x16_bf16 v[232:247], v[158:161], v[14:17], v[232:247]
  v_sub_f32 v128, v128, v200
  v_sub_f32 v129, v129, v200
  v_sub_f32 v130, v130, v200
  v_sub_f32 v131, v131, v200
  v_sub_f32 v132, v132, v200
  v_sub_f32 v133, v133, v200
  v_sub_f32 v134, v134, v200
  ds_read_b128 v[158:161], v191 offset:40960
  s_waitcnt lgkmcnt(3)
  v_mfma_f32_32x32x16_bf16 v[232:247], v[162:165], v[18:21], v[232:247]
  v_sub_f32 v135, v135, v200
  v_sub_f32 v136, v136, v200
  v_sub_f32 v137, v137, v200
  v_exp_f32 v122, v122
  v_exp_f32 v123, v123
  v_exp_f32 v124, v124
  ds_read_b128 v[162:165], v192 offset:40960
  s_waitcnt lgkmcnt(3)
  v_mfma_f32_32x32x16_bf16 v[232:247], v[166:169], v[22:25], v[232:247]
  v_exp_f32 v125, v125
  v_exp_f32 v126, v126
  v_exp_f32 v127, v127
  v_exp_f32 v128, v128
  v_exp_f32 v129, v129
  v_exp_f32 v130, v130
  v_exp_f32 v131, v131
  ds_read_b128 v[166:169], v193 offset:40960
  s_waitcnt lgkmcnt(3)
  v_mfma_f32_32x32x16_bf16 v[232:247], v[154:157], v[26:29], v[232:247]
  v_exp_f32 v132, v132
  v_exp_f32 v133, v133
  v_exp_f32 v134, v134
  v_exp_f32 v135, v135
  v_exp_f32 v136, v136
  v_exp_f32 v137, v137
  v_add_f32 v206, v122, v123
  s_waitcnt lgkmcnt(2)
  v_mfma_f32_32x32x16_bf16 v[232:247], v[158:161], v[30:33], v[232:247]
  v_add_f32 v207, v124, v125
  v_add_f32 v206, v206, v126
  v_add_f32 v207, v207, v127
  v_add_f32 v206, v206, v128
  v_add_f32 v207, v207, v129
  v_add_f32 v206, v206, v130
  s_waitcnt lgkmcnt(1)
  v_mfma_f32_32x32x16_bf16 v[232:247], v[162:165], v[34:37], v[232:247]
  v_add_f32 v207, v207, v131
  v_add_f32 v206, v206, v132
  v_add_f32 v207, v207, v133
  v_add_f32 v206, v206, v134
  v_add_f32 v207, v207, v135
  v_add_f32 v206, v206, v136
  v_add_f32 v207, v207, v137
  s_waitcnt lgkmcnt(0)
  v_mfma_f32_32x32x16_bf16 v[232:247], v[166:169], v[38:41], v[232:247]
  v_cvt_pk_bf16_f32 v146, v122, v123
  v_cvt_pk_bf16_f32 v147, v124, v125
  v_cvt_pk_bf16_f32 v148, v126, v127
  v_cvt_pk_bf16_f32 v149, v128, v129
  v_cvt_pk_bf16_f32 v150, v130, v131
  v_cvt_pk_bf16_f32 v151, v132, v133
  v_cvt_pk_bf16_f32 v152, v134, v135
  v_cvt_pk_bf16_f32 v153, v136, v137
  v_add_f32 v206, v206, v207
  v_add_f32 v201, v201, v206
  s_nop 1
  ds_read_b64_tr_b16 v[154:155], v194 offset:16384
  ds_read_b64_tr_b16 v[156:157], v194 offset:18432
  ds_read_b64_tr_b16 v[158:159], v195 offset:16384
  ds_read_b64_tr_b16 v[160:161], v195 offset:18432
  ds_read_b64_tr_b16 v[162:163], v196 offset:16384
  ds_read_b64_tr_b16 v[164:165], v196 offset:18432
  ds_read_b64_tr_b16 v[166:167], v197 offset:16384
  ds_read_b64_tr_b16 v[168:169], v197 offset:18432
  ds_read_b64_tr_b16 v[170:171], v194 offset:20480
  ds_read_b64_tr_b16 v[172:173], v194 offset:22528
  ds_read_b64_tr_b16 v[174:175], v195 offset:20480
  ds_read_b64_tr_b16 v[176:177], v195 offset:22528
  ds_read_b64_tr_b16 v[178:179], v196 offset:20480
  ds_read_b64_tr_b16 v[180:181], v196 offset:22528
  ds_read_b64_tr_b16 v[182:183], v197 offset:20480
  ds_read_b64_tr_b16 v[184:185], v197 offset:22528
  s_waitcnt lgkmcnt(14)
  v_mfma_f32_32x32x16_bf16 v[42:57], v[154:157], v[138:141], v[42:57]
  ds_read_b64_tr_b16 v[154:155], v194 offset:24576
  ds_read_b64_tr_b16 v[156:157], v194 offset:26624
  s_waitcnt lgkmcnt(14)
  v_mfma_f32_32x32x16_bf16 v[58:73], v[158:161], v[138:141], v[58:73]
  ds_read_b64_tr_b16 v[158:159], v195 offset:24576
  ds_read_b64_tr_b16 v[160:161], v195 offset:26624
  s_waitcnt lgkmcnt(14)
  v_mfma_f32_32x32x16_bf16 v[74:89], v[162:165], v[138:141], v[74:89]
  ds_read_b64_tr_b16 v[162:163], v196 offset:24576
  ds_read_b64_tr_b16 v[164:165], v196 offset:26624
  s_waitcnt lgkmcnt(14)
  v_mfma_f32_32x32x16_bf16 v[90:105], v[166:169], v[138:141], v[90:105]
  ds_read_b64_tr_b16 v[166:167], v197 offset:24576
  ds_read_b64_tr_b16 v[168:169], v197 offset:26624
  s_waitcnt lgkmcnt(14)
  v_mfma_f32_32x32x16_bf16 v[42:57], v[170:173], v[142:145], v[42:57]
  ds_read_b64_tr_b16 v[170:171], v194 offset:28672
  ds_read_b64_tr_b16 v[172:173], v194 offset:30720
  s_waitcnt lgkmcnt(14)
  v_mfma_f32_32x32x16_bf16 v[58:73], v[174:177], v[142:145], v[58:73]
  ds_read_b64_tr_b16 v[174:175], v195 offset:28672
  ds_read_b64_tr_b16 v[176:177], v195 offset:30720
  s_waitcnt lgkmcnt(14)
  v_mfma_f32_32x32x16_bf16 v[74:89], v[178:181], v[142:145], v[74:89]
  ds_read_b64_tr_b16 v[178:179], v196 offset:28672
  ds_read_b64_tr_b16 v[180:181], v196 offset:30720
  s_waitcnt lgkmcnt(14)
  v_mfma_f32_32x32x16_bf16 v[90:105], v[182:185], v[142:145], v[90:105]
  ds_read_b64_tr_b16 v[182:183], v197 offset:28672
  ds_read_b64_tr_b16 v[184:185], v197 offset:30720
  s_waitcnt lgkmcnt(14)
  v_mfma_f32_32x32x16_bf16 v[42:57], v[154:157], v[146:149], v[42:57]
  s_waitcnt lgkmcnt(12)
  v_mfma_f32_32x32x16_bf16 v[58:73], v[158:161], v[146:149], v[58:73]
  s_waitcnt lgkmcnt(10)
  v_mfma_f32_32x32x16_bf16 v[74:89], v[162:165], v[146:149], v[74:89]
  s_waitcnt lgkmcnt(8)
  v_mfma_f32_32x32x16_bf16 v[90:105], v[166:169], v[146:149], v[90:105]
  s_waitcnt lgkmcnt(6)
  v_mfma_f32_32x32x16_bf16 v[42:57], v[170:173], v[150:153], v[42:57]
  s_waitcnt lgkmcnt(4)
  v_mfma_f32_32x32x16_bf16 v[58:73], v[174:177], v[150:153], v[58:73]
  s_waitcnt lgkmcnt(2)
  v_mfma_f32_32x32x16_bf16 v[74:89], v[178:181], v[150:153], v[74:89]
  s_waitcnt lgkmcnt(0)
  v_mfma_f32_32x32x16_bf16 v[90:105], v[182:185], v[150:153], v[90:105]
  v_subrev_u32 v202, 64, v202
  s_barrier
  v_cmp_lt_i32 vcc, v202, 0
  s_nop 1
  v_cndmask_b32 v216, v216, v203, vcc
  v_cmp_lt_i32 vcc, v202, 1
  s_nop 1
  v_cndmask_b32 v217, v217, v203, vcc
  v_cmp_lt_i32 vcc, v202, 2
  s_nop 1
  v_cndmask_b32 v218, v218, v203, vcc
  v_cmp_lt_i32 vcc, v202, 3
  s_nop 1
  v_cndmask_b32 v219, v219, v203, vcc
  v_cmp_lt_i32 vcc, v202, 8
  s_nop 1
  v_cndmask_b32 v220, v220, v203, vcc
  v_cmp_lt_i32 vcc, v202, 9
  s_nop 1
  v_cndmask_b32 v221, v221, v203, vcc
  v_cmp_lt_i32 vcc, v202, 10
  s_nop 1
  v_cndmask_b32 v222, v222, v203, vcc
  v_cmp_lt_i32 vcc, v202, 11
  s_nop 1
  v_cndmask_b32 v223, v223, v203, vcc
  v_cmp_lt_i32 vcc, v202, 16
  s_nop 1
  v_cndmask_b32 v224, v224, v203, vcc
  v_cmp_lt_i32 vcc, v202, 17
  s_nop 1
  v_cndmask_b32 v225, v225, v203, vcc
  v_cmp_lt_i32 vcc, v202, 18
  s_nop 1
  v_cndmask_b32 v226, v226, v203, vcc
  v_cmp_lt_i32 vcc, v202, 19
  s_nop 1
  v_cndmask_b32 v227, v227, v203, vcc
  v_cmp_lt_i32 vcc, v202, 24
  s_nop 1
  v_cndmask_b32 v228, v228, v203, vcc
  v_cmp_lt_i32 vcc, v202, 25
  s_nop 1
  v_cndmask_b32 v229, v229, v203, vcc
  v_cmp_lt_i32 vcc, v202, 26
  s_nop 1
  v_cndmask_b32 v230, v230, v203, vcc
  v_cmp_lt_i32 vcc, v202, 27
  s_nop 1
  v_cndmask_b32 v231, v231, v203, vcc
  v_cmp_lt_i32 vcc, v202, 32
  s_nop 1
  v_cndmask_b32 v232, v232, v203, vcc
  v_cmp_lt_i32 vcc, v202, 33
  s_nop 1
  v_cndmask_b32 v233, v233, v203, vcc
  v_cmp_lt_i32 vcc, v202, 34
  s_nop 1
  v_cndmask_b32 v234, v234, v203, vcc
  v_cmp_lt_i32 vcc, v202, 35
  s_nop 1
  v_cndmask_b32 v235, v235, v203, vcc
  v_cmp_lt_i32 vcc, v202, 40
  s_nop 1
  v_cndmask_b32 v236, v236, v203, vcc
  v_cmp_lt_i32 vcc, v202, 41
  s_nop 1
  v_cndmask_b32 v237, v237, v203, vcc
  v_cmp_lt_i32 vcc, v202, 42
  s_nop 1
  v_cndmask_b32 v238, v238, v203, vcc
  v_cmp_lt_i32 vcc, v202, 43
  s_nop 1
  v_cndmask_b32 v239, v239, v203, vcc
  v_cmp_lt_i32 vcc, v202, 48
  s_nop 1
  v_cndmask_b32 v240, v240, v203, vcc
  v_cmp_lt_i32 vcc, v202, 49
  s_nop 1
  v_cndmask_b32 v241, v241, v203, vcc
  v_cmp_lt_i32 vcc, v202, 50
  s_nop 1
  v_cndmask_b32 v242, v242, v203, vcc
  v_cmp_lt_i32 vcc, v202, 51
  s_nop 1
  v_cndmask_b32 v243, v243, v203, vcc
  v_cmp_lt_i32 vcc, v202, 56
  s_nop 1
  v_cndmask_b32 v244, v244, v203, vcc
  v_cmp_lt_i32 vcc, v202, 57
  s_nop 1
  v_cndmask_b32 v245, v245, v203, vcc
  v_cmp_lt_i32 vcc, v202, 58
  s_nop 1
  v_cndmask_b32 v246, v246, v203, vcc
  v_cmp_lt_i32 vcc, v202, 59
  s_nop 1
  v_cndmask_b32 v247, v247, v203, vcc
  v_max3_f32 v204, v216, v217, v218
  v_max3_f32 v205, v219, v220, v221
  v_max3_f32 v204, v204, v222, v223
  v_max3_f32 v205, v205, v224, v225
  v_max3_f32 v204, v204, v226, v227
  v_max3_f32 v205, v205, v228, v229
  v_max3_f32 v204, v204, v230, v231
  v_max3_f32 v205, v205, v232, v233
  v_max3_f32 v204, v204, v234, v235
  v_max3_f32 v205, v205, v236, v237
  v_max3_f32 v204, v204, v238, v239
  v_max3_f32 v205, v205, v240, v241
  v_max3_f32 v204, v204, v242, v243
  v_max3_f32 v205, v205, v244, v245
  v_max3_f32 v204, v204, v246, v247
  v_max_f32 v204, v204, v205
  v_mov_b32 v205, v204
  s_nop 1
  v_permlane32_swap_b32 v204, v205
  v_max_f32 v204, v204, v205
  v_sub_f32 v205, v204, v200
  v_cmp_gt_f32 vcc, v205, s28
  s_cbranch_vccz a_kernel_nors_8
  s_nop 15
  s_nop 15
  s_nop 7
  v_max_f32 v204, v204, v200
  v_sub_f32 v205, v200, v204
  v_exp_f32 v205, v205
  v_mov_b32 v200, v204
  v_mul_f32 v201, v205, v201
  v_mul_f32 v42, v205, v42
  v_mul_f32 v43, v205, v43
  v_mul_f32 v44, v205, v44
  v_mul_f32 v45, v205, v45
  v_mul_f32 v46, v205, v46
  v_mul_f32 v47, v205, v47
  v_mul_f32 v48, v205, v48
  v_mul_f32 v49, v205, v49
  v_mul_f32 v50, v205, v50
  v_mul_f32 v51, v205, v51
  v_mul_f32 v52, v205, v52
  v_mul_f32 v53, v205, v53
  v_mul_f32 v54, v205, v54
  v_mul_f32 v55, v205, v55
  v_mul_f32 v56, v205, v56
  v_mul_f32 v57, v205, v57
  v_mul_f32 v58, v205, v58
  v_mul_f32 v59, v205, v59
  v_mul_f32 v60, v205, v60
  v_mul_f32 v61, v205, v61
  v_mul_f32 v62, v205, v62
  v_mul_f32 v63, v205, v63
  v_mul_f32 v64, v205, v64
  v_mul_f32 v65, v205, v65
  v_mul_f32 v66, v205, v66
  v_mul_f32 v67, v205, v67
  v_mul_f32 v68, v205, v68
  v_mul_f32 v69, v205, v69
  v_mul_f32 v70, v205, v70
  v_mul_f32 v71, v205, v71
  v_mul_f32 v72, v205, v72
  v_mul_f32 v73, v205, v73
  v_mul_f32 v74, v205, v74
  v_mul_f32 v75, v205, v75
  v_mul_f32 v76, v205, v76
  v_mul_f32 v77, v205, v77
  v_mul_f32 v78, v205, v78
  v_mul_f32 v79, v205, v79
  v_mul_f32 v80, v205, v80
  v_mul_f32 v81, v205, v81
  v_mul_f32 v82, v205, v82
  v_mul_f32 v83, v205, v83
  v_mul_f32 v84, v205, v84
  v_mul_f32 v85, v205, v85
  v_mul_f32 v86, v205, v86
  v_mul_f32 v87, v205, v87
  v_mul_f32 v88, v205, v88
  v_mul_f32 v89, v205, v89
  v_mul_f32 v90, v205, v90
  v_mul_f32 v91, v205, v91
  v_mul_f32 v92, v205, v92
  v_mul_f32 v93, v205, v93
  v_mul_f32 v94, v205, v94
  v_mul_f32 v95, v205, v95
  v_mul_f32 v96, v205, v96
  v_mul_f32 v97, v205, v97
  v_mul_f32 v98, v205, v98
  v_mul_f32 v99, v205, v99
  v_mul_f32 v100, v205, v100
  v_mul_f32 v101, v205, v101
  v_mul_f32 v102, v205, v102
  v_mul_f32 v103, v205, v103
  v_mul_f32 v104, v205, v104
  v_mul_f32 v105, v205, v105
  s_nop 1
a_kernel_nors_8:
  v_sub_f32 v216, v216, v200
  v_sub_f32 v217, v217, v200
  v_sub_f32 v218, v218, v200
  v_sub_f32 v219, v219, v200
  v_sub_f32 v220, v220, v200
  v_sub_f32 v221, v221, v200
  v_sub_f32 v222, v222, v200
  v_sub_f32 v223, v223, v200
  v_sub_f32 v224, v224, v200
  v_sub_f32 v225, v225, v200
  v_sub_f32 v226, v226, v200
  v_sub_f32 v227, v227, v200
  v_sub_f32 v228, v228, v200
  v_sub_f32 v229, v229, v200
  v_sub_f32 v230, v230, v200
  v_sub_f32 v231, v231, v200
  v_exp_f32 v216, v216
  v_exp_f32 v217, v217
  v_exp_f32 v218, v218
  v_exp_f32 v219, v219
  v_exp_f32 v220, v220
  v_exp_f32 v221, v221
  v_exp_f32 v222, v222
  v_exp_f32 v223, v223
  v_exp_f32 v224, v224
  v_exp_f32 v225, v225
  v_exp_f32 v226, v226
  v_exp_f32 v227, v227
  v_exp_f32 v228, v228
  v_exp_f32 v229, v229
  v_exp_f32 v230, v230
  v_exp_f32 v231, v231
  v_add_f32 v206, v216, v217
  v_add_f32 v207, v218, v219
  v_add_f32 v206, v206, v220
  v_add_f32 v207, v207, v221
  v_add_f32 v206, v206, v222
  v_add_f32 v207, v207, v223
  v_add_f32 v206, v206, v224
  v_add_f32 v207, v207, v225
  v_add_f32 v206, v206, v226
  v_add_f32 v207, v207, v227
  v_add_f32 v206, v206, v228
  v_add_f32 v207, v207, v229
  v_add_f32 v206, v206, v230
  v_add_f32 v207, v207, v231
  v_cvt_pk_bf16_f32 v138, v216, v217
  v_cvt_pk_bf16_f32 v139, v218, v219
  v_cvt_pk_bf16_f32 v140, v220, v221
  v_cvt_pk_bf16_f32 v141, v222, v223
  v_cvt_pk_bf16_f32 v142, v224, v225
  v_cvt_pk_bf16_f32 v143, v226, v227
  v_cvt_pk_bf16_f32 v144, v228, v229
  v_cvt_pk_bf16_f32 v145, v230, v231
  v_add_f32 v206, v206, v207
  v_add_f32 v201, v201, v206
  v_sub_f32 v232, v232, v200
  v_sub_f32 v233, v233, v200
  v_sub_f32 v234, v234, v200
  v_sub_f32 v235, v235, v200
  v_sub_f32 v236, v236, v200
  v_sub_f32 v237, v237, v200
  v_sub_f32 v238, v238, v200
  v_sub_f32 v239, v239, v200
  v_sub_f32 v240, v240, v200
  v_sub_f32 v241, v241, v200
  v_sub_f32 v242, v242, v200
  v_sub_f32 v243, v243, v200
  v_sub_f32 v244, v244, v200
  v_sub_f32 v245, v245, v200
  v_sub_f32 v246, v246, v200
  v_sub_f32 v247, v247, v200
  v_exp_f32 v232, v232
  v_exp_f32 v233, v233
  v_exp_f32 v234, v234
  v_exp_f32 v235, v235
  v_exp_f32 v236, v236
  v_exp_f32 v237, v237
  v_exp_f32 v238, v238
  v_exp_f32 v239, v239
  v_exp_f32 v240, v240
  v_exp_f32 v241, v241
  v_exp_f32 v242, v242
  v_exp_f32 v243, v243
  v_exp_f32 v244, v244
  v_exp_f32 v245, v245
  v_exp_f32 v246, v246
  v_exp_f32 v247, v247
  v_add_f32 v206, v232, v233
  v_add_f32 v207, v234, v235
  v_add_f32 v206, v206, v236
  v_add_f32 v207, v207, v237
  v_add_f32 v206, v206, v238
  v_add_f32 v207, v207, v239
  v_add_f32 v206, v206, v240
  v_add_f32 v207, v207, v241
  v_add_f32 v206, v206, v242
  v_add_f32 v207, v207, v243
  v_add_f32 v206, v206, v244
  v_add_f32 v207, v207, v245
  v_add_f32 v206, v206, v246
  v_add_f32 v207, v207, v247
  v_cvt_pk_bf16_f32 v146, v232, v233
  v_cvt_pk_bf16_f32 v147, v234, v235
  v_cvt_pk_bf16_f32 v148, v236, v237
  v_cvt_pk_bf16_f32 v149, v238, v239
  v_cvt_pk_bf16_f32 v150, v240, v241
  v_cvt_pk_bf16_f32 v151, v242, v243
  v_cvt_pk_bf16_f32 v152, v244, v245
  v_cvt_pk_bf16_f32 v153, v246, v247
  v_add_f32 v206, v206, v207
  v_add_f32 v201, v201, v206
  s_nop 1
  ds_read_b64_tr_b16 v[154:155], v194 offset:49152
  ds_read_b64_tr_b16 v[156:157], v194 offset:51200
  ds_read_b64_tr_b16 v[158:159], v195 offset:49152
  ds_read_b64_tr_b16 v[160:161], v195 offset:51200
  ds_read_b64_tr_b16 v[162:163], v196 offset:49152
  ds_read_b64_tr_b16 v[164:165], v196 offset:51200
  ds_read_b64_tr_b16 v[166:167], v197 offset:49152
  ds_read_b64_tr_b16 v[168:169], v197 offset:51200
  ds_read_b64_tr_b16 v[170:171], v194 offset:53248
  ds_read_b64_tr_b16 v[172:173], v194 offset:55296
  ds_read_b64_tr_b16 v[174:175], v195 offset:53248
  ds_read_b64_tr_b16 v[176:177], v195 offset:55296
  ds_read_b64_tr_b16 v[178:179], v196 offset:53248
  ds_read_b64_tr_b16 v[180:181], v196 offset:55296
  ds_read_b64_tr_b16 v[182:183], v197 offset:53248
  ds_read_b64_tr_b16 v[184:185], v197 offset:55296
  s_waitcnt lgkmcnt(14)
  v_mfma_f32_32x32x16_bf16 v[42:57], v[154:157], v[138:141], v[42:57]
  ds_read_b64_tr_b16 v[154:155], v194 offset:57344
  ds_read_b64_tr_b16 v[156:157], v194 offset:59392
  s_waitcnt lgkmcnt(14)
  v_mfma_f32_32x32x16_bf16 v[58:73], v[158:161], v[138:141], v[58:73]
  ds_read_b64_tr_b16 v[158:159], v195 offset:57344
  ds_read_b64_tr_b16 v[160:161], v195 offset:59392
  s_waitcnt lgkmcnt(14)
  v_mfma_f32_32x32x16_bf16 v[74:89], v[162:165], v[138:141], v[74:89]
  ds_read_b64_tr_b16 v[162:163], v196 offset:57344
  ds_read_b64_tr_b16 v[164:165], v196 offset:59392
  s_waitcnt lgkmcnt(14)
  v_mfma_f32_32x32x16_bf16 v[90:105], v[166:169], v[138:141], v[90:105]
  ds_read_b64_tr_b16 v[166:167], v197 offset:57344
  ds_read_b64_tr_b16 v[168:169], v197 offset:59392
  s_waitcnt lgkmcnt(14)
  v_mfma_f32_32x32x16_bf16 v[42:57], v[170:173], v[142:145], v[42:57]
  ds_read_b64_tr_b16 v[170:171], v194 offset:61440
  ds_read_b64_tr_b16 v[172:173], v194 offset:63488
  s_waitcnt lgkmcnt(14)
  v_mfma_f32_32x32x16_bf16 v[58:73], v[174:177], v[142:145], v[58:73]
  ds_read_b64_tr_b16 v[174:175], v195 offset:61440
  ds_read_b64_tr_b16 v[176:177], v195 offset:63488
  s_waitcnt lgkmcnt(14)
  v_mfma_f32_32x32x16_bf16 v[74:89], v[178:181], v[142:145], v[74:89]
  ds_read_b64_tr_b16 v[178:179], v196 offset:61440
  ds_read_b64_tr_b16 v[180:181], v196 offset:63488
  s_waitcnt lgkmcnt(14)
  v_mfma_f32_32x32x16_bf16 v[90:105], v[182:185], v[142:145], v[90:105]
  ds_read_b64_tr_b16 v[182:183], v197 offset:61440
  ds_read_b64_tr_b16 v[184:185], v197 offset:63488
  s_waitcnt lgkmcnt(14)
  v_mfma_f32_32x32x16_bf16 v[42:57], v[154:157], v[146:149], v[42:57]
  s_waitcnt lgkmcnt(12)
  v_mfma_f32_32x32x16_bf16 v[58:73], v[158:161], v[146:149], v[58:73]
  s_waitcnt lgkmcnt(10)
  v_mfma_f32_32x32x16_bf16 v[74:89], v[162:165], v[146:149], v[74:89]
  s_waitcnt lgkmcnt(8)
  v_mfma_f32_32x32x16_bf16 v[90:105], v[166:169], v[146:149], v[90:105]
  s_waitcnt lgkmcnt(6)
  v_mfma_f32_32x32x16_bf16 v[42:57], v[170:173], v[150:153], v[42:57]
  s_waitcnt lgkmcnt(4)
  v_mfma_f32_32x32x16_bf16 v[58:73], v[174:177], v[150:153], v[58:73]
  s_waitcnt lgkmcnt(2)
  v_mfma_f32_32x32x16_bf16 v[74:89], v[178:181], v[150:153], v[74:89]
  s_waitcnt lgkmcnt(0)
  v_mfma_f32_32x32x16_bf16 v[90:105], v[182:185], v[150:153], v[90:105]
  s_nop 15
  s_nop 3
  v_mov_b32 v204, v201
  v_mov_b32 v205, v201
  s_nop 1
  v_permlane32_swap_b32 v204, v205
  v_add_f32 v204, v204, v205
  v_rcp_f32 v204, v204
  v_and_b32 v2, 31, v1
  v_lshlrev_b32 v3, 13, v2
  v_lshrrev_b32 v4, 5, v1
  v_lshlrev_b32 v4, 4, v4
  v_add_u32 v212, v3, v4
  s_lshl_b32 s21, s10, 7
  s_lshl_b32 s22, s8, 5
  s_add_u32 s21, s21, s22
  s_lshl_b32 s21, s21, 13
  s_lshl_b32 s22, s9, 8
  s_add_u32 s21, s21, s22
  s_add_u32 s21, s21, 0x3000000
  v_mul_f32 v42, v204, v42
  v_mul_f32 v43, v204, v43
  v_mul_f32 v44, v204, v44
  v_mul_f32 v45, v204, v45
  v_mul_f32 v46, v204, v46
  v_mul_f32 v47, v204, v47
  v_mul_f32 v48, v204, v48
  v_mul_f32 v49, v204, v49
  v_cvt_pk_bf16_f32 v106, v42, v43
  v_cvt_pk_bf16_f32 v107, v44, v45
  v_cvt_pk_bf16_f32 v108, v46, v47
  v_cvt_pk_bf16_f32 v109, v48, v49
  s_nop 1
  v_permlane32_swap_b32 v106, v108
  v_permlane32_swap_b32 v107, v109
  buffer_store_dwordx4 v[106:109], v212, s[4:7], s21 offen offset:0
  v_mul_f32 v50, v204, v50
  v_mul_f32 v51, v204, v51
  v_mul_f32 v52, v204, v52
  v_mul_f32 v53, v204, v53
  v_mul_f32 v54, v204, v54
  v_mul_f32 v55, v204, v55
  v_mul_f32 v56, v204, v56
  v_mul_f32 v57, v204, v57
  v_cvt_pk_bf16_f32 v110, v50, v51
  v_cvt_pk_bf16_f32 v111, v52, v53
  v_cvt_pk_bf16_f32 v112, v54, v55
  v_cvt_pk_bf16_f32 v113, v56, v57
  s_nop 1
  v_permlane32_swap_b32 v110, v112
  v_permlane32_swap_b32 v111, v113
  buffer_store_dwordx4 v[110:113], v212, s[4:7], s21 offen offset:32
  v_mul_f32 v58, v204, v58
  v_mul_f32 v59, v204, v59
  v_mul_f32 v60, v204, v60
  v_mul_f32 v61, v204, v61
  v_mul_f32 v62, v204, v62
  v_mul_f32 v63, v204, v63
  v_mul_f32 v64, v204, v64
  v_mul_f32 v65, v204, v65
  v_cvt_pk_bf16_f32 v106, v58, v59
  v_cvt_pk_bf16_f32 v107, v60, v61
  v_cvt_pk_bf16_f32 v108, v62, v63
  v_cvt_pk_bf16_f32 v109, v64, v65
  s_nop 1
  v_permlane32_swap_b32 v106, v108
  v_permlane32_swap_b32 v107, v109
  buffer_store_dwordx4 v[106:109], v212, s[4:7], s21 offen offset:64
  v_mul_f32 v66, v204, v66
  v_mul_f32 v67, v204, v67
  v_mul_f32 v68, v204, v68
  v_mul_f32 v69, v204, v69
  v_mul_f32 v70, v204, v70
  v_mul_f32 v71, v204, v71
  v_mul_f32 v72, v204, v72
  v_mul_f32 v73, v204, v73
  v_cvt_pk_bf16_f32 v110, v66, v67
  v_cvt_pk_bf16_f32 v111, v68, v69
  v_cvt_pk_bf16_f32 v112, v70, v71
  v_cvt_pk_bf16_f32 v113, v72, v73
  s_nop 1
  v_permlane32_swap_b32 v110, v112
  v_permlane32_swap_b32 v111, v113
  buffer_store_dwordx4 v[110:113], v212, s[4:7], s21 offen offset:96
  v_mul_f32 v74, v204, v74
  v_mul_f32 v75, v204, v75
  v_mul_f32 v76, v204, v76
  v_mul_f32 v77, v204, v77
  v_mul_f32 v78, v204, v78
  v_mul_f32 v79, v204, v79
  v_mul_f32 v80, v204, v80
  v_mul_f32 v81, v204, v81
  v_cvt_pk_bf16_f32 v106, v74, v75
  v_cvt_pk_bf16_f32 v107, v76, v77
  v_cvt_pk_bf16_f32 v108, v78, v79
  v_cvt_pk_bf16_f32 v109, v80, v81
  s_nop 1
  v_permlane32_swap_b32 v106, v108
  v_permlane32_swap_b32 v107, v109
  buffer_store_dwordx4 v[106:109], v212, s[4:7], s21 offen offset:128
  v_mul_f32 v82, v204, v82
  v_mul_f32 v83, v204, v83
  v_mul_f32 v84, v204, v84
  v_mul_f32 v85, v204, v85
  v_mul_f32 v86, v204, v86
  v_mul_f32 v87, v204, v87
  v_mul_f32 v88, v204, v88
  v_mul_f32 v89, v204, v89
  v_cvt_pk_bf16_f32 v110, v82, v83
  v_cvt_pk_bf16_f32 v111, v84, v85
  v_cvt_pk_bf16_f32 v112, v86, v87
  v_cvt_pk_bf16_f32 v113, v88, v89
  s_nop 1
  v_permlane32_swap_b32 v110, v112
  v_permlane32_swap_b32 v111, v113
  buffer_store_dwordx4 v[110:113], v212, s[4:7], s21 offen offset:160
  v_mul_f32 v90, v204, v90
  v_mul_f32 v91, v204, v91
  v_mul_f32 v92, v204, v92
  v_mul_f32 v93, v204, v93
  v_mul_f32 v94, v204, v94
  v_mul_f32 v95, v204, v95
  v_mul_f32 v96, v204, v96
  v_mul_f32 v97, v204, v97
  v_cvt_pk_bf16_f32 v106, v90, v91
  v_cvt_pk_bf16_f32 v107, v92, v93
  v_cvt_pk_bf16_f32 v108, v94, v95
  v_cvt_pk_bf16_f32 v109, v96, v97
  s_nop 1
  v_permlane32_swap_b32 v106, v108
  v_permlane32_swap_b32 v107, v109
  buffer_store_dwordx4 v[106:109], v212, s[4:7], s21 offen offset:192
  v_mul_f32 v98, v204, v98
  v_mul_f32 v99, v204, v99
  v_mul_f32 v100, v204, v100
  v_mul_f32 v101, v204, v101
  v_mul_f32 v102, v204, v102
  v_mul_f32 v103, v204, v103
  v_mul_f32 v104, v204, v104
  v_mul_f32 v105, v204, v105
  v_cvt_pk_bf16_f32 v110, v98, v99
  v_cvt_pk_bf16_f32 v111, v100, v101
  v_cvt_pk_bf16_f32 v112, v102, v103
  v_cvt_pk_bf16_f32 v113, v104, v105
  s_nop 1
  v_permlane32_swap_b32 v110, v112
  v_permlane32_swap_b32 v111, v113
  buffer_store_dwordx4 v[110:113], v212, s[4:7], s21 offen offset:224
  s_waitcnt vmcnt(0)
  s_branch a_kernel_end
a_kernel_prod:
  s_mov_b32 s9, s30
  s_mov_b32 s26, s31
  s_mov_b32 s4, s40
  s_mov_b32 s5, s41
  s_mov_b32 s6, 0x4000000
  s_mov_b32 s7, 0x20000
  v_and_b32 v1, 63, v0
  v_lshrrev_b32 v2, 6, v0
  s_nop 0
  v_readfirstlane_b32 s8, v2
  s_nop 3
  s_lshl_b32 s13, s8, 12
  s_add_u32 s14, s13, 16384
  v_lshrrev_b32 v2, 4, v1
  v_and_b32 v3, 15, v1
  v_xor_b32 v4, v3, v2
  v_lshlrev_b32 v4, 4, v4
  v_lshlrev_b32 v5, 8, v2
  v_add_u32 v198, v4, v5
  v_lshlrev_b32 v4, 2, v2
  v_xor_b32 v4, v3, v4
  v_lshlrev_b32 v4, 4, v4
  v_add_u32 v199, v4, v5
  v_and_b32 v4, 31, v1
  v_lshlrev_b32 v4, 8, v4
  v_lshrrev_b32 v5, 5, v1
  v_xor_b32 v6, v5, v3
  v_lshlrev_b32 v6, 4, v6
  v_add_u32 v186, v4, v6
  v_xor_b32 v187, 32, v186
  v_xor_b32 v188, 64, v186
  v_xor_b32 v189, 96, v186
  v_xor_b32 v190, 128, v186
  v_xor_b32 v191, 160, v186
  v_xor_b32 v192, 192, v186
  v_xor_b32 v193, 224, v186
  v_bfe_u32 v6, v1, 4, 1
  v_bfe_u32 v7, v1, 2, 2
  v_and_b32 v8, 3, v1
  v_lshlrev_b32 v9, 2, v5
  v_add_u32 v9, v9, v7
  v_lshlrev_b32 v9, 8, v9
  v_and_b32 v4, 1, v8
  v_lshlrev_b32 v4, 3, v4
  v_add_u32 v9, v9, v4
  v_lshrrev_b32 v8, 1, v8
  v_lshlrev_b32 v6, 1, v6
  v_add_u32 v8, v8, v6
  v_lshlrev_b32 v7, 2, v7
  v_add_u32 v4, 0, v8
  v_xor_b32 v4, v4, v7
  v_lshlrev_b32 v4, 4, v4
  v_add_u32 v194, v9, v4
  v_add_u32 v4, 4, v8
  v_xor_b32 v4, v4, v7
  v_lshlrev_b32 v4, 4, v4
  v_add_u32 v195, v9, v4
  v_add_u32 v4, 8, v8
  v_xor_b32 v4, v4, v7
  v_lshlrev_b32 v4, 4, v4
  v_add_u32 v196, v9, v4
  v_add_u32 v4, 12, v8
  v_xor_b32 v4, v4, v7
  v_lshlrev_b32 v4, 4, v4
  v_add_u32 v197, v9, v4
  v_mov_b32 v203, 0xff800000
  s_mov_b32 s28, 0x41000000
  s_mov_b32 s10, s26
  s_lshl_b32 s20, s9, 19
  s_add_u32 s11, s20, 0x1000000
  s_add_u32 s12, s20, 0x2000000
  s_mov_b32 m0, 0
  v_xor_b32 v2, 0, v198
  buffer_load_dwordx4 v2, s[4:7], s11 offen lds
  s_add_u32 s11, s11, 1024
  s_mov_b32 m0, 1024
  v_xor_b32 v2, 64, v198
  buffer_load_dwordx4 v2, s[4:7], s11 offen lds
  s_add_u32 s11, s11, 1024
  s_mov_b32 m0, 2048
  v_xor_b32 v2, 128, v198
  buffer_load_dwordx4 v2, s[4:7], s11 offen lds
  s_add_u32 s11, s11, 1024
  s_mov_b32 m0, 3072
  v_xor_b32 v2, 192, v198
  buffer_load_dwordx4 v2, s[4:7], s11 offen lds
  s_add_u32 s11, s11, 1024
  s_mov_b32 m0, 4096
  v_xor_b32 v2, 0, v198
  buffer_load_dwordx4 v2, s[4:7], s11 offen lds
  s_add_u32 s11, s11, 1024
  s_mov_b32 m0, 5120
  v_xor_b32 v2, 64, v198
  buffer_load_dwordx4 v2, s[4:7], s11 offen lds
  s_add_u32 s11, s11, 1024
  s_mov_b32 m0, 6144
  v_xor_b32 v2, 128, v198
  buffer_load_dwordx4 v2, s[4:7], s11 offen lds
  s_add_u32 s11, s11, 1024
  s_mov_b32 m0, 7168
  v_xor_b32 v2, 192, v198
  buffer_load_dwordx4 v2, s[4:7], s11 offen lds
  s_add_u32 s11, s11, 1024
  s_mov_b32 m0, 8192
  v_xor_b32 v2, 0, v198
  buffer_load_dwordx4 v2, s[4:7], s11 offen lds
  s_add_u32 s11, s11, 1024
  s_mov_b32 m0, 9216
  v_xor_b32 v2, 64, v198
  buffer_load_dwordx4 v2, s[4:7], s11 offen lds
  s_add_u32 s11, s11, 1024
  s_mov_b32 m0, 10240
  v_xor_b32 v2, 128, v198
  buffer_load_dwordx4 v2, s[4:7], s11 offen lds
  s_add_u32 s11, s11, 1024
  s_mov_b32 m0, 11264
  v_xor_b32 v2, 192, v198
  buffer_load_dwordx4 v2, s[4:7], s11 offen lds
  s_add_u32 s11, s11, 1024
  s_mov_b32 m0, 12288
  v_xor_b32 v2, 0, v198
  buffer_load_dwordx4 v2, s[4:7], s11 offen lds
  s_add_u32 s11, s11, 1024
  s_mov_b32 m0, 13312
  v_xor_b32 v2, 64, v198
  buffer_load_dwordx4 v2, s[4:7], s11 offen lds
  s_add_u32 s11, s11, 1024
  s_mov_b32 m0, 14336
  v_xor_b32 v2, 128, v198
  buffer_load_dwordx4 v2, s[4:7], s11 offen lds
  s_add_u32 s11, s11, 1024
  s_mov_b32 m0, 15360
  v_xor_b32 v2, 192, v198
  buffer_load_dwordx4 v2, s[4:7], s11 offen lds
  s_add_u32 s11, s11, 1024
  s_mov_b32 m0, 32768
  v_xor_b32 v2, 0, v198
  buffer_load_dwordx4 v2, s[4:7], s11 offen lds
  s_add_u32 s11, s11, 1024
  s_mov_b32 m0, 33792
  v_xor_b32 v2, 64, v198
  buffer_load_dwordx4 v2, s[4:7], s11 offen lds
  s_add_u32 s11, s11, 1024
  s_mov_b32 m0, 34816
  v_xor_b32 v2, 128, v198
  buffer_load_dwordx4 v2, s[4:7], s11 offen lds
  s_add_u32 s11, s11, 1024
  s_mov_b32 m0, 35840
  v_xor_b32 v2, 192, v198
  buffer_load_dwordx4 v2, s[4:7], s11 offen lds
  s_add_u32 s11, s11, 1024
  s_mov_b32 m0, 36864
  v_xor_b32 v2, 0, v198
  buffer_load_dwordx4 v2, s[4:7], s11 offen lds
  s_add_u32 s11, s11, 1024
  s_mov_b32 m0, 37888
  v_xor_b32 v2, 64, v198
  buffer_load_dwordx4 v2, s[4:7], s11 offen lds
  s_add_u32 s11, s11, 1024
  s_mov_b32 m0, 38912
  v_xor_b32 v2, 128, v198
  buffer_load_dwordx4 v2, s[4:7], s11 offen lds
  s_add_u32 s11, s11, 1024
  s_mov_b32 m0, 39936
  v_xor_b32 v2, 192, v198
  buffer_load_dwordx4 v2, s[4:7], s11 offen lds
  s_add_u32 s11, s11, 1024
  s_mov_b32 m0, 40960
  v_xor_b32 v2, 0, v198
  buffer_load_dwordx4 v2, s[4:7], s11 offen lds
  s_add_u32 s11, s11, 1024
  s_mov_b32 m0, 41984
  v_xor_b32 v2, 64, v198
  buffer_load_dwordx4 v2, s[4:7], s11 offen lds
  s_add_u32 s11, s11, 1024
  s_mov_b32 m0, 43008
  v_xor_b32 v2, 128, v198
  buffer_load_dwordx4 v2, s[4:7], s11 offen lds
  s_add_u32 s11, s11, 1024
  s_mov_b32 m0, 44032
  v_xor_b32 v2, 192, v198
  buffer_load_dwordx4 v2, s[4:7], s11 offen lds
  s_add_u32 s11, s11, 1024
  s_mov_b32 m0, 45056
  v_xor_b32 v2, 0, v198
  buffer_load_dwordx4 v2, s[4:7], s11 offen lds
  s_add_u32 s11, s11, 1024
  s_mov_b32 m0, 46080
  v_xor_b32 v2, 64, v198
  buffer_load_dwordx4 v2, s[4:7], s11 offen lds
  s_add_u32 s11, s11, 1024
  s_mov_b32 m0, 47104
  v_xor_b32 v2, 128, v198
  buffer_load_dwordx4 v2, s[4:7], s11 offen lds
  s_add_u32 s11, s11, 1024
  s_mov_b32 m0, 48128
  v_xor_b32 v2, 192, v198
  buffer_load_dwordx4 v2, s[4:7], s11 offen lds
  s_add_u32 s11, s11, 1024
  s_mov_b32 m0, 16384
  s_nop 0
  buffer_load_dwordx4 v199, s[4:7], s12 offen lds
  s_add_u32 s12, s12, 1024
  s_mov_b32 m0, 17408
  s_nop 0
  buffer_load_dwordx4 v199, s[4:7], s12 offen lds
  s_add_u32 s12, s12, 1024
  s_mov_b32 m0, 18432
  s_nop 0
  buffer_load_dwordx4 v199, s[4:7], s12 offen lds
  s_add_u32 s12, s12, 1024
  s_mov_b32 m0, 19456
  s_nop 0
  buffer_load_dwordx4 v199, s[4:7], s12 offen lds
  s_add_u32 s12, s12, 1024
  s_mov_b32 m0, 20480
  s_nop 0
  buffer_load_dwordx4 v199, s[4:7], s12 offen lds
  s_add_u32 s12, s12, 1024
  s_mov_b32 m0, 21504
  s_nop 0
  buffer_load_dwordx4 v199, s[4:7], s12 offen lds
  s_add_u32 s12, s12, 1024
  s_mov_b32 m0, 22528
  s_nop 0
  buffer_load_dwordx4 v199, s[4:7], s12 offen lds
  s_add_u32 s12, s12, 1024
  s_mov_b32 m0, 23552
  s_nop 0
  buffer_load_dwordx4 v199, s[4:7], s12 offen lds
  s_add_u32 s12, s12, 1024
  s_mov_b32 m0, 24576
  s_nop 0
  buffer_load_dwordx4 v199, s[4:7], s12 offen lds
  s_add_u32 s12, s12, 1024
  s_mov_b32 m0, 25600
  s_nop 0
  buffer_load_dwordx4 v199, s[4:7], s12 offen lds
  s_add_u32 s12, s12, 1024
  s_mov_b32 m0, 26624
  s_nop 0
  buffer_load_dwordx4 v199, s[4:7], s12 offen lds
  s_add_u32 s12, s12, 1024
  s_mov_b32 m0, 27648
  s_nop 0
  buffer_load_dwordx4 v199, s[4:7], s12 offen lds
  s_add_u32 s12, s12, 1024
  s_mov_b32 m0, 28672
  s_nop 0
  buffer_load_dwordx4 v199, s[4:7], s12 offen lds
  s_add_u32 s12, s12, 1024
  s_mov_b32 m0, 29696
  s_nop 0
  buffer_load_dwordx4 v199, s[4:7], s12 offen lds
  s_add_u32 s12, s12, 1024
  s_mov_b32 m0, 30720
  s_nop 0
  buffer_load_dwordx4 v199, s[4:7], s12 offen lds
  s_add_u32 s12, s12, 1024
  s_mov_b32 m0, 31744
  s_nop 0
  buffer_load_dwordx4 v199, s[4:7], s12 offen lds
  s_add_u32 s12, s12, 1024
  s_waitcnt vmcnt(0)
  s_barrier
  s_lshl_b32 s16, s10, 1
  s_mov_b32 s15, 0
  s_cmp_ge_u32 s15, s16
  s_cbranch_scc1 a_kernel_p0_mask
a_kernel_p0_loop:
  s_waitcnt vmcnt(0)
  s_barrier
  s_mov_b32 m0, 0
  v_xor_b32 v2, 0, v198
  buffer_load_dwordx4 v2, s[4:7], s11 offen lds
  s_add_u32 s11, s11, 1024
  s_mov_b32 m0, 1024
  v_xor_b32 v2, 64, v198
  buffer_load_dwordx4 v2, s[4:7], s11 offen lds
  s_add_u32 s11, s11, 1024
  s_mov_b32 m0, 2048
  v_xor_b32 v2, 128, v198
  buffer_load_dwordx4 v2, s[4:7], s11 offen lds
  s_add_u32 s11, s11, 1024
  s_mov_b32 m0, 3072
  v_xor_b32 v2, 192, v198
  buffer_load_dwordx4 v2, s[4:7], s11 offen lds
  s_add_u32 s11, s11, 1024
  s_mov_b32 m0, 4096
  v_xor_b32 v2, 0, v198
  buffer_load_dwordx4 v2, s[4:7], s11 offen lds
  s_add_u32 s11, s11, 1024
  s_mov_b32 m0, 5120
  v_xor_b32 v2, 64, v198
  buffer_load_dwordx4 v2, s[4:7], s11 offen lds
  s_add_u32 s11, s11, 1024
  s_mov_b32 m0, 6144
  v_xor_b32 v2, 128, v198
  buffer_load_dwordx4 v2, s[4:7], s11 offen lds
  s_add_u32 s11, s11, 1024
  s_mov_b32 m0, 7168
  v_xor_b32 v2, 192, v198
  buffer_load_dwordx4 v2, s[4:7], s11 offen lds
  s_add_u32 s11, s11, 1024
  s_mov_b32 m0, 8192
  v_xor_b32 v2, 0, v198
  buffer_load_dwordx4 v2, s[4:7], s11 offen lds
  s_add_u32 s11, s11, 1024
  s_mov_b32 m0, 9216
  v_xor_b32 v2, 64, v198
  buffer_load_dwordx4 v2, s[4:7], s11 offen lds
  s_add_u32 s11, s11, 1024
  s_mov_b32 m0, 10240
  v_xor_b32 v2, 128, v198
  buffer_load_dwordx4 v2, s[4:7], s11 offen lds
  s_add_u32 s11, s11, 1024
  s_mov_b32 m0, 11264
  v_xor_b32 v2, 192, v198
  buffer_load_dwordx4 v2, s[4:7], s11 offen lds
  s_add_u32 s11, s11, 1024
  s_mov_b32 m0, 12288
  v_xor_b32 v2, 0, v198
  buffer_load_dwordx4 v2, s[4:7], s11 offen lds
  s_add_u32 s11, s11, 1024
  s_mov_b32 m0, 13312
  v_xor_b32 v2, 64, v198
  buffer_load_dwordx4 v2, s[4:7], s11 offen lds
  s_add_u32 s11, s11, 1024
  s_mov_b32 m0, 14336
  v_xor_b32 v2, 128, v198
  buffer_load_dwordx4 v2, s[4:7], s11 offen lds
  s_add_u32 s11, s11, 1024
  s_mov_b32 m0, 15360
  v_xor_b32 v2, 192, v198
  buffer_load_dwordx4 v2, s[4:7], s11 offen lds
  s_add_u32 s11, s11, 1024
  s_mov_b32 m0, 49152
  s_nop 0
  buffer_load_dwordx4 v199, s[4:7], s12 offen lds
  s_add_u32 s12, s12, 1024
  s_mov_b32 m0, 50176
  s_nop 0
  buffer_load_dwordx4 v199, s[4:7], s12 offen lds
  s_add_u32 s12, s12, 1024
  s_mov_b32 m0, 51200
  s_nop 0
  buffer_load_dwordx4 v199, s[4:7], s12 offen lds
  s_add_u32 s12, s12, 1024
  s_mov_b32 m0, 52224
  s_nop 0
  buffer_load_dwordx4 v199, s[4:7], s12 offen lds
  s_add_u32 s12, s12, 1024
  s_mov_b32 m0, 53248
  s_nop 0
  buffer_load_dwordx4 v199, s[4:7], s12 offen lds
  s_add_u32 s12, s12, 1024
  s_mov_b32 m0, 54272
  s_nop 0
  buffer_load_dwordx4 v199, s[4:7], s12 offen lds
  s_add_u32 s12, s12, 1024
  s_mov_b32 m0, 55296
  s_nop 0
  buffer_load_dwordx4 v199, s[4:7], s12 offen lds
  s_add_u32 s12, s12, 1024
  s_mov_b32 m0, 56320
  s_nop 0
  buffer_load_dwordx4 v199, s[4:7], s12 offen lds
  s_add_u32 s12, s12, 1024
  s_mov_b32 m0, 57344
  s_nop 0
  buffer_load_dwordx4 v199, s[4:7], s12 offen lds
  s_add_u32 s12, s12, 1024
  s_mov_b32 m0, 58368
  s_nop 0
  buffer_load_dwordx4 v199, s[4:7], s12 offen lds
  s_add_u32 s12, s12, 1024
  s_mov_b32 m0, 59392
  s_nop 0
  buffer_load_dwordx4 v199, s[4:7], s12 offen lds
  s_add_u32 s12, s12, 1024
  s_mov_b32 m0, 60416
  s_nop 0
  buffer_load_dwordx4 v199, s[4:7], s12 offen lds
  s_add_u32 s12, s12, 1024
  s_mov_b32 m0, 61440
  s_nop 0
  buffer_load_dwordx4 v199, s[4:7], s12 offen lds
  s_add_u32 s12, s12, 1024
  s_mov_b32 m0, 62464
  s_nop 0
  buffer_load_dwordx4 v199, s[4:7], s12 offen lds
  s_add_u32 s12, s12, 1024
  s_mov_b32 m0, 63488
  s_nop 0
  buffer_load_dwordx4 v199, s[4:7], s12 offen lds
  s_add_u32 s12, s12, 1024
  s_mov_b32 m0, 64512
  s_nop 0
  buffer_load_dwordx4 v199, s[4:7], s12 offen lds
  s_add_u32 s12, s12, 1024
  s_waitcnt vmcnt(0)
  s_barrier
  s_mov_b32 m0, 32768
  v_xor_b32 v2, 0, v198
  buffer_load_dwordx4 v2, s[4:7], s11 offen lds
  s_add_u32 s11, s11, 1024
  s_mov_b32 m0, 33792
  v_xor_b32 v2, 64, v198
  buffer_load_dwordx4 v2, s[4:7], s11 offen lds
  s_add_u32 s11, s11, 1024
  s_mov_b32 m0, 34816
  v_xor_b32 v2, 128, v198
  buffer_load_dwordx4 v2, s[4:7], s11 offen lds
  s_add_u32 s11, s11, 1024
  s_mov_b32 m0, 35840
  v_xor_b32 v2, 192, v198
  buffer_load_dwordx4 v2, s[4:7], s11 offen lds
  s_add_u32 s11, s11, 1024
  s_mov_b32 m0, 36864
  v_xor_b32 v2, 0, v198
  buffer_load_dwordx4 v2, s[4:7], s11 offen lds
  s_add_u32 s11, s11, 1024
  s_mov_b32 m0, 37888
  v_xor_b32 v2, 64, v198
  buffer_load_dwordx4 v2, s[4:7], s11 offen lds
  s_add_u32 s11, s11, 1024
  s_mov_b32 m0, 38912
  v_xor_b32 v2, 128, v198
  buffer_load_dwordx4 v2, s[4:7], s11 offen lds
  s_add_u32 s11, s11, 1024
  s_mov_b32 m0, 39936
  v_xor_b32 v2, 192, v198
  buffer_load_dwordx4 v2, s[4:7], s11 offen lds
  s_add_u32 s11, s11, 1024
  s_mov_b32 m0, 40960
  v_xor_b32 v2, 0, v198
  buffer_load_dwordx4 v2, s[4:7], s11 offen lds
  s_add_u32 s11, s11, 1024
  s_mov_b32 m0, 41984
  v_xor_b32 v2, 64, v198
  buffer_load_dwordx4 v2, s[4:7], s11 offen lds
  s_add_u32 s11, s11, 1024
  s_mov_b32 m0, 43008
  v_xor_b32 v2, 128, v198
  buffer_load_dwordx4 v2, s[4:7], s11 offen lds
  s_add_u32 s11, s11, 1024
  s_mov_b32 m0, 44032
  v_xor_b32 v2, 192, v198
  buffer_load_dwordx4 v2, s[4:7], s11 offen lds
  s_add_u32 s11, s11, 1024
  s_mov_b32 m0, 45056
  v_xor_b32 v2, 0, v198
  buffer_load_dwordx4 v2, s[4:7], s11 offen lds
  s_add_u32 s11, s11, 1024
  s_mov_b32 m0, 46080
  v_xor_b32 v2, 64, v198
  buffer_load_dwordx4 v2, s[4:7], s11 offen lds
  s_add_u32 s11, s11, 1024
  s_mov_b32 m0, 47104
  v_xor_b32 v2, 128, v198
  buffer_load_dwordx4 v2, s[4:7], s11 offen lds
  s_add_u32 s11, s11, 1024
  s_mov_b32 m0, 48128
  v_xor_b32 v2, 192, v198
  buffer_load_dwordx4 v2, s[4:7], s11 offen lds
  s_add_u32 s11, s11, 1024
  s_mov_b32 m0, 16384
  s_nop 0
  buffer_load_dwordx4 v199, s[4:7], s12 offen lds
  s_add_u32 s12, s12, 1024
  s_mov_b32 m0, 17408
  s_nop 0
  buffer_load_dwordx4 v199, s[4:7], s12 offen lds
  s_add_u32 s12, s12, 1024
  s_mov_b32 m0, 18432
  s_nop 0
  buffer_load_dwordx4 v199, s[4:7], s12 offen lds
  s_add_u32 s12, s12, 1024
  s_mov_b32 m0, 19456
  s_nop 0
  buffer_load_dwordx4 v199, s[4:7], s12 offen lds
  s_add_u32 s12, s12, 1024
  s_mov_b32 m0, 20480
  s_nop 0
  buffer_load_dwordx4 v199, s[4:7], s12 offen lds
  s_add_u32 s12, s12, 1024
  s_mov_b32 m0, 21504
  s_nop 0
  buffer_load_dwordx4 v199, s[4:7], s12 offen lds
  s_add_u32 s12, s12, 1024
  s_mov_b32 m0, 22528
  s_nop 0
  buffer_load_dwordx4 v199, s[4:7], s12 offen lds
  s_add_u32 s12, s12, 1024
  s_mov_b32 m0, 23552
  s_nop 0
  buffer_load_dwordx4 v199, s[4:7], s12 offen lds
  s_add_u32 s12, s12, 1024
  s_mov_b32 m0, 24576
  s_nop 0
  buffer_load_dwordx4 v199, s[4:7], s12 offen lds
  s_add_u32 s12, s12, 1024
  s_mov_b32 m0, 25600
  s_nop 0
  buffer_load_dwordx4 v199, s[4:7], s12 offen lds
  s_add_u32 s12, s12, 1024
  s_mov_b32 m0, 26624
  s_nop 0
  buffer_load_dwordx4 v199, s[4:7], s12 offen lds
  s_add_u32 s12, s12, 1024
  s_mov_b32 m0, 27648
  s_nop 0
  buffer_load_dwordx4 v199, s[4:7], s12 offen lds
  s_add_u32 s12, s12, 1024
  s_mov_b32 m0, 28672
  s_nop 0
  buffer_load_dwordx4 v199, s[4:7], s12 offen lds
  s_add_u32 s12, s12, 1024
  s_mov_b32 m0, 29696
  s_nop 0
  buffer_load_dwordx4 v199, s[4:7], s12 offen lds
  s_add_u32 s12, s12, 1024
  s_mov_b32 m0, 30720
  s_nop 0
  buffer_load_dwordx4 v199, s[4:7], s12 offen lds
  s_add_u32 s12, s12, 1024
  s_mov_b32 m0, 31744
  s_nop 0
  buffer_load_dwordx4 v199, s[4:7], s12 offen lds
  s_add_u32 s12, s12, 1024
  s_add_u32 s15, s15, 2
  s_cmp_lt_u32 s15, s16
  s_cbranch_scc1 a_kernel_p0_loop
a_kernel_p0_mask:
  s_waitcnt vmcnt(0)
  s_barrier
  s_mov_b32 m0, 49152
  s_nop 0
  buffer_load_dwordx4 v199, s[4:7], s12 offen lds
  s_add_u32 s12, s12, 1024
  s_mov_b32 m0, 50176
  s_nop 0
  buffer_load_dwordx4 v199, s[4:7], s12 offen lds
  s_add_u32 s12, s12, 1024
  s_mov_b32 m0, 51200
  s_nop 0
  buffer_load_dwordx4 v199, s[4:7], s12 offen lds
  s_add_u32 s12, s12, 1024
  s_mov_b32 m0, 52224
  s_nop 0
  buffer_load_dwordx4 v199, s[4:7], s12 offen lds
  s_add_u32 s12, s12, 1024
  s_mov_b32 m0, 53248
  s_nop 0
  buffer_load_dwordx4 v199, s[4:7], s12 offen lds
  s_add_u32 s12, s12, 1024
  s_mov_b32 m0, 54272
  s_nop 0
  buffer_load_dwordx4 v199, s[4:7], s12 offen lds
  s_add_u32 s12, s12, 1024
  s_mov_b32 m0, 55296
  s_nop 0
  buffer_load_dwordx4 v199, s[4:7], s12 offen lds
  s_add_u32 s12, s12, 1024
  s_mov_b32 m0, 56320
  s_nop 0
  buffer_load_dwordx4 v199, s[4:7], s12 offen lds
  s_add_u32 s12, s12, 1024
  s_mov_b32 m0, 57344
  s_nop 0
  buffer_load_dwordx4 v199, s[4:7], s12 offen lds
  s_add_u32 s12, s12, 1024
  s_mov_b32 m0, 58368
  s_nop 0
  buffer_load_dwordx4 v199, s[4:7], s12 offen lds
  s_add_u32 s12, s12, 1024
  s_mov_b32 m0, 59392
  s_nop 0
  buffer_load_dwordx4 v199, s[4:7], s12 offen lds
  s_add_u32 s12, s12, 1024
  s_mov_b32 m0, 60416
  s_nop 0
  buffer_load_dwordx4 v199, s[4:7], s12 offen lds
  s_add_u32 s12, s12, 1024
  s_mov_b32 m0, 61440
  s_nop 0
  buffer_load_dwordx4 v199, s[4:7], s12 offen lds
  s_add_u32 s12, s12, 1024
  s_mov_b32 m0, 62464
  s_nop 0
  buffer_load_dwordx4 v199, s[4:7], s12 offen lds
  s_add_u32 s12, s12, 1024
  s_mov_b32 m0, 63488
  s_nop 0
  buffer_load_dwordx4 v199, s[4:7], s12 offen lds
  s_add_u32 s12, s12, 1024
  s_mov_b32 m0, 64512
  s_nop 0
  buffer_load_dwordx4 v199, s[4:7], s12 offen lds
  s_add_u32 s12, s12, 1024
  s_waitcnt vmcnt(0)
  s_barrier
  s_sub_u32 s10, 15, s26
  s_waitcnt vmcnt(0)
  s_barrier
  s_lshl_b32 s20, s9, 19
  s_add_u32 s11, s20, 0x1000000
  s_add_u32 s12, s20, 0x2000000
  s_mov_b32 m0, 0
  v_xor_b32 v2, 0, v198
  buffer_load_dwordx4 v2, s[4:7], s11 offen lds
  s_add_u32 s11, s11, 1024
  s_mov_b32 m0, 1024
  v_xor_b32 v2, 64, v198
  buffer_load_dwordx4 v2, s[4:7], s11 offen lds
  s_add_u32 s11, s11, 1024
  s_mov_b32 m0, 2048
  v_xor_b32 v2, 128, v198
  buffer_load_dwordx4 v2, s[4:7], s11 offen lds
  s_add_u32 s11, s11, 1024
  s_mov_b32 m0, 3072
  v_xor_b32 v2, 192, v198
  buffer_load_dwordx4 v2, s[4:7], s11 offen lds
  s_add_u32 s11, s11, 1024
  s_mov_b32 m0, 4096
  v_xor_b32 v2, 0, v198
  buffer_load_dwordx4 v2, s[4:7], s11 offen lds
  s_add_u32 s11, s11, 1024
  s_mov_b32 m0, 5120
  v_xor_b32 v2, 64, v198
  buffer_load_dwordx4 v2, s[4:7], s11 offen lds
  s_add_u32 s11, s11, 1024
  s_mov_b32 m0, 6144
  v_xor_b32 v2, 128, v198
  buffer_load_dwordx4 v2, s[4:7], s11 offen lds
  s_add_u32 s11, s11, 1024
  s_mov_b32 m0, 7168
  v_xor_b32 v2, 192, v198
  buffer_load_dwordx4 v2, s[4:7], s11 offen lds
  s_add_u32 s11, s11, 1024
  s_mov_b32 m0, 8192
  v_xor_b32 v2, 0, v198
  buffer_load_dwordx4 v2, s[4:7], s11 offen lds
  s_add_u32 s11, s11, 1024
  s_mov_b32 m0, 9216
  v_xor_b32 v2, 64, v198
  buffer_load_dwordx4 v2, s[4:7], s11 offen lds
  s_add_u32 s11, s11, 1024
  s_mov_b32 m0, 10240
  v_xor_b32 v2, 128, v198
  buffer_load_dwordx4 v2, s[4:7], s11 offen lds
  s_add_u32 s11, s11, 1024
  s_mov_b32 m0, 11264
  v_xor_b32 v2, 192, v198
  buffer_load_dwordx4 v2, s[4:7], s11 offen lds
  s_add_u32 s11, s11, 1024
  s_mov_b32 m0, 12288
  v_xor_b32 v2, 0, v198
  buffer_load_dwordx4 v2, s[4:7], s11 offen lds
  s_add_u32 s11, s11, 1024
  s_mov_b32 m0, 13312
  v_xor_b32 v2, 64, v198
  buffer_load_dwordx4 v2, s[4:7], s11 offen lds
  s_add_u32 s11, s11, 1024
  s_mov_b32 m0, 14336
  v_xor_b32 v2, 128, v198
  buffer_load_dwordx4 v2, s[4:7], s11 offen lds
  s_add_u32 s11, s11, 1024
  s_mov_b32 m0, 15360
  v_xor_b32 v2, 192, v198
  buffer_load_dwordx4 v2, s[4:7], s11 offen lds
  s_add_u32 s11, s11, 1024
  s_mov_b32 m0, 32768
  v_xor_b32 v2, 0, v198
  buffer_load_dwordx4 v2, s[4:7], s11 offen lds
  s_add_u32 s11, s11, 1024
  s_mov_b32 m0, 33792
  v_xor_b32 v2, 64, v198
  buffer_load_dwordx4 v2, s[4:7], s11 offen lds
  s_add_u32 s11, s11, 1024
  s_mov_b32 m0, 34816
  v_xor_b32 v2, 128, v198
  buffer_load_dwordx4 v2, s[4:7], s11 offen lds
  s_add_u32 s11, s11, 1024
  s_mov_b32 m0, 35840
  v_xor_b32 v2, 192, v198
  buffer_load_dwordx4 v2, s[4:7], s11 offen lds
  s_add_u32 s11, s11, 1024
  s_mov_b32 m0, 36864
  v_xor_b32 v2, 0, v198
  buffer_load_dwordx4 v2, s[4:7], s11 offen lds
  s_add_u32 s11, s11, 1024
  s_mov_b32 m0, 37888
  v_xor_b32 v2, 64, v198
  buffer_load_dwordx4 v2, s[4:7], s11 offen lds
  s_add_u32 s11, s11, 1024
  s_mov_b32 m0, 38912
  v_xor_b32 v2, 128, v198
  buffer_load_dwordx4 v2, s[4:7], s11 offen lds
  s_add_u32 s11, s11, 1024
  s_mov_b32 m0, 39936
  v_xor_b32 v2, 192, v198
  buffer_load_dwordx4 v2, s[4:7], s11 offen lds
  s_add_u32 s11, s11, 1024
  s_mov_b32 m0, 40960
  v_xor_b32 v2, 0, v198
  buffer_load_dwordx4 v2, s[4:7], s11 offen lds
  s_add_u32 s11, s11, 1024
  s_mov_b32 m0, 41984
  v_xor_b32 v2, 64, v198
  buffer_load_dwordx4 v2, s[4:7], s11 offen lds
  s_add_u32 s11, s11, 1024
  s_mov_b32 m0, 43008
  v_xor_b32 v2, 128, v198
  buffer_load_dwordx4 v2, s[4:7], s11 offen lds
  s_add_u32 s11, s11, 1024
  s_mov_b32 m0, 44032
  v_xor_b32 v2, 192, v198
  buffer_load_dwordx4 v2, s[4:7], s11 offen lds
  s_add_u32 s11, s11, 1024
  s_mov_b32 m0, 45056
  v_xor_b32 v2, 0, v198
  buffer_load_dwordx4 v2, s[4:7], s11 offen lds
  s_add_u32 s11, s11, 1024
  s_mov_b32 m0, 46080
  v_xor_b32 v2, 64, v198
  buffer_load_dwordx4 v2, s[4:7], s11 offen lds
  s_add_u32 s11, s11, 1024
  s_mov_b32 m0, 47104
  v_xor_b32 v2, 128, v198
  buffer_load_dwordx4 v2, s[4:7], s11 offen lds
  s_add_u32 s11, s11, 1024
  s_mov_b32 m0, 48128
  v_xor_b32 v2, 192, v198
  buffer_load_dwordx4 v2, s[4:7], s11 offen lds
  s_add_u32 s11, s11, 1024
  s_mov_b32 m0, 16384
  s_nop 0
  buffer_load_dwordx4 v199, s[4:7], s12 offen lds
  s_add_u32 s12, s12, 1024
  s_mov_b32 m0, 17408
  s_nop 0
  buffer_load_dwordx4 v199, s[4:7], s12 offen lds
  s_add_u32 s12, s12, 1024
  s_mov_b32 m0, 18432
  s_nop 0
  buffer_load_dwordx4 v199, s[4:7], s12 offen lds
  s_add_u32 s12, s12, 1024
  s_mov_b32 m0, 19456
  s_nop 0
  buffer_load_dwordx4 v199, s[4:7], s12 offen lds
  s_add_u32 s12, s12, 1024
  s_mov_b32 m0, 20480
  s_nop 0
  buffer_load_dwordx4 v199, s[4:7], s12 offen lds
  s_add_u32 s12, s12, 1024
  s_mov_b32 m0, 21504
  s_nop 0
  buffer_load_dwordx4 v199, s[4:7], s12 offen lds
  s_add_u32 s12, s12, 1024
  s_mov_b32 m0, 22528
  s_nop 0
  buffer_load_dwordx4 v199, s[4:7], s12 offen lds
  s_add_u32 s12, s12, 1024
  s_mov_b32 m0, 23552
  s_nop 0
  buffer_load_dwordx4 v199, s[4:7], s12 offen lds
  s_add_u32 s12, s12, 1024
  s_mov_b32 m0, 24576
  s_nop 0
  buffer_load_dwordx4 v199, s[4:7], s12 offen lds
  s_add_u32 s12, s12, 1024
  s_mov_b32 m0, 25600
  s_nop 0
  buffer_load_dwordx4 v199, s[4:7], s12 offen lds
  s_add_u32 s12, s12, 1024
  s_mov_b32 m0, 26624
  s_nop 0
  buffer_load_dwordx4 v199, s[4:7], s12 offen lds
  s_add_u32 s12, s12, 1024
  s_mov_b32 m0, 27648
  s_nop 0
  buffer_load_dwordx4 v199, s[4:7], s12 offen lds
  s_add_u32 s12, s12, 1024
  s_mov_b32 m0, 28672
  s_nop 0
  buffer_load_dwordx4 v199, s[4:7], s12 offen lds
  s_add_u32 s12, s12, 1024
  s_mov_b32 m0, 29696
  s_nop 0
  buffer_load_dwordx4 v199, s[4:7], s12 offen lds
  s_add_u32 s12, s12, 1024
  s_mov_b32 m0, 30720
  s_nop 0
  buffer_load_dwordx4 v199, s[4:7], s12 offen lds
  s_add_u32 s12, s12, 1024
  s_mov_b32 m0, 31744
  s_nop 0
  buffer_load_dwordx4 v199, s[4:7], s12 offen lds
  s_add_u32 s12, s12, 1024
  s_waitcnt vmcnt(0)
  s_barrier
  s_lshl_b32 s16, s10, 1
  s_mov_b32 s15, 0
  s_cmp_ge_u32 s15, s16
  s_cbranch_scc1 a_kernel_p1_mask
a_kernel_p1_loop:
  s_waitcnt vmcnt(0)
  s_barrier
  s_mov_b32 m0, 0
  v_xor_b32 v2, 0, v198
  buffer_load_dwordx4 v2, s[4:7], s11 offen lds
  s_add_u32 s11, s11, 1024
  s_mov_b32 m0, 1024
  v_xor_b32 v2, 64, v198
  buffer_load_dwordx4 v2, s[4:7], s11 offen lds
  s_add_u32 s11, s11, 1024
  s_mov_b32 m0, 2048
  v_xor_b32 v2, 128, v198
  buffer_load_dwordx4 v2, s[4:7], s11 offen lds
  s_add_u32 s11, s11, 1024
  s_mov_b32 m0, 3072
  v_xor_b32 v2, 192, v198
  buffer_load_dwordx4 v2, s[4:7], s11 offen lds
  s_add_u32 s11, s11, 1024
  s_mov_b32 m0, 4096
  v_xor_b32 v2, 0, v198
  buffer_load_dwordx4 v2, s[4:7], s11 offen lds
  s_add_u32 s11, s11, 1024
  s_mov_b32 m0, 5120
  v_xor_b32 v2, 64, v198
  buffer_load_dwordx4 v2, s[4:7], s11 offen lds
  s_add_u32 s11, s11, 1024
  s_mov_b32 m0, 6144
  v_xor_b32 v2, 128, v198
  buffer_load_dwordx4 v2, s[4:7], s11 offen lds
  s_add_u32 s11, s11, 1024
  s_mov_b32 m0, 7168
  v_xor_b32 v2, 192, v198
  buffer_load_dwordx4 v2, s[4:7], s11 offen lds
  s_add_u32 s11, s11, 1024
  s_mov_b32 m0, 8192
  v_xor_b32 v2, 0, v198
  buffer_load_dwordx4 v2, s[4:7], s11 offen lds
  s_add_u32 s11, s11, 1024
  s_mov_b32 m0, 9216
  v_xor_b32 v2, 64, v198
  buffer_load_dwordx4 v2, s[4:7], s11 offen lds
  s_add_u32 s11, s11, 1024
  s_mov_b32 m0, 10240
  v_xor_b32 v2, 128, v198
  buffer_load_dwordx4 v2, s[4:7], s11 offen lds
  s_add_u32 s11, s11, 1024
  s_mov_b32 m0, 11264
  v_xor_b32 v2, 192, v198
  buffer_load_dwordx4 v2, s[4:7], s11 offen lds
  s_add_u32 s11, s11, 1024
  s_mov_b32 m0, 12288
  v_xor_b32 v2, 0, v198
  buffer_load_dwordx4 v2, s[4:7], s11 offen lds
  s_add_u32 s11, s11, 1024
  s_mov_b32 m0, 13312
  v_xor_b32 v2, 64, v198
  buffer_load_dwordx4 v2, s[4:7], s11 offen lds
  s_add_u32 s11, s11, 1024
  s_mov_b32 m0, 14336
  v_xor_b32 v2, 128, v198
  buffer_load_dwordx4 v2, s[4:7], s11 offen lds
  s_add_u32 s11, s11, 1024
  s_mov_b32 m0, 15360
  v_xor_b32 v2, 192, v198
  buffer_load_dwordx4 v2, s[4:7], s11 offen lds
  s_add_u32 s11, s11, 1024
  s_mov_b32 m0, 49152
  s_nop 0
  buffer_load_dwordx4 v199, s[4:7], s12 offen lds
  s_add_u32 s12, s12, 1024
  s_mov_b32 m0, 50176
  s_nop 0
  buffer_load_dwordx4 v199, s[4:7], s12 offen lds
  s_add_u32 s12, s12, 1024
  s_mov_b32 m0, 51200
  s_nop 0
  buffer_load_dwordx4 v199, s[4:7], s12 offen lds
  s_add_u32 s12, s12, 1024
  s_mov_b32 m0, 52224
  s_nop 0
  buffer_load_dwordx4 v199, s[4:7], s12 offen lds
  s_add_u32 s12, s12, 1024
  s_mov_b32 m0, 53248
  s_nop 0
  buffer_load_dwordx4 v199, s[4:7], s12 offen lds
  s_add_u32 s12, s12, 1024
  s_mov_b32 m0, 54272
  s_nop 0
  buffer_load_dwordx4 v199, s[4:7], s12 offen lds
  s_add_u32 s12, s12, 1024
  s_mov_b32 m0, 55296
  s_nop 0
  buffer_load_dwordx4 v199, s[4:7], s12 offen lds
  s_add_u32 s12, s12, 1024
  s_mov_b32 m0, 56320
  s_nop 0
  buffer_load_dwordx4 v199, s[4:7], s12 offen lds
  s_add_u32 s12, s12, 1024
  s_mov_b32 m0, 57344
  s_nop 0
  buffer_load_dwordx4 v199, s[4:7], s12 offen lds
  s_add_u32 s12, s12, 1024
  s_mov_b32 m0, 58368
  s_nop 0
  buffer_load_dwordx4 v199, s[4:7], s12 offen lds
  s_add_u32 s12, s12, 1024
  s_mov_b32 m0, 59392
  s_nop 0
  buffer_load_dwordx4 v199, s[4:7], s12 offen lds
  s_add_u32 s12, s12, 1024
  s_mov_b32 m0, 60416
  s_nop 0
  buffer_load_dwordx4 v199, s[4:7], s12 offen lds
  s_add_u32 s12, s12, 1024
  s_mov_b32 m0, 61440
  s_nop 0
  buffer_load_dwordx4 v199, s[4:7], s12 offen lds
  s_add_u32 s12, s12, 1024
  s_mov_b32 m0, 62464
  s_nop 0
  buffer_load_dwordx4 v199, s[4:7], s12 offen lds
  s_add_u32 s12, s12, 1024
  s_mov_b32 m0, 63488
  s_nop 0
  buffer_load_dwordx4 v199, s[4:7], s12 offen lds
  s_add_u32 s12, s12, 1024
  s_mov_b32 m0, 64512
  s_nop 0
  buffer_load_dwordx4 v199, s[4:7], s12 offen lds
  s_add_u32 s12, s12, 1024
  s_waitcnt vmcnt(0)
  s_barrier
  s_mov_b32 m0, 32768
  v_xor_b32 v2, 0, v198
  buffer_load_dwordx4 v2, s[4:7], s11 offen lds
  s_add_u32 s11, s11, 1024
  s_mov_b32 m0, 33792
  v_xor_b32 v2, 64, v198
  buffer_load_dwordx4 v2, s[4:7], s11 offen lds
  s_add_u32 s11, s11, 1024
  s_mov_b32 m0, 34816
  v_xor_b32 v2, 128, v198
  buffer_load_dwordx4 v2, s[4:7], s11 offen lds
  s_add_u32 s11, s11, 1024
  s_mov_b32 m0, 35840
  v_xor_b32 v2, 192, v198
  buffer_load_dwordx4 v2, s[4:7], s11 offen lds
  s_add_u32 s11, s11, 1024
  s_mov_b32 m0, 36864
  v_xor_b32 v2, 0, v198
  buffer_load_dwordx4 v2, s[4:7], s11 offen lds
  s_add_u32 s11, s11, 1024
  s_mov_b32 m0, 37888
  v_xor_b32 v2, 64, v198
  buffer_load_dwordx4 v2, s[4:7], s11 offen lds
  s_add_u32 s11, s11, 1024
  s_mov_b32 m0, 38912
  v_xor_b32 v2, 128, v198
  buffer_load_dwordx4 v2, s[4:7], s11 offen lds
  s_add_u32 s11, s11, 1024
  s_mov_b32 m0, 39936
  v_xor_b32 v2, 192, v198
  buffer_load_dwordx4 v2, s[4:7], s11 offen lds
  s_add_u32 s11, s11, 1024
  s_mov_b32 m0, 40960
  v_xor_b32 v2, 0, v198
  buffer_load_dwordx4 v2, s[4:7], s11 offen lds
  s_add_u32 s11, s11, 1024
  s_mov_b32 m0, 41984
  v_xor_b32 v2, 64, v198
  buffer_load_dwordx4 v2, s[4:7], s11 offen lds
  s_add_u32 s11, s11, 1024
  s_mov_b32 m0, 43008
  v_xor_b32 v2, 128, v198
  buffer_load_dwordx4 v2, s[4:7], s11 offen lds
  s_add_u32 s11, s11, 1024
  s_mov_b32 m0, 44032
  v_xor_b32 v2, 192, v198
  buffer_load_dwordx4 v2, s[4:7], s11 offen lds
  s_add_u32 s11, s11, 1024
  s_mov_b32 m0, 45056
  v_xor_b32 v2, 0, v198
  buffer_load_dwordx4 v2, s[4:7], s11 offen lds
  s_add_u32 s11, s11, 1024
  s_mov_b32 m0, 46080
  v_xor_b32 v2, 64, v198
  buffer_load_dwordx4 v2, s[4:7], s11 offen lds
  s_add_u32 s11, s11, 1024
  s_mov_b32 m0, 47104
  v_xor_b32 v2, 128, v198
  buffer_load_dwordx4 v2, s[4:7], s11 offen lds
  s_add_u32 s11, s11, 1024
  s_mov_b32 m0, 48128
  v_xor_b32 v2, 192, v198
  buffer_load_dwordx4 v2, s[4:7], s11 offen lds
  s_add_u32 s11, s11, 1024
  s_mov_b32 m0, 16384
  s_nop 0
  buffer_load_dwordx4 v199, s[4:7], s12 offen lds
  s_add_u32 s12, s12, 1024
  s_mov_b32 m0, 17408
  s_nop 0
  buffer_load_dwordx4 v199, s[4:7], s12 offen lds
  s_add_u32 s12, s12, 1024
  s_mov_b32 m0, 18432
  s_nop 0
  buffer_load_dwordx4 v199, s[4:7], s12 offen lds
  s_add_u32 s12, s12, 1024
  s_mov_b32 m0, 19456
  s_nop 0
  buffer_load_dwordx4 v199, s[4:7], s12 offen lds
  s_add_u32 s12, s12, 1024
  s_mov_b32 m0, 20480
  s_nop 0
  buffer_load_dwordx4 v199, s[4:7], s12 offen lds
  s_add_u32 s12, s12, 1024
  s_mov_b32 m0, 21504
  s_nop 0
  buffer_load_dwordx4 v199, s[4:7], s12 offen lds
  s_add_u32 s12, s12, 1024
  s_mov_b32 m0, 22528
  s_nop 0
  buffer_load_dwordx4 v199, s[4:7], s12 offen lds
  s_add_u32 s12, s12, 1024
  s_mov_b32 m0, 23552
  s_nop 0
  buffer_load_dwordx4 v199, s[4:7], s12 offen lds
  s_add_u32 s12, s12, 1024
  s_mov_b32 m0, 24576
  s_nop 0
  buffer_load_dwordx4 v199, s[4:7], s12 offen lds
  s_add_u32 s12, s12, 1024
  s_mov_b32 m0, 25600
  s_nop 0
  buffer_load_dwordx4 v199, s[4:7], s12 offen lds
  s_add_u32 s12, s12, 1024
  s_mov_b32 m0, 26624
  s_nop 0
  buffer_load_dwordx4 v199, s[4:7], s12 offen lds
  s_add_u32 s12, s12, 1024
  s_mov_b32 m0, 27648
  s_nop 0
  buffer_load_dwordx4 v199, s[4:7], s12 offen lds
  s_add_u32 s12, s12, 1024
  s_mov_b32 m0, 28672
  s_nop 0
  buffer_load_dwordx4 v199, s[4:7], s12 offen lds
  s_add_u32 s12, s12, 1024
  s_mov_b32 m0, 29696
  s_nop 0
  buffer_load_dwordx4 v199, s[4:7], s12 offen lds
  s_add_u32 s12, s12, 1024
  s_mov_b32 m0, 30720
  s_nop 0
  buffer_load_dwordx4 v199, s[4:7], s12 offen lds
  s_add_u32 s12, s12, 1024
  s_mov_b32 m0, 31744
  s_nop 0
  buffer_load_dwordx4 v199, s[4:7], s12 offen lds
  s_add_u32 s12, s12, 1024
  s_add_u32 s15, s15, 2
  s_cmp_lt_u32 s15, s16
  s_cbranch_scc1 a_kernel_p1_loop
a_kernel_p1_mask:
  s_waitcnt vmcnt(0)
  s_barrier
  s_mov_b32 m0, 49152
  s_nop 0
  buffer_load_dwordx4 v199, s[4:7], s12 offen lds
  s_add_u32 s12, s12, 1024
  s_mov_b32 m0, 50176
  s_nop 0
  buffer_load_dwordx4 v199, s[4:7], s12 offen lds
  s_add_u32 s12, s12, 1024
  s_mov_b32 m0, 51200
  s_nop 0
  buffer_load_dwordx4 v199, s[4:7], s12 offen lds
  s_add_u32 s12, s12, 1024
  s_mov_b32 m0, 52224
  s_nop 0
  buffer_load_dwordx4 v199, s[4:7], s12 offen lds
  s_add_u32 s12, s12, 1024
  s_mov_b32 m0, 53248
  s_nop 0
  buffer_load_dwordx4 v199, s[4:7], s12 offen lds
  s_add_u32 s12, s12, 1024
  s_mov_b32 m0, 54272
  s_nop 0
  buffer_load_dwordx4 v199, s[4:7], s12 offen lds
  s_add_u32 s12, s12, 1024
  s_mov_b32 m0, 55296
  s_nop 0
  buffer_load_dwordx4 v199, s[4:7], s12 offen lds
  s_add_u32 s12, s12, 1024
  s_mov_b32 m0, 56320
  s_nop 0
  buffer_load_dwordx4 v199, s[4:7], s12 offen lds
  s_add_u32 s12, s12, 1024
  s_mov_b32 m0, 57344
  s_nop 0
  buffer_load_dwordx4 v199, s[4:7], s12 offen lds
  s_add_u32 s12, s12, 1024
  s_mov_b32 m0, 58368
  s_nop 0
  buffer_load_dwordx4 v199, s[4:7], s12 offen lds
  s_add_u32 s12, s12, 1024
  s_mov_b32 m0, 59392
  s_nop 0
  buffer_load_dwordx4 v199, s[4:7], s12 offen lds
  s_add_u32 s12, s12, 1024
  s_mov_b32 m0, 60416
  s_nop 0
  buffer_load_dwordx4 v199, s[4:7], s12 offen lds
  s_add_u32 s12, s12, 1024
  s_mov_b32 m0, 61440
  s_nop 0
  buffer_load_dwordx4 v199, s[4:7], s12 offen lds
  s_add_u32 s12, s12, 1024
  s_mov_b32 m0, 62464
  s_nop 0
  buffer_load_dwordx4 v199, s[4:7], s12 offen lds
  s_add_u32 s12, s12, 1024
  s_mov_b32 m0, 63488
  s_nop 0
  buffer_load_dwordx4 v199, s[4:7], s12 offen lds
  s_add_u32 s12, s12, 1024
  s_mov_b32 m0, 64512
  s_nop 0
  buffer_load_dwordx4 v199, s[4:7], s12 offen lds
  s_add_u32 s12, s12, 1024
  s_waitcnt vmcnt(0)
  s_barrier
  s_waitcnt vmcnt(0)
a_kernel_end:
  s_endpgm
.section .rodata,"a"
.p2align 6
.amdhsa_kernel a_kernel
  .amdhsa_next_free_vgpr 248
  .amdhsa_next_free_sgpr 64
  .amdhsa_accum_offset 248
  .amdhsa_group_segment_fixed_size 0
  .amdhsa_kernarg_size 120
  .amdhsa_user_sgpr_count 2
  .amdhsa_user_sgpr_kernarg_segment_ptr 1
  .amdhsa_system_sgpr_workgroup_id_x 1
.end_amdhsa_kernel
.text
.globl l3_kernel
.p2align 8
.type l3_kernel,@function
l3_kernel:
  s_cmp_ge_u32 s2, 256
  s_cbranch_scc1 l3_kernel_end
  s_load_dwordx2 s[40:41], s[0:1], 40
  s_load_dwordx2 s[42:43], s[0:1], 80
  s_load_dwordx2 s[44:45], s[0:1], 96
  s_load_dwordx2 s[50:51], s[0:1], 112
  s_waitcnt lgkmcnt(0)
  s_mov_b32 s16, s2
  s_and_b32 s32, s16, 7
  s_lshr_b32 s33, s16, 3
  s_and_b32 s31, s33, 7
  s_lshr_b32 s33, s33, 3
  s_lshl_b32 s33, s33, 3
  s_add_u32 s30, s32, s33
  v_and_b32 v1, 63, v0
  v_lshrrev_b32 v2, 6, v0
  s_nop 0
  v_readfirstlane_b32 s17, v2
  s_nop 3
  s_and_b32 s18, s17, 1
  s_lshr_b32 s19, s17, 1
  s_mul_i32 s26, s17, 1024
  s_mul_i32 s27, s17, 1024
  s_add_u32 s27, s27, 4096
  v_lshrrev_b32 v2, 3, v1
  v_and_b32 v3, 7, v1
  v_bfe_u32 v4, v2, 1, 1
  v_lshlrev_b32 v4, 2, v4
  v_xor_b32 v3, v3, v4
  v_lshlrev_b32 v3, 4, v3
  s_mov_b32 s28, 1024
  v_mul_lo_u32 v4, v2, s28
  v_add_u32 v10, v3, v4
  v_lshrrev_b32 v5, 2, v1
  v_and_b32 v3, 3, v1
  v_bfe_u32 v4, v1, 4, 2
  v_xor_b32 v3, v3, v4
  v_lshlrev_b32 v3, 4, v3
  s_mov_b32 s28, 8192
  v_mul_lo_u32 v4, v5, s28
  v_add_u32 v11, v3, v4
  v_lshrrev_b32 v2, 5, v1
  v_bfe_u32 v3, v1, 4, 1
  v_bfe_u32 v4, v1, 2, 2
  v_and_b32 v5, 3, v1
  v_lshlrev_b32 v6, 3, v2
  v_add_u32 v6, v6, v4
  s_mov_b32 s28, 128
  v_mul_lo_u32 v6, v6, s28
  v_lshrrev_b32 v7, 1, v5
  v_lshlrev_b32 v8, 1, v3
  v_add_u32 v7, v7, v8
  s_mul_i32 s28, s18, 4
  v_add_u32 v7, s28, v7
  v_lshrrev_b32 v8, 1, v4
  v_lshlrev_b32 v8, 2, v8
  v_and_b32 v5, 1, v5
  v_lshlrev_b32 v5, 3, v5
  v_add_u32 v6, v6, v5
  v_add_u32 v9, 0, v7
  v_xor_b32 v9, v9, v8
  v_lshlrev_b32 v9, 4, v9
  v_add_u32 v12, v6, v9
  v_and_b32 v3, 31, v1
  s_mul_i32 s28, s19, 32
  v_add_u32 v4, s28, v3
  v_lshlrev_b32 v4, 6, v4
  v_add_u32 v4, 4096, v4
  v_bfe_u32 v5, v1, 2, 2
  v_add_u32 v6, 0, v2
  v_xor_b32 v6, v6, v5
  v_lshlrev_b32 v6, 4, v6
  v_add_u32 v14, v4, v6
  v_add_u32 v6, 2, v2
  v_xor_b32 v6, v6, v5
  v_lshlrev_b32 v6, 4, v6
  v_add_u32 v15, v4, v6
  s_mov_b32 s28, 1024
  v_mul_lo_u32 v4, v3, s28
  v_lshlrev_b32 v5, 4, v2
  v_add_u32 v16, v4, v5
  s_add_u32 s28, s50, 0x3000000
  s_addc_u32 s29, s51, 0
  s_mov_b32 s4, s28
  s_mov_b32 s5, s29
  s_mov_b32 s6, 0x1000000
  s_mov_b32 s7, 0x20000
  s_mov_b32 s8, s40
  s_mov_b32 s9, s41
  s_mov_b32 s10, 0x400000
  s_mov_b32 s11, 0x20000
  s_mov_b32 s12, s44
  s_mov_b32 s13, s45
  s_mov_b32 s14, 0x200000
  s_mov_b32 s15, 0x20000
  s_lshl_b32 s28, s30, 6
  s_lshl_b32 s21, s17, 4
  s_add_u32 s21, s21, s28
  s_mul_i32 s21, s21, 8192
  s_lshl_b32 s22, s17, 13
  s_lshl_b32 s28, s31, 7
  s_add_u32 s22, s22, s28
  s_add_u32 m0, s26, 0
  s_add_u32 s28, s22, 0
  buffer_load_dwordx4 v10, s[8:11], s28 offen lds
  s_add_u32 m0, s27, 0
  s_add_u32 s28, s21, 0
  buffer_load_dwordx4 v11, s[4:7], s28 offen lds
  s_add_u32 s22, s22, 32768
  s_add_u32 s21, s21, 64
  s_add_u32 m0, s26, 8192
  s_add_u32 s28, s22, 0
  buffer_load_dwordx4 v10, s[8:11], s28 offen lds
  s_add_u32 m0, s27, 8192
  s_add_u32 s28, s21, 0
  buffer_load_dwordx4 v11, s[4:7], s28 offen lds
  s_add_u32 s22, s22, 32768
  s_add_u32 s21, s21, 64
  s_add_u32 m0, s26, 16384
  s_add_u32 s28, s22, 0
  buffer_load_dwordx4 v10, s[8:11], s28 offen lds
  s_add_u32 m0, s27, 16384
  s_add_u32 s28, s21, 0
  buffer_load_dwordx4 v11, s[4:7], s28 offen lds
  s_add_u32 s22, s22, 32768
  s_add_u32 s21, s21, 64
  s_add_u32 m0, s26, 24576
  s_add_u32 s28, s22, 0
  buffer_load_dwordx4 v10, s[8:11], s28 offen lds
  s_add_u32 m0, s27, 24576
  s_add_u32 s28, s21, 0
  buffer_load_dwordx4 v11, s[4:7], s28 offen lds
  s_add_u32 s22, s22, 32768
  s_add_u32 s21, s21, 64
  s_add_u32 m0, s26, 32768
  s_add_u32 s28, s22, 0
  buffer_load_dwordx4 v10, s[8:11], s28 offen lds
  s_add_u32 m0, s27, 32768
  s_add_u32 s28, s21, 0
  buffer_load_dwordx4 v11, s[4:7], s28 offen lds
  s_add_u32 s22, s22, 32768
  s_add_u32 s21, s21, 64
  s_add_u32 m0, s26, 40960
  s_add_u32 s28, s22, 0
  buffer_load_dwordx4 v10, s[8:11], s28 offen lds
  s_add_u32 m0, s27, 40960
  s_add_u32 s28, s21, 0
  buffer_load_dwordx4 v11, s[4:7], s28 offen lds
  s_add_u32 s22, s22, 32768
  s_add_u32 s21, s21, 64
  s_waitcnt vmcnt(8)
  s_barrier
  ds_read_b64_tr_b16 v[28:29], v12 offset:0
  ds_read_b64_tr_b16 v[30:31], v12 offset:512
  ds_read_b128 v[32:35], v14 offset:0
  ds_read_b64_tr_b16 v[44:45], v12 offset:2048
  ds_read_b64_tr_b16 v[46:47], v12 offset:2560
  ds_read_b128 v[48:51], v15 offset:0
  s_add_u32 m0, s26, 49152
  s_add_u32 s28, s22, 0
  buffer_load_dwordx4 v10, s[8:11], s28 offen lds
  s_add_u32 m0, s27, 49152
  s_add_u32 s28, s21, 0
  buffer_load_dwordx4 v11, s[4:7], s28 offen lds
  s_add_u32 s22, s22, 32768
  s_add_u32 s21, s21, 64
  s_add_u32 m0, s26, 57344
  s_add_u32 s28, s22, 0
  buffer_load_dwordx4 v10, s[8:11], s28 offen lds
  s_add_u32 m0, s27, 57344
  s_add_u32 s28, s21, 0
  buffer_load_dwordx4 v11, s[4:7], s28 offen lds
  s_add_u32 s22, s22, 32768
  s_add_u32 s21, s21, 64
  s_waitcnt lgkmcnt(3)
  v_mfma_f32_32x32x16_bf16 v[64:79], v[28:31], v[32:35], 0
  ds_read_b64_tr_b16 v[28:29], v12 offset:8192
  ds_read_b64_tr_b16 v[30:31], v12 offset:8704
  ds_read_b128 v[32:35], v14 offset:8192
  s_waitcnt lgkmcnt(3)
  v_mfma_f32_32x32x16_bf16 v[64:79], v[44:47], v[48:51], v[64:79]
  ds_read_b64_tr_b16 v[44:45], v12 offset:10240
  ds_read_b64_tr_b16 v[46:47], v12 offset:10752
  ds_read_b128 v[48:51], v15 offset:8192
  s_waitcnt lgkmcnt(3)
  v_mfma_f32_32x32x16_bf16 v[64:79], v[28:31], v[32:35], v[64:79]
  s_waitcnt lgkmcnt(0)
  v_mfma_f32_32x32x16_bf16 v[64:79], v[44:47], v[48:51], v[64:79]
  s_waitcnt vmcnt(8)
  s_barrier
  ds_read_b64_tr_b16 v[28:29], v12 offset:16384
  ds_read_b64_tr_b16 v[30:31], v12 offset:16896
  ds_read_b128 v[32:35], v14 offset:16384
  ds_read_b64_tr_b16 v[44:45], v12 offset:18432
  ds_read_b64_tr_b16 v[46:47], v12 offset:18944
  ds_read_b128 v[48:51], v15 offset:16384
  s_add_u32 m0, s26, 0
  s_add_u32 s28, s22, 0
  buffer_load_dwordx4 v10, s[8:11], s28 offen lds
  s_add_u32 m0, s27, 0
  s_add_u32 s28, s21, 0
  buffer_load_dwordx4 v11, s[4:7], s28 offen lds
  s_add_u32 s22, s22, 32768
  s_add_u32 s21, s21, 64
  s_add_u32 m0, s26, 8192
  s_add_u32 s28, s22, 0
  buffer_load_dwordx4 v10, s[8:11], s28 offen lds
  s_add_u32 m0, s27, 8192
  s_add_u32 s28, s21, 0
  buffer_load_dwordx4 v11, s[4:7], s28 offen lds
  s_add_u32 s22, s22, 32768
  s_add_u32 s21, s21, 64
  s_waitcnt lgkmcnt(3)
  v_mfma_f32_32x32x16_bf16 v[64:79], v[28:31], v[32:35], v[64:79]
  ds_read_b64_tr_b16 v[28:29], v12 offset:24576
  ds_read_b64_tr_b16 v[30:31], v12 offset:25088
  ds_read_b128 v[32:35], v14 offset:24576
  s_waitcnt lgkmcnt(3)
  v_mfma_f32_32x32x16_bf16 v[64:79], v[44:47], v[48:51], v[64:79]
  ds_read_b64_tr_b16 v[44:45], v12 offset:26624
  ds_read_b64_tr_b16 v[46:47], v12 offset:27136
  ds_read_b128 v[48:51], v15 offset:24576
  s_waitcnt lgkmcnt(3)
  v_mfma_f32_32x32x16_bf16 v[64:79], v[28:31], v[32:35], v[64:79]
  s_waitcnt lgkmcnt(0)
  v_mfma_f32_32x32x16_bf16 v[64:79], v[44:47], v[48:51], v[64:79]
  s_waitcnt vmcnt(8)
  s_barrier
  ds_read_b64_tr_b16 v[28:29], v12 offset:32768
  ds_read_b64_tr_b16 v[30:31], v12 offset:33280
  ds_read_b128 v[32:35], v14 offset:32768
  ds_read_b64_tr_b16 v[44:45], v12 offset:34816
  ds_read_b64_tr_b16 v[46:47], v12 offset:35328
  ds_read_b128 v[48:51], v15 offset:32768
  s_add_u32 m0, s26, 16384
  s_add_u32 s28, s22, 0
  buffer_load_dwordx4 v10, s[8:11], s28 offen lds
  s_add_u32 m0, s27, 16384
  s_add_u32 s28, s21, 0
  buffer_load_dwordx4 v11, s[4:7], s28 offen lds
  s_add_u32 s22, s22, 32768
  s_add_u32 s21, s21, 64
  s_add_u32 m0, s26, 24576
  s_add_u32 s28, s22, 0
  buffer_load_dwordx4 v10, s[8:11], s28 offen lds
  s_add_u32 m0, s27, 24576
  s_add_u32 s28, s21, 0
  buffer_load_dwordx4 v11, s[4:7], s28 offen lds
  s_add_u32 s22, s22, 32768
  s_add_u32 s21, s21, 64
  s_waitcnt lgkmcnt(3)
  v_mfma_f32_32x32x16_bf16 v[64:79], v[28:31], v[32:35], v[64:79]
  ds_read_b64_tr_b16 v[28:29], v12 offset:40960
  ds_read_b64_tr_b16 v[30:31], v12 offset:41472
  ds_read_b128 v[32:35], v14 offset:40960
  s_waitcnt lgkmcnt(3)
  v_mfma_f32_32x32x16_bf16 v[64:79], v[44:47], v[48:51], v[64:79]
  ds_read_b64_tr_b16 v[44:45], v12 offset:43008
  ds_read_b64_tr_b16 v[46:47], v12 offset:43520
  ds_read_b128 v[48:51], v15 offset:40960
  s_waitcnt lgkmcnt(3)
  v_mfma_f32_32x32x16_bf16 v[64:79], v[28:31], v[32:35], v[64:79]
  s_waitcnt lgkmcnt(0)
  v_mfma_f32_32x32x16_bf16 v[64:79], v[44:47], v[48:51], v[64:79]
  s_waitcnt vmcnt(8)
  s_barrier
  ds_read_b64_tr_b16 v[28:29], v12 offset:49152
  ds_read_b64_tr_b16 v[30:31], v12 offset:49664
  ds_read_b128 v[32:35], v14 offset:49152
  ds_read_b64_tr_b16 v[44:45], v12 offset:51200
  ds_read_b64_tr_b16 v[46:47], v12 offset:51712
  ds_read_b128 v[48:51], v15 offset:49152
  s_add_u32 m0, s26, 32768
  s_add_u32 s28, s22, 0
  buffer_load_dwordx4 v10, s[8:11], s28 offen lds
  s_add_u32 m0, s27, 32768
  s_add_u32 s28, s21, 0
  buffer_load_dwordx4 v11, s[4:7], s28 offen lds
  s_add_u32 s22, s22, 32768
  s_add_u32 s21, s21, 64
  s_add_u32 m0, s26, 40960
  s_add_u32 s28, s22, 0
  buffer_load_dwordx4 v10, s[8:11], s28 offen lds
  s_add_u32 m0, s27, 40960
  s_add_u32 s28, s21, 0
  buffer_load_dwordx4 v11, s[4:7], s28 offen lds
  s_add_u32 s22, s22, 32768
  s_add_u32 s21, s21, 64
  s_waitcnt lgkmcnt(3)
  v_mfma_f32_32x32x16_bf16 v[64:79], v[28:31], v[32:35], v[64:79]
  ds_read_b64_tr_b16 v[28:29], v12 offset:57344
  ds_read_b64_tr_b16 v[30:31], v12 offset:57856
  ds_read_b128 v[32:35], v14 offset:57344
  s_waitcnt lgkmcnt(3)
  v_mfma_f32_32x32x16_bf16 v[64:79], v[44:47], v[48:51], v[64:79]
  ds_read_b64_tr_b16 v[44:45], v12 offset:59392
  ds_read_b64_tr_b16 v[46:47], v12 offset:59904
  ds_read_b128 v[48:51], v15 offset:57344
  s_waitcnt lgkmcnt(3)
  v_mfma_f32_32x32x16_bf16 v[64:79], v[28:31], v[32:35], v[64:79]
  s_waitcnt lgkmcnt(0)
  v_mfma_f32_32x32x16_bf16 v[64:79], v[44:47], v[48:51], v[64:79]
  s_mov_b32 s20, 14
l3_kernel_mid:
  s_waitcnt vmcnt(8)
  s_barrier
  ds_read_b64_tr_b16 v[28:29], v12 offset:0
  ds_read_b64_tr_b16 v[30:31], v12 offset:512
  ds_read_b128 v[32:35], v14 offset:0
  ds_read_b64_tr_b16 v[44:45], v12 offset:2048
  ds_read_b64_tr_b16 v[46:47], v12 offset:2560
  ds_read_b128 v[48:51], v15 offset:0
  s_add_u32 m0, s26, 49152
  s_add_u32 s28, s22, 0
  buffer_load_dwordx4 v10, s[8:11], s28 offen lds
  s_add_u32 m0, s27, 49152
  s_add_u32 s28, s21, 0
  buffer_load_dwordx4 v11, s[4:7], s28 offen lds
  s_add_u32 s22, s22, 32768
  s_add_u32 s21, s21, 64
  s_add_u32 m0, s26, 57344
  s_add_u32 s28, s22, 0
  buffer_load_dwordx4 v10, s[8:11], s28 offen lds
  s_add_u32 m0, s27, 57344
  s_add_u32 s28, s21, 0
  buffer_load_dwordx4 v11, s[4:7], s28 offen lds
  s_add_u32 s22, s22, 32768
  s_add_u32 s21, s21, 64
  s_waitcnt lgkmcnt(3)
  v_mfma_f32_32x32x16_bf16 v[64:79], v[28:31], v[32:35], v[64:79]
  ds_read_b64_tr_b16 v[28:29], v12 offset:8192
  ds_read_b64_tr_b16 v[30:31], v12 offset:8704
  ds_read_b128 v[32:35], v14 offset:8192
  s_waitcnt lgkmcnt(3)
  v_mfma_f32_32x32x16_bf16 v[64:79], v[44:47], v[48:51], v[64:79]
  ds_read_b64_tr_b16 v[44:45], v12 offset:10240
  ds_read_b64_tr_b16 v[46:47], v12 offset:10752
  ds_read_b128 v[48:51], v15 offset:8192
  s_waitcnt lgkmcnt(3)
  v_mfma_f32_32x32x16_bf16 v[64:79], v[28:31], v[32:35], v[64:79]
  s_waitcnt lgkmcnt(0)
  v_mfma_f32_32x32x16_bf16 v[64:79], v[44:47], v[48:51], v[64:79]
  s_waitcnt vmcnt(8)
  s_barrier
  ds_read_b64_tr_b16 v[28:29], v12 offset:16384
  ds_read_b64_tr_b16 v[30:31], v12 offset:16896
  ds_read_b128 v[32:35], v14 offset:16384
  ds_read_b64_tr_b16 v[44:45], v12 offset:18432
  ds_read_b64_tr_b16 v[46:47], v12 offset:18944
  ds_read_b128 v[48:51], v15 offset:16384
  s_add_u32 m0, s26, 0
  s_add_u32 s28, s22, 0
  buffer_load_dwordx4 v10, s[8:11], s28 offen lds
  s_add_u32 m0, s27, 0
  s_add_u32 s28, s21, 0
  buffer_load_dwordx4 v11, s[4:7], s28 offen lds
  s_add_u32 s22, s22, 32768
  s_add_u32 s21, s21, 64
  s_add_u32 m0, s26, 8192
  s_add_u32 s28, s22, 0
  buffer_load_dwordx4 v10, s[8:11], s28 offen lds
  s_add_u32 m0, s27, 8192
  s_add_u32 s28, s21, 0
  buffer_load_dwordx4 v11, s[4:7], s28 offen lds
  s_add_u32 s22, s22, 32768
  s_add_u32 s21, s21, 64
  s_waitcnt lgkmcnt(3)
  v_mfma_f32_32x32x16_bf16 v[64:79], v[28:31], v[32:35], v[64:79]
  ds_read_b64_tr_b16 v[28:29], v12 offset:24576
  ds_read_b64_tr_b16 v[30:31], v12 offset:25088
  ds_read_b128 v[32:35], v14 offset:24576
  s_waitcnt lgkmcnt(3)
  v_mfma_f32_32x32x16_bf16 v[64:79], v[44:47], v[48:51], v[64:79]
  ds_read_b64_tr_b16 v[44:45], v12 offset:26624
  ds_read_b64_tr_b16 v[46:47], v12 offset:27136
  ds_read_b128 v[48:51], v15 offset:24576
  s_waitcnt lgkmcnt(3)
  v_mfma_f32_32x32x16_bf16 v[64:79], v[28:31], v[32:35], v[64:79]
  s_waitcnt lgkmcnt(0)
  v_mfma_f32_32x32x16_bf16 v[64:79], v[44:47], v[48:51], v[64:79]
  s_waitcnt vmcnt(8)
  s_barrier
  ds_read_b64_tr_b16 v[28:29], v12 offset:32768
  ds_read_b64_tr_b16 v[30:31], v12 offset:33280
  ds_read_b128 v[32:35], v14 offset:32768
  ds_read_b64_tr_b16 v[44:45], v12 offset:34816
  ds_read_b64_tr_b16 v[46:47], v12 offset:35328
  ds_read_b128 v[48:51], v15 offset:32768
  s_add_u32 m0, s26, 16384
  s_add_u32 s28, s22, 0
  buffer_load_dwordx4 v10, s[8:11], s28 offen lds
  s_add_u32 m0, s27, 16384
  s_add_u32 s28, s21, 0
  buffer_load_dwordx4 v11, s[4:7], s28 offen lds
  s_add_u32 s22, s22, 32768
  s_add_u32 s21, s21, 64
  s_add_u32 m0, s26, 24576
  s_add_u32 s28, s22, 0
  buffer_load_dwordx4 v10, s[8:11], s28 offen lds
  s_add_u32 m0, s27, 24576
  s_add_u32 s28, s21, 0
  buffer_load_dwordx4 v11, s[4:7], s28 offen lds
  s_add_u32 s22, s22, 32768
  s_add_u32 s21, s21, 64
  s_waitcnt lgkmcnt(3)
  v_mfma_f32_32x32x16_bf16 v[64:79], v[28:31], v[32:35], v[64:79]
  ds_read_b64_tr_b16 v[28:29], v12 offset:40960
  ds_read_b64_tr_b16 v[30:31], v12 offset:41472
  ds_read_b128 v[32:35], v14 offset:40960
  s_waitcnt lgkmcnt(3)
  v_mfma_f32_32x32x16_bf16 v[64:79], v[44:47], v[48:51], v[64:79]
  ds_read_b64_tr_b16 v[44:45], v12 offset:43008
  ds_read_b64_tr_b16 v[46:47], v12 offset:43520
  ds_read_b128 v[48:51], v15 offset:40960
  s_waitcnt lgkmcnt(3)
  v_mfma_f32_32x32x16_bf16 v[64:79], v[28:31], v[32:35], v[64:79]
  s_waitcnt lgkmcnt(0)
  v_mfma_f32_32x32x16_bf16 v[64:79], v[44:47], v[48:51], v[64:79]
  s_waitcnt vmcnt(8)
  s_barrier
  ds_read_b64_tr_b16 v[28:29], v12 offset:49152
  ds_read_b64_tr_b16 v[30:31], v12 offset:49664
  ds_read_b128 v[32:35], v14 offset:49152
  ds_read_b64_tr_b16 v[44:45], v12 offset:51200
  ds_read_b64_tr_b16 v[46:47], v12 offset:51712
  ds_read_b128 v[48:51], v15 offset:49152
  s_add_u32 m0, s26, 32768
  s_add_u32 s28, s22, 0
  buffer_load_dwordx4 v10, s[8:11], s28 offen lds
  s_add_u32 m0, s27, 32768
  s_add_u32 s28, s21, 0
  buffer_load_dwordx4 v11, s[4:7], s28 offen lds
  s_add_u32 s22, s22, 32768
  s_add_u32 s21, s21, 64
  s_add_u32 m0, s26, 40960
  s_add_u32 s28, s22, 0
  buffer_load_dwordx4 v10, s[8:11], s28 offen lds
  s_add_u32 m0, s27, 40960
  s_add_u32 s28, s21, 0
  buffer_load_dwordx4 v11, s[4:7], s28 offen lds
  s_add_u32 s22, s22, 32768
  s_add_u32 s21, s21, 64
  s_waitcnt lgkmcnt(3)
  v_mfma_f32_32x32x16_bf16 v[64:79], v[28:31], v[32:35], v[64:79]
  ds_read_b64_tr_b16 v[28:29], v12 offset:57344
  ds_read_b64_tr_b16 v[30:31], v12 offset:57856
  ds_read_b128 v[32:35], v14 offset:57344
  s_waitcnt lgkmcnt(3)
  v_mfma_f32_32x32x16_bf16 v[64:79], v[44:47], v[48:51], v[64:79]
  ds_read_b64_tr_b16 v[44:45], v12 offset:59392
  ds_read_b64_tr_b16 v[46:47], v12 offset:59904
  ds_read_b128 v[48:51], v15 offset:57344
  s_waitcnt lgkmcnt(3)
  v_mfma_f32_32x32x16_bf16 v[64:79], v[28:31], v[32:35], v[64:79]
  s_waitcnt lgkmcnt(0)
  v_mfma_f32_32x32x16_bf16 v[64:79], v[44:47], v[48:51], v[64:79]
  s_sub_u32 s20, s20, 1
  s_cmp_lg_u32 s20, 0
  s_cbranch_scc1 l3_kernel_mid
  s_waitcnt vmcnt(8)
  s_barrier
  ds_read_b64_tr_b16 v[28:29], v12 offset:0
  ds_read_b64_tr_b16 v[30:31], v12 offset:512
  ds_read_b128 v[32:35], v14 offset:0
  ds_read_b64_tr_b16 v[44:45], v12 offset:2048
  ds_read_b64_tr_b16 v[46:47], v12 offset:2560
  ds_read_b128 v[48:51], v15 offset:0
  s_add_u32 m0, s26, 49152
  s_add_u32 s28, s22, 0
  buffer_load_dwordx4 v10, s[8:11], s28 offen lds
  s_add_u32 m0, s27, 49152
  s_add_u32 s28, s21, 0
  buffer_load_dwordx4 v11, s[4:7], s28 offen lds
  s_add_u32 s22, s22, 32768
  s_add_u32 s21, s21, 64
  s_add_u32 m0, s26, 57344
  s_add_u32 s28, s22, 0
  buffer_load_dwordx4 v10, s[8:11], s28 offen lds
  s_add_u32 m0, s27, 57344
  s_add_u32 s28, s21, 0
  buffer_load_dwordx4 v11, s[4:7], s28 offen lds
  s_add_u32 s22, s22, 32768
  s_add_u32 s21, s21, 64
  s_waitcnt lgkmcnt(3)
  v_mfma_f32_32x32x16_bf16 v[64:79], v[28:31], v[32:35], v[64:79]
  ds_read_b64_tr_b16 v[28:29], v12 offset:8192
  ds_read_b64_tr_b16 v[30:31], v12 offset:8704
  ds_read_b128 v[32:35], v14 offset:8192
  s_waitcnt lgkmcnt(3)
  v_mfma_f32_32x32x16_bf16 v[64:79], v[44:47], v[48:51], v[64:79]
  ds_read_b64_tr_b16 v[44:45], v12 offset:10240
  ds_read_b64_tr_b16 v[46:47], v12 offset:10752
  ds_read_b128 v[48:51], v15 offset:8192
  s_waitcnt lgkmcnt(3)
  v_mfma_f32_32x32x16_bf16 v[64:79], v[28:31], v[32:35], v[64:79]
  s_waitcnt lgkmcnt(0)
  v_mfma_f32_32x32x16_bf16 v[64:79], v[44:47], v[48:51], v[64:79]
  s_waitcnt vmcnt(8)
  s_barrier
  ds_read_b64_tr_b16 v[28:29], v12 offset:16384
  ds_read_b64_tr_b16 v[30:31], v12 offset:16896
  ds_read_b128 v[32:35], v14 offset:16384
  ds_read_b64_tr_b16 v[44:45], v12 offset:18432
  ds_read_b64_tr_b16 v[46:47], v12 offset:18944
  ds_read_b128 v[48:51], v15 offset:16384
  v_lshrrev_b32 v5, 2, v1
  v_and_b32 v3, 3, v1
  v_bfe_u32 v4, v1, 4, 2
  v_xor_b32 v3, v3, v4
  v_lshlrev_b32 v3, 4, v3
  s_mov_b32 s28, 1024
  v_mul_lo_u32 v4, v5, s28
  v_add_u32 v11, v3, v4
  s_add_u32 s28, s50, 0x4300000
  s_addc_u32 s29, s51, 0
  s_mov_b32 s4, s28
  s_mov_b32 s5, s29
  s_mov_b32 s6, 0x200000
  s_mov_b32 s7, 0x20000
  s_mov_b32 s8, s42
  s_mov_b32 s9, s43
  s_mov_b32 s10, 0x80000
  s_mov_b32 s11, 0x20000
  s_lshl_b32 s28, s30, 6
  s_lshl_b32 s21, s17, 4
  s_add_u32 s21, s21, s28
  s_mul_i32 s21, s21, 1024
  s_lshl_b32 s22, s17, 13
  s_lshl_b32 s28, s31, 7
  s_add_u32 s22, s22, s28
  s_add_u32 m0, s26, 0
  s_add_u32 s28, s22, 0
  buffer_load_dwordx4 v10, s[8:11], s28 offen lds
  s_add_u32 m0, s27, 0
  s_add_u32 s28, s21, 0
  buffer_load_dwordx4 v11, s[4:7], s28 offen lds
  s_add_u32 s22, s22, 32768
  s_add_u32 s21, s21, 64
  s_add_u32 m0, s26, 8192
  s_add_u32 s28, s22, 0
  buffer_load_dwordx4 v10, s[8:11], s28 offen lds
  s_add_u32 m0, s27, 8192
  s_add_u32 s28, s21, 0
  buffer_load_dwordx4 v11, s[4:7], s28 offen lds
  s_add_u32 s22, s22, 32768
  s_add_u32 s21, s21, 64
  s_waitcnt lgkmcnt(3)
  v_mfma_f32_32x32x16_bf16 v[64:79], v[28:31], v[32:35], v[64:79]
  ds_read_b64_tr_b16 v[28:29], v12 offset:24576
  ds_read_b64_tr_b16 v[30:31], v12 offset:25088
  ds_read_b128 v[32:35], v14 offset:24576
  s_waitcnt lgkmcnt(3)
  v_mfma_f32_32x32x16_bf16 v[64:79], v[44:47], v[48:51], v[64:79]
  ds_read_b64_tr_b16 v[44:45], v12 offset:26624
  ds_read_b64_tr_b16 v[46:47], v12 offset:27136
  ds_read_b128 v[48:51], v15 offset:24576
  s_waitcnt lgkmcnt(3)
  v_mfma_f32_32x32x16_bf16 v[64:79], v[28:31], v[32:35], v[64:79]
  s_waitcnt lgkmcnt(0)
  v_mfma_f32_32x32x16_bf16 v[64:79], v[44:47], v[48:51], v[64:79]
  s_waitcnt vmcnt(8)
  s_barrier
  ds_read_b64_tr_b16 v[28:29], v12 offset:32768
  ds_read_b64_tr_b16 v[30:31], v12 offset:33280
  ds_read_b128 v[32:35], v14 offset:32768
  ds_read_b64_tr_b16 v[44:45], v12 offset:34816
  ds_read_b64_tr_b16 v[46:47], v12 offset:35328
  ds_read_b128 v[48:51], v15 offset:32768
  s_add_u32 m0, s26, 16384
  s_add_u32 s28, s22, 0
  buffer_load_dwordx4 v10, s[8:11], s28 offen lds
  s_add_u32 m0, s27, 16384
  s_add_u32 s28, s21, 0
  buffer_load_dwordx4 v11, s[4:7], s28 offen lds
  s_add_u32 s22, s22, 32768
  s_add_u32 s21, s21, 64
  s_add_u32 m0, s26, 24576
  s_add_u32 s28, s22, 0
  buffer_load_dwordx4 v10, s[8:11], s28 offen lds
  s_add_u32 m0, s27, 24576
  s_add_u32 s28, s21, 0
  buffer_load_dwordx4 v11, s[4:7], s28 offen lds
  s_add_u32 s22, s22, 32768
  s_add_u32 s21, s21, 64
  s_waitcnt lgkmcnt(3)
  v_mfma_f32_32x32x16_bf16 v[64:79], v[28:31], v[32:35], v[64:79]
  ds_read_b64_tr_b16 v[28:29], v12 offset:40960
  ds_read_b64_tr_b16 v[30:31], v12 offset:41472
  ds_read_b128 v[32:35], v14 offset:40960
  s_waitcnt lgkmcnt(3)
  v_mfma_f32_32x32x16_bf16 v[64:79], v[44:47], v[48:51], v[64:79]
  ds_read_b64_tr_b16 v[44:45], v12 offset:43008
  ds_read_b64_tr_b16 v[46:47], v12 offset:43520
  ds_read_b128 v[48:51], v15 offset:40960
  s_waitcnt lgkmcnt(3)
  v_mfma_f32_32x32x16_bf16 v[64:79], v[28:31], v[32:35], v[64:79]
  s_waitcnt lgkmcnt(0)
  v_mfma_f32_32x32x16_bf16 v[64:79], v[44:47], v[48:51], v[64:79]
  s_waitcnt vmcnt(8)
  s_barrier
  ds_read_b64_tr_b16 v[28:29], v12 offset:49152
  ds_read_b64_tr_b16 v[30:31], v12 offset:49664
  ds_read_b128 v[32:35], v14 offset:49152
  ds_read_b64_tr_b16 v[44:45], v12 offset:51200
  ds_read_b64_tr_b16 v[46:47], v12 offset:51712
  ds_read_b128 v[48:51], v15 offset:49152
  s_add_u32 m0, s26, 32768
  s_add_u32 s28, s22, 0
  buffer_load_dwordx4 v10, s[8:11], s28 offen lds
  s_add_u32 m0, s27, 32768
  s_add_u32 s28, s21, 0
  buffer_load_dwordx4 v11, s[4:7], s28 offen lds
  s_add_u32 s22, s22, 32768
  s_add_u32 s21, s21, 64
  s_add_u32 m0, s26, 40960
  s_add_u32 s28, s22, 0
  buffer_load_dwordx4 v10, s[8:11], s28 offen lds
  s_add_u32 m0, s27, 40960
  s_add_u32 s28, s21, 0
  buffer_load_dwordx4 v11, s[4:7], s28 offen lds
  s_add_u32 s22, s22, 32768
  s_add_u32 s21, s21, 64
  s_waitcnt lgkmcnt(3)
  v_mfma_f32_32x32x16_bf16 v[64:79], v[28:31], v[32:35], v[64:79]
  ds_read_b64_tr_b16 v[28:29], v12 offset:57344
  ds_read_b64_tr_b16 v[30:31], v12 offset:57856
  ds_read_b128 v[32:35], v14 offset:57344
  s_waitcnt lgkmcnt(3)
  v_mfma_f32_32x32x16_bf16 v[64:79], v[44:47], v[48:51], v[64:79]
  ds_read_b64_tr_b16 v[44:45], v12 offset:59392
  ds_read_b64_tr_b16 v[46:47], v12 offset:59904
  ds_read_b128 v[48:51], v15 offset:57344
  s_waitcnt lgkmcnt(3)
  v_mfma_f32_32x32x16_bf16 v[64:79], v[28:31], v[32:35], v[64:79]
  s_waitcnt lgkmcnt(0)
  v_mfma_f32_32x32x16_bf16 v[64:79], v[44:47], v[48:51], v[64:79]
  s_waitcnt vmcnt(8)
  s_barrier
  ds_read_b64_tr_b16 v[28:29], v12 offset:0
  ds_read_b64_tr_b16 v[30:31], v12 offset:512
  ds_read_b128 v[32:35], v14 offset:0
  ds_read_b64_tr_b16 v[44:45], v12 offset:2048
  ds_read_b64_tr_b16 v[46:47], v12 offset:2560
  ds_read_b128 v[48:51], v15 offset:0
  s_add_u32 m0, s26, 49152
  s_add_u32 s28, s22, 0
  buffer_load_dwordx4 v10, s[8:11], s28 offen lds
  s_add_u32 m0, s27, 49152
  s_add_u32 s28, s21, 0
  buffer_load_dwordx4 v11, s[4:7], s28 offen lds
  s_add_u32 s22, s22, 32768
  s_add_u32 s21, s21, 64
  s_add_u32 m0, s26, 57344
  s_add_u32 s28, s22, 0
  buffer_load_dwordx4 v10, s[8:11], s28 offen lds
  s_add_u32 m0, s27, 57344
  s_add_u32 s28, s21, 0
  buffer_load_dwordx4 v11, s[4:7], s28 offen lds
  s_add_u32 s22, s22, 32768
  s_add_u32 s21, s21, 64
  s_waitcnt lgkmcnt(3)
  v_mfma_f32_32x32x16_bf16 v[80:95], v[28:31], v[32:35], 0
  ds_read_b64_tr_b16 v[28:29], v12 offset:8192
  ds_read_b64_tr_b16 v[30:31], v12 offset:8704
  ds_read_b128 v[32:35], v14 offset:8192
  s_waitcnt lgkmcnt(3)
  v_mfma_f32_32x32x16_bf16 v[80:95], v[44:47], v[48:51], v[80:95]
  ds_read_b64_tr_b16 v[44:45], v12 offset:10240
  ds_read_b64_tr_b16 v[46:47], v12 offset:10752
  ds_read_b128 v[48:51], v15 offset:8192
  s_waitcnt lgkmcnt(3)
  v_mfma_f32_32x32x16_bf16 v[80:95], v[28:31], v[32:35], v[80:95]
  s_waitcnt lgkmcnt(0)
  v_mfma_f32_32x32x16_bf16 v[80:95], v[44:47], v[48:51], v[80:95]
  s_waitcnt vmcnt(8)
  s_barrier
  ds_read_b64_tr_b16 v[28:29], v12 offset:16384
  ds_read_b64_tr_b16 v[30:31], v12 offset:16896
  ds_read_b128 v[32:35], v14 offset:16384
  ds_read_b64_tr_b16 v[44:45], v12 offset:18432
  ds_read_b64_tr_b16 v[46:47], v12 offset:18944
  ds_read_b128 v[48:51], v15 offset:16384
  s_add_u32 m0, s26, 0
  s_add_u32 s28, s22, 0
  buffer_load_dwordx4 v10, s[8:11], s28 offen lds
  s_add_u32 m0, s27, 0
  s_add_u32 s28, s21, 0
  buffer_load_dwordx4 v11, s[4:7], s28 offen lds
  s_add_u32 s22, s22, 32768
  s_add_u32 s21, s21, 64
  s_add_u32 m0, s26, 8192
  s_add_u32 s28, s22, 0
  buffer_load_dwordx4 v10, s[8:11], s28 offen lds
  s_add_u32 m0, s27, 8192
  s_add_u32 s28, s21, 0
  buffer_load_dwordx4 v11, s[4:7], s28 offen lds
  s_add_u32 s22, s22, 32768
  s_add_u32 s21, s21, 64
  s_waitcnt lgkmcnt(3)
  v_mfma_f32_32x32x16_bf16 v[80:95], v[28:31], v[32:35], v[80:95]
  ds_read_b64_tr_b16 v[28:29], v12 offset:24576
  ds_read_b64_tr_b16 v[30:31], v12 offset:25088
  ds_read_b128 v[32:35], v14 offset:24576
  s_waitcnt lgkmcnt(3)
  v_mfma_f32_32x32x16_bf16 v[80:95], v[44:47], v[48:51], v[80:95]
  ds_read_b64_tr_b16 v[44:45], v12 offset:26624
  ds_read_b64_tr_b16 v[46:47], v12 offset:27136
  ds_read_b128 v[48:51], v15 offset:24576
  s_waitcnt lgkmcnt(3)
  v_mfma_f32_32x32x16_bf16 v[80:95], v[28:31], v[32:35], v[80:95]
  s_waitcnt lgkmcnt(0)
  v_mfma_f32_32x32x16_bf16 v[80:95], v[44:47], v[48:51], v[80:95]
  s_waitcnt vmcnt(8)
  s_barrier
  ds_read_b64_tr_b16 v[28:29], v12 offset:32768
  ds_read_b64_tr_b16 v[30:31], v12 offset:33280
  ds_read_b128 v[32:35], v14 offset:32768
  ds_read_b64_tr_b16 v[44:45], v12 offset:34816
  ds_read_b64_tr_b16 v[46:47], v12 offset:35328
  ds_read_b128 v[48:51], v15 offset:32768
  s_add_u32 m0, s26, 16384
  s_add_u32 s28, s22, 0
  buffer_load_dwordx4 v10, s[8:11], s28 offen lds
  s_add_u32 m0, s27, 16384
  s_add_u32 s28, s21, 0
  buffer_load_dwordx4 v11, s[4:7], s28 offen lds
  s_add_u32 s22, s22, 32768
  s_add_u32 s21, s21, 64
  s_add_u32 m0, s26, 24576
  s_add_u32 s28, s22, 0
  buffer_load_dwordx4 v10, s[8:11], s28 offen lds
  s_add_u32 m0, s27, 24576
  s_add_u32 s28, s21, 0
  buffer_load_dwordx4 v11, s[4:7], s28 offen lds
  s_add_u32 s22, s22, 32768
  s_add_u32 s21, s21, 64
  s_waitcnt lgkmcnt(3)
  v_mfma_f32_32x32x16_bf16 v[80:95], v[28:31], v[32:35], v[80:95]
  ds_read_b64_tr_b16 v[28:29], v12 offset:40960
  ds_read_b64_tr_b16 v[30:31], v12 offset:41472
  ds_read_b128 v[32:35], v14 offset:40960
  s_waitcnt lgkmcnt(3)
  v_mfma_f32_32x32x16_bf16 v[80:95], v[44:47], v[48:51], v[80:95]
  ds_read_b64_tr_b16 v[44:45], v12 offset:43008
  ds_read_b64_tr_b16 v[46:47], v12 offset:43520
  ds_read_b128 v[48:51], v15 offset:40960
  s_waitcnt lgkmcnt(3)
  v_mfma_f32_32x32x16_bf16 v[80:95], v[28:31], v[32:35], v[80:95]
  s_waitcnt lgkmcnt(0)
  v_mfma_f32_32x32x16_bf16 v[80:95], v[44:47], v[48:51], v[80:95]
  s_waitcnt vmcnt(8)
  s_barrier
  ds_read_b64_tr_b16 v[28:29], v12 offset:49152
  ds_read_b64_tr_b16 v[30:31], v12 offset:49664
  ds_read_b128 v[32:35], v14 offset:49152
  ds_read_b64_tr_b16 v[44:45], v12 offset:51200
  ds_read_b64_tr_b16 v[46:47], v12 offset:51712
  ds_read_b128 v[48:51], v15 offset:49152
  s_add_u32 m0, s26, 32768
  s_add_u32 s28, s22, 0
  buffer_load_dwordx4 v10, s[8:11], s28 offen lds
  s_add_u32 m0, s27, 32768
  s_add_u32 s28, s21, 0
  buffer_load_dwordx4 v11, s[4:7], s28 offen lds
  s_add_u32 s22, s22, 32768
  s_add_u32 s21, s21, 64
  s_add_u32 m0, s26, 40960
  s_add_u32 s28, s22, 0
  buffer_load_dwordx4 v10, s[8:11], s28 offen lds
  s_add_u32 m0, s27, 40960
  s_add_u32 s28, s21, 0
  buffer_load_dwordx4 v11, s[4:7], s28 offen lds
  s_add_u32 s22, s22, 32768
  s_add_u32 s21, s21, 64
  s_waitcnt lgkmcnt(3)
  v_mfma_f32_32x32x16_bf16 v[80:95], v[28:31], v[32:35], v[80:95]
  ds_read_b64_tr_b16 v[28:29], v12 offset:57344
  ds_read_b64_tr_b16 v[30:31], v12 offset:57856
  ds_read_b128 v[32:35], v14 offset:57344
  s_waitcnt lgkmcnt(3)
  v_mfma_f32_32x32x16_bf16 v[80:95], v[44:47], v[48:51], v[80:95]
  ds_read_b64_tr_b16 v[44:45], v12 offset:59392
  ds_read_b64_tr_b16 v[46:47], v12 offset:59904
  ds_read_b128 v[48:51], v15 offset:57344
  s_waitcnt lgkmcnt(3)
  v_mfma_f32_32x32x16_bf16 v[80:95], v[28:31], v[32:35], v[80:95]
  s_waitcnt lgkmcnt(0)
  v_mfma_f32_32x32x16_bf16 v[80:95], v[44:47], v[48:51], v[80:95]
  s_waitcnt vmcnt(8)
  s_barrier
  ds_read_b64_tr_b16 v[28:29], v12 offset:0
  ds_read_b64_tr_b16 v[30:31], v12 offset:512
  ds_read_b128 v[32:35], v14 offset:0
  ds_read_b64_tr_b16 v[44:45], v12 offset:2048
  ds_read_b64_tr_b16 v[46:47], v12 offset:2560
  ds_read_b128 v[48:51], v15 offset:0
  s_add_u32 m0, s26, 49152
  s_add_u32 s28, s22, 0
  buffer_load_dwordx4 v10, s[8:11], s28 offen lds
  s_add_u32 m0, s27, 49152
  s_add_u32 s28, s21, 0
  buffer_load_dwordx4 v11, s[4:7], s28 offen lds
  s_add_u32 s22, s22, 32768
  s_add_u32 s21, s21, 64
  s_add_u32 m0, s26, 57344
  s_add_u32 s28, s22, 0
  buffer_load_dwordx4 v10, s[8:11], s28 offen lds
  s_add_u32 m0, s27, 57344
  s_add_u32 s28, s21, 0
  buffer_load_dwordx4 v11, s[4:7], s28 offen lds
  s_add_u32 s22, s22, 32768
  s_add_u32 s21, s21, 64
  s_waitcnt lgkmcnt(3)
  v_mfma_f32_32x32x16_bf16 v[80:95], v[28:31], v[32:35], v[80:95]
  ds_read_b64_tr_b16 v[28:29], v12 offset:8192
  ds_read_b64_tr_b16 v[30:31], v12 offset:8704
  ds_read_b128 v[32:35], v14 offset:8192
  s_waitcnt lgkmcnt(3)
  v_mfma_f32_32x32x16_bf16 v[80:95], v[44:47], v[48:51], v[80:95]
  ds_read_b64_tr_b16 v[44:45], v12 offset:10240
  ds_read_b64_tr_b16 v[46:47], v12 offset:10752
  ds_read_b128 v[48:51], v15 offset:8192
  s_waitcnt lgkmcnt(3)
  v_mfma_f32_32x32x16_bf16 v[80:95], v[28:31], v[32:35], v[80:95]
  s_waitcnt lgkmcnt(0)
  v_mfma_f32_32x32x16_bf16 v[80:95], v[44:47], v[48:51], v[80:95]
  s_waitcnt vmcnt(0)
  s_barrier
  ds_read_b64_tr_b16 v[28:29], v12 offset:16384
  ds_read_b64_tr_b16 v[30:31], v12 offset:16896
  ds_read_b128 v[32:35], v14 offset:16384
  ds_read_b64_tr_b16 v[44:45], v12 offset:18432
  ds_read_b64_tr_b16 v[46:47], v12 offset:18944
  ds_read_b128 v[48:51], v15 offset:16384
  s_waitcnt lgkmcnt(3)
  v_mfma_f32_32x32x16_bf16 v[80:95], v[28:31], v[32:35], v[80:95]
  ds_read_b64_tr_b16 v[28:29], v12 offset:24576
  ds_read_b64_tr_b16 v[30:31], v12 offset:25088
  ds_read_b128 v[32:35], v14 offset:24576
  s_waitcnt lgkmcnt(3)
  v_mfma_f32_32x32x16_bf16 v[80:95], v[44:47], v[48:51], v[80:95]
  ds_read_b64_tr_b16 v[44:45], v12 offset:26624
  ds_read_b64_tr_b16 v[46:47], v12 offset:27136
  ds_read_b128 v[48:51], v15 offset:24576
  s_waitcnt lgkmcnt(3)
  v_mfma_f32_32x32x16_bf16 v[80:95], v[28:31], v[32:35], v[80:95]
  s_waitcnt lgkmcnt(0)
  v_mfma_f32_32x32x16_bf16 v[80:95], v[44:47], v[48:51], v[80:95]
  s_waitcnt vmcnt(0)
  s_barrier
  ds_read_b64_tr_b16 v[28:29], v12 offset:32768
  ds_read_b64_tr_b16 v[30:31], v12 offset:33280
  ds_read_b128 v[32:35], v14 offset:32768
  ds_read_b64_tr_b16 v[44:45], v12 offset:34816
  ds_read_b64_tr_b16 v[46:47], v12 offset:35328
  ds_read_b128 v[48:51], v15 offset:32768
  s_waitcnt lgkmcnt(3)
  v_mfma_f32_32x32x16_bf16 v[80:95], v[28:31], v[32:35], v[80:95]
  ds_read_b64_tr_b16 v[28:29], v12 offset:40960
  ds_read_b64_tr_b16 v[30:31], v12 offset:41472
  ds_read_b128 v[32:35], v14 offset:40960
  s_waitcnt lgkmcnt(3)
  v_mfma_f32_32x32x16_bf16 v[80:95], v[44:47], v[48:51], v[80:95]
  ds_read_b64_tr_b16 v[44:45], v12 offset:43008
  ds_read_b64_tr_b16 v[46:47], v12 offset:43520
  ds_read_b128 v[48:51], v15 offset:40960
  s_waitcnt lgkmcnt(3)
  v_mfma_f32_32x32x16_bf16 v[80:95], v[28:31], v[32:35], v[80:95]
  s_waitcnt lgkmcnt(0)
  v_mfma_f32_32x32x16_bf16 v[80:95], v[44:47], v[48:51], v[80:95]
  s_waitcnt vmcnt(0)
  s_barrier
  ds_read_b64_tr_b16 v[28:29], v12 offset:49152
  ds_read_b64_tr_b16 v[30:31], v12 offset:49664
  ds_read_b128 v[32:35], v14 offset:49152
  ds_read_b64_tr_b16 v[44:45], v12 offset:51200
  ds_read_b64_tr_b16 v[46:47], v12 offset:51712
  ds_read_b128 v[48:51], v15 offset:49152
  s_waitcnt lgkmcnt(3)
  v_mfma_f32_32x32x16_bf16 v[80:95], v[28:31], v[32:35], v[80:95]
  ds_read_b64_tr_b16 v[28:29], v12 offset:57344
  ds_read_b64_tr_b16 v[30:31], v12 offset:57856
  ds_read_b128 v[32:35], v14 offset:57344
  s_waitcnt lgkmcnt(3)
  v_mfma_f32_32x32x16_bf16 v[80:95], v[44:47], v[48:51], v[80:95]
  ds_read_b64_tr_b16 v[44:45], v12 offset:59392
  ds_read_b64_tr_b16 v[46:47], v12 offset:59904
  ds_read_b128 v[48:51], v15 offset:57344
  s_waitcnt lgkmcnt(3)
  v_mfma_f32_32x32x16_bf16 v[80:95], v[28:31], v[32:35], v[80:95]
  s_waitcnt lgkmcnt(0)
  v_mfma_f32_32x32x16_bf16 v[80:95], v[44:47], v[48:51], v[80:95]
  s_lshl_b32 s28, s30, 6
  s_lshl_b32 s29, s19, 5
  s_add_u32 s28, s28, s29
  s_lshl_b32 s28, s28, 2
  s_add_u32 s28, s28, 0x4500000
  s_mov_b32 s4, s50
  s_mov_b32 s5, s51
  s_mov_b32 s6, 0x4600000
  s_mov_b32 s7, 0x20000
  v_and_b32 v2, 31, v1
  v_lshlrev_b32 v2, 2, v2
  buffer_load_dword v100, v2, s[4:7], s28 offen
  s_lshl_b32 s23, s30, 6
  s_lshl_b32 s28, s19, 5
  s_add_u32 s23, s23, s28
  s_lshl_b32 s23, s23, 10
  s_lshl_b32 s28, s31, 7
  s_add_u32 s23, s23, s28
  s_lshl_b32 s28, s18, 6
  s_add_u32 s23, s23, s28
  s_waitcnt vmcnt(0)
  v_sub_f32 v101, 1.0, v100
  v_cvt_pk_bf16_f32 v101, 0, v101
  s_nop 15
  s_nop 3
  v_cvt_pk_bf16_f32 v64, 0, v64
  v_cvt_pk_bf16_f32 v80, 0, v80
  v_mul_f32 v64, v100, v64
  v_mul_f32 v80, v101, v80
  v_cvt_pk_bf16_f32 v64, 0, v64
  v_cvt_pk_bf16_f32 v80, 0, v80
  v_add_f32 v64, v64, v80
  v_cvt_pk_bf16_f32 v65, 0, v65
  v_cvt_pk_bf16_f32 v81, 0, v81
  v_mul_f32 v65, v100, v65
  v_mul_f32 v81, v101, v81
  v_cvt_pk_bf16_f32 v65, 0, v65
  v_cvt_pk_bf16_f32 v81, 0, v81
  v_add_f32 v65, v65, v81
  v_cvt_pk_bf16_f32 v66, 0, v66
  v_cvt_pk_bf16_f32 v82, 0, v82
  v_mul_f32 v66, v100, v66
  v_mul_f32 v82, v101, v82
  v_cvt_pk_bf16_f32 v66, 0, v66
  v_cvt_pk_bf16_f32 v82, 0, v82
  v_add_f32 v66, v66, v82
  v_cvt_pk_bf16_f32 v67, 0, v67
  v_cvt_pk_bf16_f32 v83, 0, v83
  v_mul_f32 v67, v100, v67
  v_mul_f32 v83, v101, v83
  v_cvt_pk_bf16_f32 v67, 0, v67
  v_cvt_pk_bf16_f32 v83, 0, v83
  v_add_f32 v67, v67, v83
  v_cvt_pk_bf16_f32 v68, 0, v68
  v_cvt_pk_bf16_f32 v84, 0, v84
  v_mul_f32 v68, v100, v68
  v_mul_f32 v84, v101, v84
  v_cvt_pk_bf16_f32 v68, 0, v68
  v_cvt_pk_bf16_f32 v84, 0, v84
  v_add_f32 v68, v68, v84
  v_cvt_pk_bf16_f32 v69, 0, v69
  v_cvt_pk_bf16_f32 v85, 0, v85
  v_mul_f32 v69, v100, v69
  v_mul_f32 v85, v101, v85
  v_cvt_pk_bf16_f32 v69, 0, v69
  v_cvt_pk_bf16_f32 v85, 0, v85
  v_add_f32 v69, v69, v85
  v_cvt_pk_bf16_f32 v70, 0, v70
  v_cvt_pk_bf16_f32 v86, 0, v86
  v_mul_f32 v70, v100, v70
  v_mul_f32 v86, v101, v86
  v_cvt_pk_bf16_f32 v70, 0, v70
  v_cvt_pk_bf16_f32 v86, 0, v86
  v_add_f32 v70, v70, v86
  v_cvt_pk_bf16_f32 v71, 0, v71
  v_cvt_pk_bf16_f32 v87, 0, v87
  v_mul_f32 v71, v100, v71
  v_mul_f32 v87, v101, v87
  v_cvt_pk_bf16_f32 v71, 0, v71
  v_cvt_pk_bf16_f32 v87, 0, v87
  v_add_f32 v71, v71, v87
  v_cvt_pk_bf16_f32 v72, 0, v72
  v_cvt_pk_bf16_f32 v88, 0, v88
  v_mul_f32 v72, v100, v72
  v_mul_f32 v88, v101, v88
  v_cvt_pk_bf16_f32 v72, 0, v72
  v_cvt_pk_bf16_f32 v88, 0, v88
  v_add_f32 v72, v72, v88
  v_cvt_pk_bf16_f32 v73, 0, v73
  v_cvt_pk_bf16_f32 v89, 0, v89
  v_mul_f32 v73, v100, v73
  v_mul_f32 v89, v101, v89
  v_cvt_pk_bf16_f32 v73, 0, v73
  v_cvt_pk_bf16_f32 v89, 0, v89
  v_add_f32 v73, v73, v89
  v_cvt_pk_bf16_f32 v74, 0, v74
  v_cvt_pk_bf16_f32 v90, 0, v90
  v_mul_f32 v74, v100, v74
  v_mul_f32 v90, v101, v90
  v_cvt_pk_bf16_f32 v74, 0, v74
  v_cvt_pk_bf16_f32 v90, 0, v90
  v_add_f32 v74, v74, v90
  v_cvt_pk_bf16_f32 v75, 0, v75
  v_cvt_pk_bf16_f32 v91, 0, v91
  v_mul_f32 v75, v100, v75
  v_mul_f32 v91, v101, v91
  v_cvt_pk_bf16_f32 v75, 0, v75
  v_cvt_pk_bf16_f32 v91, 0, v91
  v_add_f32 v75, v75, v91
  v_cvt_pk_bf16_f32 v76, 0, v76
  v_cvt_pk_bf16_f32 v92, 0, v92
  v_mul_f32 v76, v100, v76
  v_mul_f32 v92, v101, v92
  v_cvt_pk_bf16_f32 v76, 0, v76
  v_cvt_pk_bf16_f32 v92, 0, v92
  v_add_f32 v76, v76, v92
  v_cvt_pk_bf16_f32 v77, 0, v77
  v_cvt_pk_bf16_f32 v93, 0, v93
  v_mul_f32 v77, v100, v77
  v_mul_f32 v93, v101, v93
  v_cvt_pk_bf16_f32 v77, 0, v77
  v_cvt_pk_bf16_f32 v93, 0, v93
  v_add_f32 v77, v77, v93
  v_cvt_pk_bf16_f32 v78, 0, v78
  v_cvt_pk_bf16_f32 v94, 0, v94
  v_mul_f32 v78, v100, v78
  v_mul_f32 v94, v101, v94
  v_cvt_pk_bf16_f32 v78, 0, v78
  v_cvt_pk_bf16_f32 v94, 0, v94
  v_add_f32 v78, v78, v94
  v_cvt_pk_bf16_f32 v79, 0, v79
  v_cvt_pk_bf16_f32 v95, 0, v95
  v_mul_f32 v79, v100, v79
  v_mul_f32 v95, v101, v95
  v_cvt_pk_bf16_f32 v79, 0, v79
  v_cvt_pk_bf16_f32 v95, 0, v95
  v_add_f32 v79, v79, v95
  s_nop 15
  s_nop 3
  v_cvt_pk_bf16_f32 v20, v64, v65
  v_cvt_pk_bf16_f32 v21, v66, v67
  v_cvt_pk_bf16_f32 v22, v68, v69
  v_cvt_pk_bf16_f32 v23, v70, v71
  s_nop 1
  v_permlane32_swap_b32 v20, v22
  v_permlane32_swap_b32 v21, v23
  buffer_store_dwordx4 v[20:23], v16, s[12:15], s23 offen offset:0
  v_cvt_pk_bf16_f32 v24, v72, v73
  v_cvt_pk_bf16_f32 v25, v74, v75
  v_cvt_pk_bf16_f32 v26, v76, v77
  v_cvt_pk_bf16_f32 v27, v78, v79
  s_nop 1
  v_permlane32_swap_b32 v24, v26
  v_permlane32_swap_b32 v25, v27
  buffer_store_dwordx4 v[24:27], v16, s[12:15], s23 offen offset:32
  s_waitcnt vmcnt(0)
l3_kernel_end:
  s_endpgm
.section .rodata,"a"
.p2align 6
.amdhsa_kernel l3_kernel
  .amdhsa_next_free_vgpr 104
  .amdhsa_next_free_sgpr 64
  .amdhsa_accum_offset 104
  .amdhsa_group_segment_fixed_size 0
  .amdhsa_kernarg_size 120
  .amdhsa_user_sgpr_count 2
  .amdhsa_user_sgpr_kernarg_segment_ptr 1
  .amdhsa_system_sgpr_workgroup_id_x 1
.end_amdhsa_kernel
```
